```python
import torch

def _softmax(x, axis=-1):
    return torch.softmax(x, dim=axis)
def _gelu(x):
    return torch.nn.functional.gelu(x, approximate="tanh")
def _silu(x):
    return torch.nn.functional.silu(x)
def _sigmoid(x):
    return torch.sigmoid(x)
def _layernorm(x, axis=-1, eps=1e-5):
    m = x.mean(dim=axis, keepdim=True)
    v = x.var(dim=axis, keepdim=True, unbiased=False)
    return (x - m) / torch.sqrt(v + eps)
def _scatter_add(tgt, idx, src, axis=0):
    return tgt.clone().index_add_(axis, idx, src)
def _segment_sum(src, seg, n):
    out = torch.zeros((n,) + src.shape[1:], dtype=src.dtype)
    return out.index_add_(0, seg, src)
def _pad(x, pw):
    flat = tuple(v for pair in reversed(pw) for v in pair)
    return torch.nn.functional.pad(x, flat)

kernel_name = 'gated_mix__linear_attn_block__glu_gated_reglu__prompt'

def setup_inputs():

    _w = (lambda a: (lambda t: t.to(torch.bfloat16) if t.is_floating_point() else t)(torch.as_tensor(a)))
    def _A_setup():
        B, S, D = 1, 2048, 512
        return {
            "x": _w((lambda *s: torch.randn(*s, dtype=torch.bfloat16) * 0.05)(B, S, D)),
            "wqkv": _w((lambda *s: torch.randn(*s, dtype=torch.bfloat16) * 0.8)(D, 3 * D)),
            "wo": _w((lambda *s: torch.randn(*s, dtype=torch.bfloat16) * 0.05)(D, D)),
        }
    _A_in = _A_setup()

    def _B_setup():
        B, S, D, F = 1, 2048, 512, 1792
        return {
            "x": _w((lambda *s: torch.randn(*s, dtype=torch.bfloat16) * 0.05)(B, S, D)),
            "W_gate": _w((lambda *s: torch.randn(*s, dtype=torch.bfloat16) * 1.6)(D, F) * (2.0 / D) ** 0.5),
            "W_up": _w((lambda *s: torch.randn(*s, dtype=torch.bfloat16) * 1.6)(D, F) * (2.0 / D) ** 0.5),
            "W_down": _w((lambda *s: torch.randn(*s, dtype=torch.bfloat16) * 1.6)(F, D) * (1.0 / F) ** 0.5),
        }
    _B_in = _B_setup()

    return {
        "A_x": _A_in["x"],
        "A_wqkv": _A_in["wqkv"],
        "A_wo": _A_in["wo"],
        "B_x": _B_in["x"],
        "B_W_gate": _B_in["W_gate"],
        "B_W_up": _B_in["W_up"],
        "B_W_down": _B_in["W_down"],
        "gate_w": _w((lambda *s: torch.randn(*s, dtype=torch.bfloat16) * 0.05)(512) * 16.0),
    }

def reference(A_x, A_wqkv, A_wo, B_x, B_W_gate, B_W_up, B_W_down, gate_w):
    def _A_ref(x, wqkv, wo):
        B, S, D = x.shape
        H = 32; Dh = D // H
        qkv = (lambda x, *d: x.permute(*d))((x @ wqkv).reshape(B, S, 3, H, Dh), 2, 0, 3, 1, 4)
        q, k, v = qkv[0], qkv[1], qkv[2]
        phi = lambda t: torch.where(t > 0, t + 1, torch.exp(t)) + 1e-6
        pq, pk = phi(q), phi(k)
        kv = torch.einsum("bhsd,bhse->bhde", pk, v)
        z = torch.einsum("bhsd->bhd", pk)
        num = torch.einsum("bhqd,bhde->bhqe", pq, kv)
        den = torch.einsum("bhqd,bhd->bhq", pq, z)[..., None] + 1e-6
        o = num / den
        return (lambda x, *d: x.permute(*d))(o, 0, 2, 1, 3).reshape(B, S, D) @ wo

    def _B_ref(x, W_gate, W_up, W_down):
        gate = torch.einsum("bsd,df->bsf", x, W_gate)
        up = torch.einsum("bsd,df->bsf", x, W_up)
        gate = gate * (lambda x, dt: x.to(dt))(gate > 0, gate.dtype)
        h = gate * up
        return torch.einsum("bsf,fd->bsd", h, W_down)

    x = A_x
    g = _sigmoid((x * gate_w).sum(-1, keepdims=True))
    a = _A_ref(x, A_wqkv, A_wo)
    b = _B_ref(x, B_W_gate, B_W_up, B_W_down)
    return g * a + (1 - g) * b
```

```asm
; @launch grid=(256,1,1) block=(256,1,1) lds=163840
.amdgcn_target "amdgcn-amd-amdhsa--gfx950"
.text
.globl gated_mix__linear_attn_block__glu_gated_reglu__prompt_kernel
.p2align 8
.type gated_mix__linear_attn_block__glu_gated_reglu__prompt_kernel,@function
gated_mix__linear_attn_block__glu_gated_reglu__prompt_kernel:
    s_load_dwordx16 s[4:19], s[0:1], 0
    s_cmpk_ge_u32 s2, 0x100
    s_cbranch_scc1 L_end
    s_getpc_b64 s[40:41]
L_pc:
    s_mov_b32 s42, L_code_end-L_pc
    s_mov_b32 s43, 0x20000
    s_andn2_b32 s79, s2, 7
    s_lshl_b32 s79, s79, 8
    v_lshlrev_b32 v30, 3, v0
    v_lshrrev_b32 v28, 6, v0
    buffer_load_dword v26, v30, s[40:43], s79 offen
    s_load_dwordx4 s[20:23], s[0:1], 64
    s_load_dwordx2 s[24:25], s[0:1], 80
    v_readfirstlane_b32 s64, v28
    v_and_b32 v20, 63, v0
    s_bfe_u32 s86, s2, 0x30003
    s_and_b32 s87, s2, 1
    s_lshl3_add_u32 s67, s87, s86
    s_bfe_u32 s68, s2, 0x20001
    s_lshr_b32 s69, s2, 6
    s_mul_i32 s92, s86, 2
    s_lshl1_add_u32 s92, s68, s92
    s_add_u32 s92, s87, s92
    s_lshl2_add_u32 s92, s69, s92
    s_and_b32 s92, s92, 7
    s_and_b32 s79, s69, 1
    s_lshl1_add_u32 s72, s68, s79
    s_lshr_b32 s79, s69, 1
    s_lshl2_add_u32 s75, s72, s79
    s_lshl2_add_u32 s79, s79, 14
    s_cmp_eq_u32 s72, 7
    s_cselect_b32 s75, s79, s75
    s_lshl_b32 s75, s75, 7
    s_lshr_b32 s65, s64, 1
    s_and_b32 s66, s64, 1
    s_lshl_b32 s74, s64, 12
    s_lshl2_add_u32 s73, s67, s64
    s_lshl_b32 s73, s73, 15
    v_lshrrev_b32 v28, 3, v20
    v_lshrrev_b32 v29, 4, v20
    v_and_b32 v30, 7, v20
    v_xor_b32 v29, v29, v30
    v_lshlrev_b32 v29, 4, v29
    v_lshl_add_u32 v36, v28, 10, v29
    v_xor_b32 v29, 64, v36
    v_add_u32 v37, 7168, v29
    v_add_u32 v38, 14336, v36
    v_add_u32 v39, 21504, v29
    v_and_b32 v29, 2, v28
    v_xor_b32 v30, v29, v30
    v_lshl_add_u32 v31, s66, 5, v28
    v_mul_u32_u24 v28, 3584, v31
    v_lshl_add_u32 v40, v30, 4, v28
    v_xor_b32 v28, 64, v40
    v_add_u32 v41, 27648, v28
    v_add_u32 v42, 55296, v40
    v_add_u32 v43, 82944, v28
    s_mov_b32 s30, 2097152
    s_mov_b32 s31, s43
    s_mov_b32 s38, 1835008
    s_mov_b32 s39, s43
    s_add_u32 m0, s74, 131072
    s_mul_i32 s78, s92, 128
    s_add_u32 s78, s78, s73
    s_cmp_eq_u32 s65, 0
    s_waitcnt lgkmcnt(0)
    s_mov_b64 s[28:29], s[4:5]
    s_cselect_b64 s[36:37], s[12:13], s[14:15]
    buffer_load_dwordx4 v36, s[28:31], s78 offen offset:0  lds
    buffer_load_dwordx4 v37, s[28:31], s78 offen offset:1024  lds
    buffer_load_dwordx4 v38, s[28:31], s78 offen offset:2048  lds
    buffer_load_dwordx4 v39, s[28:31], s78 offen offset:3072  lds
    s_add_u32 m0, s74, 0
    s_mul_i32 s78, s92, 229376
    s_add_u32 s78, s78, s75
    buffer_load_dwordx4 v40, s[36:39], s78 offen offset:0  lds
    buffer_load_dwordx4 v41, s[36:39], s78 offen offset:1024  lds
    buffer_load_dwordx4 v42, s[36:39], s78 offen offset:2048  lds
    buffer_load_dwordx4 v43, s[36:39], s78 offen offset:3072  lds
    s_cmp_ge_u32 s69, 2
    s_cbranch_scc1 L_roleB
    s_branch L_roleA
L_end:
    s_endpgm
LA_slow0:
    s_mov_b32 s91, 200000
LA_spin0:
    s_waitcnt lgkmcnt(0)
    s_cmp_ge_u32 s67, 1
    s_cbranch_scc1 LA_back0
    buffer_load_dword v27, off, s[56:59], 0 sc1
    s_waitcnt vmcnt(0)
    v_readfirstlane_b32 s67, v27
    s_nop 3
    s_sub_u32 s91, s91, 1
    s_cmp_lg_u32 s91, 0
    s_cbranch_scc1 LA_spin0
    s_waitcnt lgkmcnt(0)
    s_branch LA_back0
LA_slow1:
    s_mov_b32 s91, 200000
LA_spin1:
    s_waitcnt lgkmcnt(0)
    s_cmp_ge_u32 s69, 4
    s_cbranch_scc1 LA_back1
    s_mov_b32 s69, 0
    s_atomic_add s69, s[48:49], s89 offset:0 glc
    s_sub_u32 s91, s91, 1
    s_cmp_lg_u32 s91, 0
    s_cbranch_scc1 LA_spin1
    s_waitcnt lgkmcnt(0)
    s_branch LA_back1
LA_slow2:
    s_mov_b32 s91, 200000
LA_spin2:
    s_waitcnt lgkmcnt(0)
    s_cmp_ge_u32 s65, 8
    s_cbranch_scc1 LA_back2
    s_mov_b32 s65, 0
    s_atomic_add s65, s[48:49], s89 offset:4 glc
    s_sub_u32 s91, s91, 1
    s_cmp_lg_u32 s91, 0
    s_cbranch_scc1 LA_spin2
    s_waitcnt lgkmcnt(0)
    s_branch LA_back2
LA_slow3:
    s_mov_b32 s91, 200000
LA_spin3:
    s_waitcnt lgkmcnt(0)
    s_cmp_ge_u32 s69, 4
    s_cbranch_scc1 LA_back3
    s_mov_b32 s69, 0
    s_atomic_add s69, s[48:49], s89 offset:8 glc
    s_sub_u32 s91, s91, 1
    s_cmp_lg_u32 s91, 0
    s_cbranch_scc1 LA_spin3
    s_waitcnt lgkmcnt(0)
    s_branch LA_back3
LA_slow4:
    s_mov_b32 s91, 200000
LA_spin4:
    s_waitcnt lgkmcnt(0)
    s_cmp_ge_u32 s65, 4
    s_cbranch_scc1 LA_back4
    s_mov_b32 s65, 0
    s_atomic_add s65, s[48:49], s89 offset:12 glc
    s_sub_u32 s91, s91, 1
    s_cmp_lg_u32 s91, 0
    s_cbranch_scc1 LA_spin4
    s_waitcnt lgkmcnt(0)
    s_branch LA_back4
LA_slow5:
    s_mov_b32 s91, 200000
LA_spin5:
    s_waitcnt lgkmcnt(0)
    s_cmp_ge_u32 s67, 32
    s_cbranch_scc1 LA_back5
    s_mov_b32 s67, 0
    s_atomic_add s67, s[48:49], s76 offset:0 glc
    s_sub_u32 s91, s91, 1
    s_cmp_lg_u32 s91, 0
    s_cbranch_scc1 LA_spin5
    s_waitcnt lgkmcnt(0)
    s_branch LA_back5
LA_slow6:
    s_mov_b32 s91, 200000
LA_spin6:
    s_waitcnt lgkmcnt(0)
    s_cmp_ge_u32 s67, 16
    s_cbranch_scc1 LA_back6
    s_mov_b32 s67, 0
    s_atomic_add s67, s[48:49], s75 offset:0 glc
    s_sub_u32 s91, s91, 1
    s_cmp_lg_u32 s91, 0
    s_cbranch_scc1 LA_spin6
    s_waitcnt lgkmcnt(0)
    s_branch LA_back6
LB_slow0:
    s_mov_b32 s91, 200000
LB_spin0:
    s_waitcnt lgkmcnt(0)
    s_cmp_ge_u32 s67, 1
    s_cbranch_scc1 LB_back0
    buffer_load_dword v27, off, s[56:59], 0 sc1
    s_waitcnt vmcnt(0)
    v_readfirstlane_b32 s67, v27
    s_nop 3
    s_sub_u32 s91, s91, 1
    s_cmp_lg_u32 s91, 0
    s_cbranch_scc1 LB_spin0
    s_waitcnt lgkmcnt(0)
    s_branch LB_back0
LB_slow1:
    s_mov_b32 s91, 200000
LB_spin1:
    s_waitcnt lgkmcnt(0)
    s_cmp_ge_u32 s69, 4
    s_cbranch_scc1 LB_back1
    s_mov_b32 s69, 0
    s_atomic_add s69, s[48:49], s89 offset:0 glc
    s_sub_u32 s91, s91, 1
    s_cmp_lg_u32 s91, 0
    s_cbranch_scc1 LB_spin1
    s_waitcnt lgkmcnt(0)
    s_branch LB_back1
LB_slow2:
    s_mov_b32 s91, 200000
LB_spin2:
    s_waitcnt lgkmcnt(0)
    s_cmp_ge_u32 s65, 8
    s_cbranch_scc1 LB_back2
    s_mov_b32 s65, 0
    s_atomic_add s65, s[48:49], s89 offset:4 glc
    s_sub_u32 s91, s91, 1
    s_cmp_lg_u32 s91, 0
    s_cbranch_scc1 LB_spin2
    s_waitcnt lgkmcnt(0)
    s_branch LB_back2
LB_slow3:
    s_mov_b32 s91, 200000
LB_spin3:
    s_waitcnt lgkmcnt(0)
    s_cmp_ge_u32 s69, 4
    s_cbranch_scc1 LB_back3
    s_mov_b32 s69, 0
    s_atomic_add s69, s[48:49], s89 offset:8 glc
    s_sub_u32 s91, s91, 1
    s_cmp_lg_u32 s91, 0
    s_cbranch_scc1 LB_spin3
    s_waitcnt lgkmcnt(0)
    s_branch LB_back3
LB_slow4:
    s_mov_b32 s91, 200000
LB_spin4:
    s_waitcnt lgkmcnt(0)
    s_cmp_ge_u32 s65, 4
    s_cbranch_scc1 LB_back4
    s_mov_b32 s65, 0
    s_atomic_add s65, s[48:49], s89 offset:12 glc
    s_sub_u32 s91, s91, 1
    s_cmp_lg_u32 s91, 0
    s_cbranch_scc1 LB_spin4
    s_waitcnt lgkmcnt(0)
    s_branch LB_back4
LB_slow5:
    s_mov_b32 s91, 200000
LB_spin5:
    s_waitcnt lgkmcnt(0)
    s_cmp_ge_u32 s67, 32
    s_cbranch_scc1 LB_back5
    s_mov_b32 s67, 0
    s_atomic_add s67, s[48:49], s76 offset:0 glc
    s_sub_u32 s91, s91, 1
    s_cmp_lg_u32 s91, 0
    s_cbranch_scc1 LB_spin5
    s_waitcnt lgkmcnt(0)
    s_branch LB_back5
    .p2align 12
L_roleA:
    s_cmp_eq_u32 s72, 7
    s_cselect_b32 s76, 12, 3
    s_lshl_b32 s76, s76, 7
    s_add_u32 s76, s76, s75
    s_mov_b64 s[32:33], s[6:7]
    s_mov_b32 s34, 1572864
    s_mov_b32 s35, 0x20000
    v_mul_u32_u24 v28, 3072, v31
    v_lshl_add_u32 v44, v30, 4, v28
    v_xor_b32 v28, 64, v44
    v_add_u32 v45, 23552, v28
    v_add_u32 v46, 47104, v44
    v_add_u32 v47, 70656, v28
    s_add_u32 s93, s92, 1
    s_and_b32 s93, s93, 7
    s_add_u32 s94, s93, 1
    s_and_b32 s94, s94, 7
    s_add_u32 s95, s94, 1
    s_and_b32 s95, s95, 7
    s_add_u32 s96, s95, 1
    s_and_b32 s96, s96, 7
    s_add_u32 s97, s96, 1
    s_and_b32 s97, s97, 7
    s_add_u32 s98, s97, 1
    s_and_b32 s98, s98, 7
    s_add_u32 s99, s98, 1
    s_and_b32 s99, s99, 7
    s_mov_b64 s[48:49], s[24:25]
    s_mov_b32 s50, 11206656
    s_mov_b32 s51, 0x20000
    s_lshl1_add_u32 s79, s67, s65
    s_mul_i32 s85, s79, 294912
    s_lshl2_add_u32 s79, s79, s68
    s_lshl_b32 s88, s79, 7
    s_add_u32 s88, s88, 9830400
    s_lshl2_add_u32 s79, s79, s69
    s_lshl1_add_u32 s79, s79, s66
    s_lshl_b32 s3, s79, 1
    v_lshlrev_b32 v21, 4, v20
    v_lshrrev_b32 v28, 4, v20
    v_bfe_u32 v29, v20, 2, 2
    v_lshl_add_u32 v28, v28, 3, v29
    v_and_b32 v29, 3, v20
    v_lshlrev_b32 v29, 3, v29
    v_bfe_u32 v30, v20, 3, 2
    v_lshlrev_b32 v30, 5, v30
    v_lshl_add_u32 v31, v28, 7, v29
    v_or_b32 v31, v31, v30
    s_lshl_b32 s79, s66, 6
    v_xor_b32 v72, s79, v31
    v_xor_b32 v73, 32, v72
    v_add_u32 v74, 0x10000, v72
    v_add_u32 v75, 0x10000, v73
    v_add_u32 v80, s74, v31
    v_and_b32 v28, 15, v20
    v_lshrrev_b32 v29, 4, v20
    v_bfe_u32 v30, v20, 1, 3
    v_xor_b32 v29, v29, v30
    v_lshlrev_b32 v29, 4, v29
    v_lshl_add_u32 v28, v28, 7, v29
    s_lshl_b32 s79, s65, 13
    s_add_u32 s79, s79, 98304
    v_add_u32 v88, s79, v28
    v_xor_b32 v89, 64, v88
    s_cmp_lg_u32 s2, 0
    s_cbranch_scc1 LA_noclear
    v_mov_b32 v12, 0
    v_mov_b32 v13, 0
    v_mov_b32 v14, 0
    v_mov_b32 v15, 0
    s_mul_i32 s86, s64, 6144
    s_add_u32 s86, s86, 9830400
    s_add_u32 s87, s86, 4096
    buffer_store_dwordx4 v[12:15], v21, s[48:51], s86 offen offset:0 sc1
    buffer_store_dwordx4 v[12:15], v21, s[48:51], s86 offen offset:1024 sc1
    buffer_store_dwordx4 v[12:15], v21, s[48:51], s86 offen offset:2048 sc1
    buffer_store_dwordx4 v[12:15], v21, s[48:51], s86 offen offset:3072 sc1
    buffer_store_dwordx4 v[12:15], v21, s[48:51], s87 offen offset:0 sc1
    buffer_store_dwordx4 v[12:15], v21, s[48:51], s87 offen offset:1024 sc1
    s_nop 1
LA_noclear:
    s_mov_b64 exec, 0
    s_cmp_eq_u32 s64, 1
    s_cbranch_scc1 LA_pg2
    s_cmp_eq_u32 s64, 2
    s_cbranch_scc1 LA_pg3
    s_cmp_eq_u32 s64, 3
    s_cbranch_scc1 LA_pg4
    s_branch LA_pg1
LA_walked:
    s_mov_b64 exec, -1
    s_mov_b64 s[56:57], s[22:23]
    s_mov_b32 s58, 256
    s_mov_b32 s59, 0x20000
    s_mov_b64 s[60:61], s[18:19]
    s_mov_b32 s62, 1024
    s_mov_b32 s63, 0x20000
    s_mov_b64 s[40:41], s[16:17]
    s_mov_b32 s42, 1835008
    s_mov_b32 s43, 0x20000
    s_mov_b64 s[44:45], s[8:9]
    s_mov_b32 s46, 524288
    s_mov_b32 s47, 0x20000
    s_mov_b64 s[52:53], s[20:21]
    s_mov_b32 s54, 2097152
    s_mov_b32 s55, 0x20000
    v_mov_b32 v29, 0x40000000
    v_lshlrev_b32 v31, 7, v20
    s_and_b32 s1, s2, 255
    s_add_u32 m0, s74, 147456
    s_mul_i32 s78, s93, 128
    s_add_u32 s78, s78, s73
    buffer_load_dwordx4 v36, s[28:31], s78 offen offset:0  lds
    v_cmp_gt_u32 vcc, 14, v20
    s_lshl2_add_u32 s1, s1, s64
    s_mul_i32 s0, s1, 1792
    v_cndmask_b32 v66, v29, v31, vcc
    v_cmp_gt_u32 vcc, 4, v20
    s_mul_i32 s1, s1, 512
    s_and_b32 s86, s69, 1
    v_cndmask_b32 v67, v29, v31, vcc
    s_xor_b32 s77, s72, 4
    s_lshl_b32 s77, s77, 7
    s_bfe_u32 s70, s2, 0x30003
    s_lshr_b32 s79, s2, 7
    s_xor_b32 s79, s79, s70
    s_and_b32 s79, s79, 1
    s_and_b32 s71, s69, 1
    s_xor_b32 s71, s71, 1
    s_lshl1_add_u32 s71, s71, s79
    s_and_b32 s79, s2, 1
    buffer_load_dwordx4 v37, s[28:31], s78 offen offset:1024  lds
    s_lshl2_add_u32 s71, s79, s71
    s_lshl3_add_u32 s70, s68, s70
    s_lshl1_add_u32 s90, s72, s66
    s_lshl1_add_u32 s90, s90, s65
    s_xor_b32 s90, s90, 16
    v_xor_b32 v81, 32, v80
    v_xor_b32 v82, 64, v80
    v_xor_b32 v83, 0x60, v80
    v_add_u32 v84, 0x10000, v80
    v_add_u32 v85, 0x10000, v81
    v_add_u32 v86, 0x10000, v82
    v_add_u32 v87, 0x10000, v83
    v_bfe_u32 v28, v20, 1, 3
    v_bfe_u32 v29, v20, 4, 1
    v_lshlrev_b32 v29, 2, v29
    v_sub_u32 v28, v28, v29
    v_and_b32 v30, 1, v20
    v_lshlrev_b32 v30, 4, v30
    buffer_load_dwordx4 v38, s[28:31], s78 offen offset:2048  lds
    v_mov_b32 v31, 0x3f80
    v_lshlrev_b32 v30, v30, v31
    v_cmp_eq_u32 vcc, 0, v28
    s_nop 1
    v_cndmask_b32 v92, 0, v30, vcc
    v_cmp_eq_u32 vcc, 1, v28
    s_nop 1
    v_cndmask_b32 v93, 0, v30, vcc
    v_cmp_eq_u32 vcc, 2, v28
    s_nop 1
    v_cndmask_b32 v94, 0, v30, vcc
    v_cmp_eq_u32 vcc, 3, v28
    s_nop 1
    v_cndmask_b32 v95, 0, v30, vcc
    v_lshrrev_b32 v28, 5, v20
    v_bfe_u32 v29, v20, 3, 2
    v_lshl_add_u32 v28, v28, 4, v29
    v_lshlrev_b32 v28, 10, v28
    v_and_b32 v29, 2, v29
    v_and_b32 v30, 7, v20
    v_xor_b32 v29, v29, v30
    v_lshl_add_u32 v52, v29, 4, v28
    buffer_load_dwordx4 v39, s[28:31], s78 offen offset:3072  lds
    v_xor_b32 v28, 64, v52
    v_add_u32 v53, 3072, v28
    v_add_u32 v54, 6144, v52
    v_add_u32 v55, 9216, v28
    v_lshl_or_b32 v56, s64, 10, v21
    v_xor_b32 v57, 1024, v56
    v_xor_b32 v58, 2048, v56
    v_xor_b32 v59, 3072, v56
    v_and_b32 v28, 15, v20
    v_lshlrev_b32 v22, 2, v28
    v_mov_b32 v29, 0x40000000
    v_and_b32 v28, 31, v20
    v_cmp_eq_u32 vcc, 0, v28
    v_lshrrev_b32 v30, 3, v20
    s_mul_i32 s79, s70, 294912
    v_cndmask_b32 v24, v29, v30, vcc
    s_lshl2_add_u32 s81, s74, s79
    s_lshl1_add_u32 s82, s74, s79
    s_add_u32 m0, s74, 16384
    s_mul_i32 s78, s93, 229376
    s_add_u32 s78, s78, s75
    buffer_load_dwordx4 v40, s[36:39], s78 offen offset:0  lds
    s_lshl_b32 s79, s71, 7
    s_lshl4_add_u32 s84, s74, s79
    s_lshl4_add_u32 s83, s74, s84
    s_xor_b32 s83, s83, 0x40000
    s_lshl2_add_u32 s84, s64, 2
    s_lshl3_add_u32 vcc_lo, s64, 4
    s_cmp_eq_u32 s64, 3
    s_cselect_b32 s84, 22, s84
    s_cmp_eq_u32 s64, 3
    s_cselect_b32 vcc_lo, 14, vcc_lo
    s_cmp_eq_u32 s64, 3
    s_cselect_b32 vcc_hi, 4, 1
    s_lshl_b32 s84, s84, 16
    s_add_u32 s84, s84, s79
    s_lshl_b32 vcc_lo, vcc_lo, 16
    s_add_u32 vcc_lo, vcc_lo, s79
    s_lshl_b32 vcc_hi, vcc_hi, 16
    s_lshl_b32 s10, s64, 19
    buffer_load_dwordx4 v41, s[36:39], s78 offen offset:1024  lds
    s_add_u32 s10, s10, s79
    s_mov_b32 s11, 0x10000
    s_lshl2_add_u32 s79, s70, s64
    s_lshl_b32 s89, s79, 7
    s_add_u32 s89, s89, 9830400
    s_cmp_eq_u32 s65, 0
    s_cselect_b32 s24, s92, s93
    s_cmp_eq_u32 s65, 0
    s_cselect_b32 s25, s94, s95
    s_cmp_eq_u32 s65, 0
    s_cselect_b32 s26, s96, s97
    s_cmp_eq_u32 s65, 0
    s_cselect_b32 s27, s98, s99
    s_bfe_u32 s87, s70, 0x10001
    s_lshl_b32 s79, s87, 13
    s_sub_u32 s18, s81, s79
    s_add_u32 s81, s81, s79
    s_lshl_b32 s79, s87, 12
    buffer_load_dwordx4 v42, s[36:39], s78 offen offset:2048  lds
    s_sub_u32 s19, s82, s79
    s_add_u32 s82, s82, s79
    s_lshl_b32 s79, s87, 16
    s_sub_u32 s20, s83, s79
    s_add_u32 s83, s83, s79
    s_lshl_b32 s79, s87, 15
    s_sub_u32 s21, s84, s79
    s_add_u32 s84, s84, s79
    s_mov_b64 s[12:13], s[10:11]
    s_cmp_eq_u32 s87, 0
    s_cselect_b64 s[10:11], s[12:13], vcc
    s_cmp_eq_u32 s87, 0
    s_cselect_b64 vcc, vcc, s[12:13]
    s_mov_b32 s12, 1
    s_mov_b32 s13, 1
    s_mov_b32 s14, 1
    s_mov_b32 s15, 1
    buffer_load_dwordx4 v43, s[36:39], s78 offen offset:3072  lds
    s_waitcnt vmcnt(8)
    s_barrier
    ds_read_b128 a[0:3], v88 offset:32768
    ds_read_b128 a[4:7], v88 offset:34816
    ds_read_b128 a[8:11], v88 offset:36864
    ds_read_b128 a[12:15], v88 offset:38912
    ds_read_b64_tr_b16 v[104:105], v72 offset:0
    ds_read_b64_tr_b16 v[106:107], v72 offset:512
    ds_read_b64_tr_b16 v[108:109], v72 offset:4096
    ds_read_b64_tr_b16 v[110:111], v72 offset:4608
    ds_read_b128 a[16:19], v89 offset:32768
    ds_read_b128 a[20:23], v89 offset:34816
    ds_read_b128 a[24:27], v89 offset:36864
    ds_read_b128 a[28:31], v89 offset:38912
    ds_read_b64_tr_b16 v[112:113], v73 offset:0
    ds_read_b64_tr_b16 v[114:115], v73 offset:512
    ds_read_b64_tr_b16 v[116:117], v73 offset:4096
    ds_read_b64_tr_b16 v[118:119], v73 offset:4608
    s_waitcnt lgkmcnt(4)
    v_mfma_f32_16x16x32_bf16 v[128:131], v[104:107], a[0:3], 0
    ds_read_b64_tr_b16 v[120:121], v72 offset:8192
    s_add_u32 m0, s74, 114688
    v_mfma_f32_16x16x32_bf16 v[128:131], v[108:111], a[16:19], v[128:131]
    s_mul_i32 s78, s94, 128
    s_add_u32 s78, s78, s73
    buffer_load_dwordx4 v36, s[28:31], s78 offen offset:0  lds
    v_mfma_f32_16x16x32_bf16 v[132:135], v[104:107], a[4:7], 0
    ds_read_b64_tr_b16 v[122:123], v72 offset:8704
    v_mfma_f32_16x16x32_bf16 v[132:135], v[108:111], a[20:23], v[132:135]
    buffer_load_dwordx4 v37, s[28:31], s78 offen offset:1024  lds
    v_mfma_f32_16x16x32_bf16 v[136:139], v[104:107], a[8:11], 0
    ds_read_b64_tr_b16 v[124:125], v72 offset:12288
    v_mfma_f32_16x16x32_bf16 v[136:139], v[108:111], a[24:27], v[136:139]
    buffer_load_dwordx4 v38, s[28:31], s78 offen offset:2048  lds
    v_mfma_f32_16x16x32_bf16 v[140:143], v[104:107], a[12:15], 0
    ds_read_b64_tr_b16 v[126:127], v72 offset:12800
    v_mfma_f32_16x16x32_bf16 v[140:143], v[108:111], a[28:31], v[140:143]
    s_waitcnt lgkmcnt(4)
    buffer_load_dwordx4 v39, s[28:31], s78 offen offset:3072  lds
    v_mfma_f32_16x16x32_bf16 v[156:159], v[112:115], a[12:15], 0
    ds_read_b64_tr_b16 v[104:105], v73 offset:8192
    s_add_u32 m0, s74, 32768
    v_mfma_f32_16x16x32_bf16 v[156:159], v[116:119], a[28:31], v[156:159]
    s_mul_i32 s78, s94, 229376
    s_add_u32 s78, s78, s75
    buffer_load_dwordx4 v40, s[36:39], s78 offen offset:0  lds
    v_mfma_f32_16x16x32_bf16 v[152:155], v[112:115], a[8:11], 0
    ds_read_b64_tr_b16 v[106:107], v73 offset:8704
    v_mfma_f32_16x16x32_bf16 v[152:155], v[116:119], a[24:27], v[152:155]
    buffer_load_dwordx4 v41, s[36:39], s78 offen offset:1024  lds
    v_mfma_f32_16x16x32_bf16 v[148:151], v[112:115], a[4:7], 0
    ds_read_b64_tr_b16 v[108:109], v73 offset:12288
    v_mfma_f32_16x16x32_bf16 v[148:151], v[116:119], a[20:23], v[148:151]
    buffer_load_dwordx4 v42, s[36:39], s78 offen offset:2048  lds
    v_mfma_f32_16x16x32_bf16 v[144:147], v[112:115], a[0:3], 0
    ds_read_b64_tr_b16 v[110:111], v73 offset:12800
    v_mfma_f32_16x16x32_bf16 v[144:147], v[116:119], a[16:19], v[144:147]
    s_waitcnt vmcnt(7) lgkmcnt(4)
    s_barrier
    buffer_load_dwordx4 v43, s[36:39], s78 offen offset:3072  lds
    v_mfma_f32_16x16x32_bf16 v[160:163], v[120:123], a[0:3], 0
    ds_read_b128 a[32:35], v88 offset:49152
    s_add_u32 m0, s74, 49152
    s_or_b32 s91, s2, s64
    s_cbranch_scc1 LA_nogo
    s_mov_b32 s22, 1
    s_atomic_add s22, s[56:57], 0 glc
LA_nogo:
    v_mfma_f32_16x16x32_bf16 v[160:163], v[124:127], a[16:19], v[160:163]
    ds_read_b128 a[36:39], v88 offset:51200
    s_mul_i32 s78, s92, 229376
    s_add_u32 s78, s78, s76
    buffer_load_dwordx4 v40, s[36:39], s78 offen offset:0  lds
    v_mfma_f32_16x16x32_bf16 v[164:167], v[120:123], a[4:7], 0
    ds_read_b128 a[40:43], v88 offset:53248
    v_mfma_f32_16x16x32_bf16 v[164:167], v[124:127], a[20:23], v[164:167]
    ds_read_b128 a[44:47], v88 offset:55296
    v_mfma_f32_16x16x32_bf16 v[168:171], v[120:123], a[8:11], 0
    ds_read_b64_tr_b16 v[112:113], v72 offset:16384
    v_mfma_f32_16x16x32_bf16 v[168:171], v[124:127], a[24:27], v[168:171]
    ds_read_b64_tr_b16 v[114:115], v72 offset:16896
    buffer_load_dwordx4 v41, s[36:39], s78 offen offset:1024  lds
    v_mfma_f32_16x16x32_bf16 v[172:175], v[120:123], a[12:15], 0
    ds_read_b64_tr_b16 v[116:117], v72 offset:20480
    v_mfma_f32_16x16x32_bf16 v[172:175], v[124:127], a[28:31], v[172:175]
    s_waitcnt lgkmcnt(7)
    ds_read_b64_tr_b16 v[118:119], v72 offset:20992
    v_mfma_f32_16x16x32_bf16 v[188:191], v[104:107], a[12:15], 0
    ds_read_b128 a[48:51], v89 offset:49152
    v_mfma_f32_16x16x32_bf16 v[188:191], v[108:111], a[28:31], v[188:191]
    ds_read_b128 a[52:55], v89 offset:51200
    buffer_load_dwordx4 v42, s[36:39], s78 offen offset:2048  lds
    v_mfma_f32_16x16x32_bf16 v[184:187], v[104:107], a[8:11], 0
    ds_read_b128 a[56:59], v89 offset:53248
    v_mfma_f32_16x16x32_bf16 v[184:187], v[108:111], a[24:27], v[184:187]
    ds_read_b128 a[60:63], v89 offset:55296
    v_mfma_f32_16x16x32_bf16 v[180:183], v[104:107], a[4:7], 0
    ds_read_b64_tr_b16 v[120:121], v73 offset:16384
    v_mfma_f32_16x16x32_bf16 v[180:183], v[108:111], a[20:23], v[180:183]
    ds_read_b64_tr_b16 v[122:123], v73 offset:16896
    buffer_load_dwordx4 v43, s[36:39], s78 offen offset:3072  lds
    v_mfma_f32_16x16x32_bf16 v[176:179], v[104:107], a[0:3], 0
    ds_read_b64_tr_b16 v[124:125], v73 offset:20480
    s_add_u32 m0, s74, 131072
    v_mfma_f32_16x16x32_bf16 v[176:179], v[108:111], a[16:19], v[176:179]
    s_waitcnt lgkmcnt(3)
    ds_read_b64_tr_b16 v[126:127], v73 offset:20992
    v_mfma_f32_16x16x32_bf16 v[128:131], v[112:115], a[32:35], v[128:131]
    ds_read_b64_tr_b16 v[104:105], v72 offset:24576
    s_mul_i32 s78, s95, 128
    v_mfma_f32_16x16x32_bf16 v[128:131], v[116:119], a[48:51], v[128:131]
    s_add_u32 s78, s78, s73
    buffer_load_dwordx4 v36, s[28:31], s78 offen offset:0  lds
    v_mfma_f32_16x16x32_bf16 v[132:135], v[112:115], a[36:39], v[132:135]
    ds_read_b64_tr_b16 v[106:107], v72 offset:25088
    v_mfma_f32_16x16x32_bf16 v[132:135], v[116:119], a[52:55], v[132:135]
    buffer_load_dwordx4 v37, s[28:31], s78 offen offset:1024  lds
    v_mfma_f32_16x16x32_bf16 v[136:139], v[112:115], a[40:43], v[136:139]
    ds_read_b64_tr_b16 v[108:109], v72 offset:28672
    v_mfma_f32_16x16x32_bf16 v[136:139], v[116:119], a[56:59], v[136:139]
    buffer_load_dwordx4 v38, s[28:31], s78 offen offset:2048  lds
    v_mfma_f32_16x16x32_bf16 v[140:143], v[112:115], a[44:47], v[140:143]
    ds_read_b64_tr_b16 v[110:111], v72 offset:29184
    v_mfma_f32_16x16x32_bf16 v[140:143], v[116:119], a[60:63], v[140:143]
    s_waitcnt lgkmcnt(4)
    v_mfma_f32_16x16x32_bf16 v[156:159], v[120:123], a[44:47], v[156:159]
    ds_read_b64_tr_b16 v[112:113], v73 offset:24576
    v_mfma_f32_16x16x32_bf16 v[156:159], v[124:127], a[60:63], v[156:159]
    buffer_load_dwordx4 v39, s[28:31], s78 offen offset:3072  lds
    v_mfma_f32_16x16x32_bf16 v[152:155], v[120:123], a[40:43], v[152:155]
    ds_read_b64_tr_b16 v[114:115], v73 offset:25088
    s_add_u32 m0, s74, 65536
    v_mfma_f32_16x16x32_bf16 v[152:155], v[124:127], a[56:59], v[152:155]
    s_mul_i32 s78, s95, 229376
    s_add_u32 s78, s78, s75
    buffer_load_dwordx4 v40, s[36:39], s78 offen offset:0  lds
    v_mfma_f32_16x16x32_bf16 v[148:151], v[120:123], a[36:39], v[148:151]
    ds_read_b64_tr_b16 v[116:117], v73 offset:28672
    v_mfma_f32_16x16x32_bf16 v[148:151], v[124:127], a[52:55], v[148:151]
    buffer_load_dwordx4 v41, s[36:39], s78 offen offset:1024  lds
    v_mfma_f32_16x16x32_bf16 v[144:147], v[120:123], a[32:35], v[144:147]
    ds_read_b64_tr_b16 v[118:119], v73 offset:29184
    v_mfma_f32_16x16x32_bf16 v[144:147], v[124:127], a[48:51], v[144:147]
    s_waitcnt vmcnt(10) lgkmcnt(4)
    s_barrier
    v_mfma_f32_16x16x32_bf16 v[160:163], v[104:107], a[32:35], v[160:163]
    ds_read_b128 a[64:67], v88 offset:16384
    v_mfma_f32_16x16x32_bf16 v[160:163], v[108:111], a[48:51], v[160:163]
    ds_read_b128 a[68:71], v88 offset:18432
    buffer_load_dwordx4 v42, s[36:39], s78 offen offset:2048  lds
    v_mfma_f32_16x16x32_bf16 v[164:167], v[104:107], a[36:39], v[164:167]
    ds_read_b128 a[72:75], v88 offset:20480
    v_mfma_f32_16x16x32_bf16 v[164:167], v[108:111], a[52:55], v[164:167]
    ds_read_b128 a[76:79], v88 offset:22528
    buffer_load_dwordx4 v43, s[36:39], s78 offen offset:3072  lds
    v_mfma_f32_16x16x32_bf16 v[168:171], v[104:107], a[40:43], v[168:171]
    ds_read_b64_tr_b16 v[120:121], v72 offset:32768
    v_mfma_f32_16x16x32_bf16 v[168:171], v[108:111], a[56:59], v[168:171]
    ds_read_b64_tr_b16 v[122:123], v72 offset:33280
    buffer_load_dword v62, v66, s[40:43], s0 offen
    buffer_load_dword v63, v67, s[44:47], s1 offen
    v_mfma_f32_16x16x32_bf16 v[172:175], v[104:107], a[44:47], v[172:175]
    ds_read_b64_tr_b16 v[124:125], v72 offset:36864
    s_add_u32 m0, s74, 147456
    v_mfma_f32_16x16x32_bf16 v[172:175], v[108:111], a[60:63], v[172:175]
    s_waitcnt lgkmcnt(7)
    ds_read_b64_tr_b16 v[126:127], v72 offset:37376
    v_mfma_f32_16x16x32_bf16 v[188:191], v[112:115], a[44:47], v[188:191]
    ds_read_b128 a[80:83], v89 offset:16384
    s_mul_i32 s78, s96, 128
    v_mfma_f32_16x16x32_bf16 v[188:191], v[116:119], a[60:63], v[188:191]
    ds_read_b128 a[84:87], v89 offset:18432
    s_add_u32 s78, s78, s73
    buffer_load_dwordx4 v36, s[28:31], s78 offen offset:0  lds
    v_mfma_f32_16x16x32_bf16 v[184:187], v[112:115], a[40:43], v[184:187]
    ds_read_b128 a[88:91], v89 offset:20480
    v_mfma_f32_16x16x32_bf16 v[184:187], v[116:119], a[56:59], v[184:187]
    ds_read_b128 a[92:95], v89 offset:22528
    v_mfma_f32_16x16x32_bf16 v[180:183], v[112:115], a[36:39], v[180:183]
    ds_read_b64_tr_b16 v[104:105], v73 offset:32768
    v_mfma_f32_16x16x32_bf16 v[180:183], v[116:119], a[52:55], v[180:183]
    ds_read_b64_tr_b16 v[106:107], v73 offset:33280
    buffer_load_dwordx4 v37, s[28:31], s78 offen offset:1024  lds
    v_mfma_f32_16x16x32_bf16 v[176:179], v[112:115], a[32:35], v[176:179]
    ds_read_b64_tr_b16 v[108:109], v73 offset:36864
    v_mfma_f32_16x16x32_bf16 v[176:179], v[116:119], a[48:51], v[176:179]
    s_waitcnt lgkmcnt(3)
    ds_read_b64_tr_b16 v[110:111], v73 offset:37376
    v_mfma_f32_16x16x32_bf16 v[128:131], v[120:123], a[64:67], v[128:131]
    ds_read_b64_tr_b16 v[112:113], v72 offset:40960
    v_mfma_f32_16x16x32_bf16 v[128:131], v[124:127], a[80:83], v[128:131]
    buffer_load_dwordx4 v38, s[28:31], s78 offen offset:2048  lds
    v_mfma_f32_16x16x32_bf16 v[132:135], v[120:123], a[68:71], v[132:135]
    ds_read_b64_tr_b16 v[114:115], v72 offset:41472
    v_mfma_f32_16x16x32_bf16 v[132:135], v[124:127], a[84:87], v[132:135]
    buffer_load_dwordx4 v39, s[28:31], s78 offen offset:3072  lds
    v_mfma_f32_16x16x32_bf16 v[136:139], v[120:123], a[72:75], v[136:139]
    ds_read_b64_tr_b16 v[116:117], v72 offset:45056
    s_add_u32 m0, s74, 81920
    v_mfma_f32_16x16x32_bf16 v[136:139], v[124:127], a[88:91], v[136:139]
    s_mul_i32 s78, s96, 229376
    s_add_u32 s78, s78, s75
    buffer_load_dwordx4 v40, s[36:39], s78 offen offset:0  lds
    v_mfma_f32_16x16x32_bf16 v[140:143], v[120:123], a[76:79], v[140:143]
    ds_read_b64_tr_b16 v[118:119], v72 offset:45568
    v_mfma_f32_16x16x32_bf16 v[140:143], v[124:127], a[92:95], v[140:143]
    s_waitcnt lgkmcnt(4)
    v_mfma_f32_16x16x32_bf16 v[156:159], v[104:107], a[76:79], v[156:159]
    ds_read_b64_tr_b16 v[120:121], v73 offset:40960
    v_mfma_f32_16x16x32_bf16 v[156:159], v[108:111], a[92:95], v[156:159]
    buffer_load_dwordx4 v41, s[36:39], s78 offen offset:1024  lds
    v_mfma_f32_16x16x32_bf16 v[152:155], v[104:107], a[72:75], v[152:155]
    ds_read_b64_tr_b16 v[122:123], v73 offset:41472
    v_mfma_f32_16x16x32_bf16 v[152:155], v[108:111], a[88:91], v[152:155]
    buffer_load_dwordx4 v42, s[36:39], s78 offen offset:2048  lds
    v_mfma_f32_16x16x32_bf16 v[148:151], v[104:107], a[68:71], v[148:151]
    ds_read_b64_tr_b16 v[124:125], v73 offset:45056
    v_mfma_f32_16x16x32_bf16 v[148:151], v[108:111], a[84:87], v[148:151]
    buffer_load_dwordx4 v43, s[36:39], s78 offen offset:3072  lds
    v_mfma_f32_16x16x32_bf16 v[144:147], v[104:107], a[64:67], v[144:147]
    ds_read_b64_tr_b16 v[126:127], v73 offset:45568
    s_lshl_b32 s3, s3, 10
    v_mfma_f32_16x16x32_bf16 v[144:147], v[108:111], a[80:83], v[144:147]
    s_waitcnt vmcnt(18) lgkmcnt(4)
    s_barrier
    v_mfma_f32_16x16x32_bf16 v[160:163], v[112:115], a[64:67], v[160:163]
    ds_read_b64_tr_b16 v[104:105], v72 offset:49152
    v_mfma_f32_16x16x32_bf16 v[160:163], v[116:119], a[80:83], v[160:163]
    buffer_load_dwordx4 v[4:7], v21, s[28:31], s3 offen offset:0
    v_mfma_f32_16x16x32_bf16 v[164:167], v[112:115], a[68:71], v[164:167]
    ds_read_b64_tr_b16 v[106:107], v72 offset:49664
    v_mfma_f32_16x16x32_bf16 v[164:167], v[116:119], a[84:87], v[164:167]
    buffer_load_dwordx4 v[8:11], v21, s[28:31], s3 offen offset:1024
    v_mfma_f32_16x16x32_bf16 v[168:171], v[112:115], a[72:75], v[168:171]
    ds_read_b64_tr_b16 v[108:109], v72 offset:53248
    v_mfma_f32_16x16x32_bf16 v[168:171], v[116:119], a[88:91], v[168:171]
    buffer_load_dwordx4 v[12:15], v21, s[60:63], 0 offen
    v_mfma_f32_16x16x32_bf16 v[172:175], v[112:115], a[76:79], v[172:175]
    ds_read_b64_tr_b16 v[110:111], v72 offset:53760
    s_lshr_b32 s3, s3, 8
    v_mfma_f32_16x16x32_bf16 v[172:175], v[116:119], a[92:95], v[172:175]
    s_waitcnt lgkmcnt(4)
    s_add_u32 s3, s3, 9764864
    s_add_u32 m0, s74, 114688
    v_mfma_f32_16x16x32_bf16 v[188:191], v[120:123], a[76:79], v[188:191]
    ds_read_b64_tr_b16 v[112:113], v73 offset:49152
    s_mul_i32 s78, s97, 128
    v_mfma_f32_16x16x32_bf16 v[188:191], v[124:127], a[92:95], v[188:191]
    s_add_u32 s78, s78, s73
    buffer_load_dwordx4 v36, s[28:31], s78 offen offset:0  lds
    v_mfma_f32_16x16x32_bf16 v[184:187], v[120:123], a[72:75], v[184:187]
    ds_read_b64_tr_b16 v[114:115], v73 offset:49664
    v_mfma_f32_16x16x32_bf16 v[184:187], v[124:127], a[88:91], v[184:187]
    buffer_load_dwordx4 v37, s[28:31], s78 offen offset:1024  lds
    v_mfma_f32_16x16x32_bf16 v[180:183], v[120:123], a[68:71], v[180:183]
    ds_read_b64_tr_b16 v[116:117], v73 offset:53248
    v_mfma_f32_16x16x32_bf16 v[180:183], v[124:127], a[84:87], v[180:183]
    buffer_load_dwordx4 v38, s[28:31], s78 offen offset:2048  lds
    v_mfma_f32_16x16x32_bf16 v[176:179], v[120:123], a[64:67], v[176:179]
    ds_read_b64_tr_b16 v[118:119], v73 offset:53760
    v_mfma_f32_16x16x32_bf16 v[176:179], v[124:127], a[80:83], v[176:179]
    s_waitcnt lgkmcnt(4)
    v_mfma_f32_16x16x32_bf16 v[192:195], v[104:107], a[0:3], 0
    ds_read_b64_tr_b16 v[120:121], v72 offset:57344
    v_mfma_f32_16x16x32_bf16 v[192:195], v[108:111], a[16:19], v[192:195]
    buffer_load_dwordx4 v39, s[28:31], s78 offen offset:3072  lds
    v_mfma_f32_16x16x32_bf16 v[196:199], v[104:107], a[4:7], 0
    ds_read_b64_tr_b16 v[122:123], v72 offset:57856
    s_add_u32 m0, s74, 98304
    v_mfma_f32_16x16x32_bf16 v[196:199], v[108:111], a[20:23], v[196:199]
    s_mul_i32 s78, s97, 229376
    s_add_u32 s78, s78, s75
    v_mfma_f32_16x16x32_bf16 v[200:203], v[104:107], a[8:11], 0
    ds_read_b64_tr_b16 v[124:125], v72 offset:61440
    v_mfma_f32_16x16x32_bf16 v[200:203], v[108:111], a[24:27], v[200:203]
    buffer_load_dwordx4 v40, s[36:39], s78 offen offset:0  lds
    v_mfma_f32_16x16x32_bf16 v[204:207], v[104:107], a[12:15], 0
    ds_read_b64_tr_b16 v[126:127], v72 offset:61952
    v_mfma_f32_16x16x32_bf16 v[204:207], v[108:111], a[28:31], v[204:207]
    s_waitcnt lgkmcnt(4)
    v_mfma_f32_16x16x32_bf16 v[220:223], v[112:115], a[12:15], 0
    ds_read_b64_tr_b16 v[104:105], v73 offset:57344
    v_mfma_f32_16x16x32_bf16 v[220:223], v[116:119], a[28:31], v[220:223]
    buffer_load_dwordx4 v41, s[36:39], s78 offen offset:1024  lds
    v_mfma_f32_16x16x32_bf16 v[216:219], v[112:115], a[8:11], 0
    ds_read_b64_tr_b16 v[106:107], v73 offset:57856
    v_mfma_f32_16x16x32_bf16 v[216:219], v[116:119], a[24:27], v[216:219]
    buffer_load_dwordx4 v42, s[36:39], s78 offen offset:2048  lds
    v_mfma_f32_16x16x32_bf16 v[212:215], v[112:115], a[4:7], 0
    ds_read_b64_tr_b16 v[108:109], v73 offset:61440
    v_mfma_f32_16x16x32_bf16 v[212:215], v[116:119], a[20:23], v[212:215]
    buffer_load_dwordx4 v43, s[36:39], s78 offen offset:3072  lds
    v_mfma_f32_16x16x32_bf16 v[208:211], v[112:115], a[0:3], 0
    ds_read_b64_tr_b16 v[110:111], v73 offset:61952
    s_add_u32 m0, s74, 0
    v_mfma_f32_16x16x32_bf16 v[208:211], v[116:119], a[16:19], v[208:211]
    s_waitcnt vmcnt(21) lgkmcnt(4)
    s_barrier
    s_mul_i32 s78, s93, 229376
    v_mfma_f32_16x16x32_bf16 v[224:227], v[120:123], a[0:3], 0
    ds_read_b128 a[96:99], v88 offset:32768
    s_add_u32 s78, s78, s76
    v_mfma_f32_16x16x32_bf16 v[224:227], v[124:127], a[16:19], v[224:227]
    ds_read_b128 a[100:103], v88 offset:34816
    buffer_load_dwordx4 v40, s[36:39], s78 offen offset:0  lds
    v_mfma_f32_16x16x32_bf16 v[228:231], v[120:123], a[4:7], 0
    ds_read_b128 a[104:107], v88 offset:36864
    v_mfma_f32_16x16x32_bf16 v[228:231], v[124:127], a[20:23], v[228:231]
    ds_read_b128 a[108:111], v88 offset:38912
    buffer_load_dwordx4 v41, s[36:39], s78 offen offset:1024  lds
    v_mfma_f32_16x16x32_bf16 v[232:235], v[120:123], a[8:11], 0
    ds_read_b64_tr_b16 v[112:113], v74 offset:0
    v_mfma_f32_16x16x32_bf16 v[232:235], v[124:127], a[24:27], v[232:235]
    ds_read_b64_tr_b16 v[114:115], v74 offset:512
    buffer_load_dwordx4 v42, s[36:39], s78 offen offset:2048  lds
    v_mfma_f32_16x16x32_bf16 v[236:239], v[120:123], a[12:15], 0
    ds_read_b64_tr_b16 v[116:117], v74 offset:4096
    v_mfma_f32_16x16x32_bf16 v[236:239], v[124:127], a[28:31], v[236:239]
    s_waitcnt lgkmcnt(7)
    ds_read_b64_tr_b16 v[118:119], v74 offset:4608
    v_mfma_f32_16x16x32_bf16 v[252:255], v[104:107], a[12:15], 0
    ds_read_b128 a[112:115], v89 offset:32768
    v_mfma_f32_16x16x32_bf16 v[252:255], v[108:111], a[28:31], v[252:255]
    ds_read_b128 a[116:119], v89 offset:34816
    buffer_load_dwordx4 v43, s[36:39], s78 offen offset:3072  lds
    v_mfma_f32_16x16x32_bf16 v[248:251], v[104:107], a[8:11], 0
    ds_read_b128 a[120:123], v89 offset:36864
    s_add_u32 m0, s74, 131072
    v_mfma_f32_16x16x32_bf16 v[248:251], v[108:111], a[24:27], v[248:251]
    ds_read_b128 a[124:127], v89 offset:38912
    s_mul_i32 s78, s98, 128
    v_mfma_f32_16x16x32_bf16 v[244:247], v[104:107], a[4:7], 0
    ds_read_b64_tr_b16 v[120:121], v75 offset:0
    s_add_u32 s78, s78, s73
    v_mfma_f32_16x16x32_bf16 v[244:247], v[108:111], a[20:23], v[244:247]
    ds_read_b64_tr_b16 v[122:123], v75 offset:512
    v_mov_b32 v25, 0
    v_mfma_f32_16x16x32_bf16 v[240:243], v[104:107], a[0:3], 0
    ds_read_b64_tr_b16 v[124:125], v75 offset:4096
    v_mov_b32 v16, 0
    v_mfma_f32_16x16x32_bf16 v[240:243], v[108:111], a[16:19], v[240:243]
    s_waitcnt lgkmcnt(3)
    ds_read_b64_tr_b16 v[126:127], v75 offset:4608
    v_mfma_f32_16x16x32_bf16 v[128:131], v[112:115], a[96:99], v[128:131]
    ds_read_b64_tr_b16 v[104:105], v74 offset:8192
    s_waitcnt vmcnt(12)
    v_lshlrev_b32 v29, 16, v12
    v_mfma_f32_16x16x32_bf16 v[128:131], v[116:119], a[112:115], v[128:131]
    v_and_b32 v12, 0xffff0000, v12
    v_lshlrev_b32 v28, 16, v4
    v_mfma_f32_16x16x32_bf16 v[132:135], v[112:115], a[100:103], v[132:135]
    ds_read_b64_tr_b16 v[106:107], v74 offset:8704
    v_and_b32 v4, 0xffff0000, v4
    v_mfma_f32_16x16x32_bf16 v[132:135], v[116:119], a[116:119], v[132:135]
    v_fmac_f32 v25, v28, v29
    v_fmac_f32 v25, v4, v12
    v_mfma_f32_16x16x32_bf16 v[136:139], v[112:115], a[104:107], v[136:139]
    ds_read_b64_tr_b16 v[108:109], v74 offset:12288
    v_lshlrev_b32 v28, 16, v8
    v_mfma_f32_16x16x32_bf16 v[136:139], v[116:119], a[120:123], v[136:139]
    v_and_b32 v8, 0xffff0000, v8
    v_fmac_f32 v16, v28, v29
    v_mfma_f32_16x16x32_bf16 v[140:143], v[112:115], a[108:111], v[140:143]
    ds_read_b64_tr_b16 v[110:111], v74 offset:12800
    v_fmac_f32 v16, v8, v12
    v_mfma_f32_16x16x32_bf16 v[140:143], v[116:119], a[124:127], v[140:143]
    s_waitcnt lgkmcnt(4)
    v_lshlrev_b32 v29, 16, v13
    v_and_b32 v13, 0xffff0000, v13
    v_mfma_f32_16x16x32_bf16 v[156:159], v[120:123], a[108:111], v[156:159]
    ds_read_b64_tr_b16 v[112:113], v75 offset:8192
    v_lshlrev_b32 v28, 16, v5
    v_mfma_f32_16x16x32_bf16 v[156:159], v[124:127], a[124:127], v[156:159]
    v_and_b32 v5, 0xffff0000, v5
    v_fmac_f32 v25, v28, v29
    v_mfma_f32_16x16x32_bf16 v[152:155], v[120:123], a[104:107], v[152:155]
LA_pg1:
    s_cbranch_execz LA_pg5
    ds_read_b64_tr_b16 v[114:115], v75 offset:8704
    v_fmac_f32 v25, v5, v13
    v_mfma_f32_16x16x32_bf16 v[152:155], v[124:127], a[120:123], v[152:155]
    v_lshlrev_b32 v28, 16, v9
    v_and_b32 v9, 0xffff0000, v9
    v_mfma_f32_16x16x32_bf16 v[148:151], v[120:123], a[100:103], v[148:151]
    ds_read_b64_tr_b16 v[116:117], v75 offset:12288
    v_fmac_f32 v16, v28, v29
    v_mfma_f32_16x16x32_bf16 v[148:151], v[124:127], a[116:119], v[148:151]
    v_fmac_f32 v16, v9, v13
    v_lshlrev_b32 v29, 16, v14
    v_mfma_f32_16x16x32_bf16 v[144:147], v[120:123], a[96:99], v[144:147]
    ds_read_b64_tr_b16 v[118:119], v75 offset:12800
    v_and_b32 v14, 0xffff0000, v14
    v_mfma_f32_16x16x32_bf16 v[144:147], v[124:127], a[112:115], v[144:147]
    s_waitcnt lgkmcnt(4)
    s_barrier
    v_lshlrev_b32 v28, 16, v6
    v_mfma_f32_16x16x32_bf16 v[160:163], v[104:107], a[96:99], v[160:163]
    ds_read_b128 a[128:131], v88 offset:49152
    v_and_b32 v6, 0xffff0000, v6
    v_mfma_f32_16x16x32_bf16 v[160:163], v[108:111], a[112:115], v[160:163]
    ds_read_b128 a[132:135], v88 offset:51200
    buffer_load_dwordx4 v36, s[28:31], s78 offen offset:0  lds
    v_mfma_f32_16x16x32_bf16 v[164:167], v[104:107], a[100:103], v[164:167]
    ds_read_b128 a[136:139], v88 offset:53248
    v_fmac_f32 v25, v28, v29
    v_mfma_f32_16x16x32_bf16 v[164:167], v[108:111], a[116:119], v[164:167]
    ds_read_b128 a[140:143], v88 offset:55296
    buffer_load_dwordx4 v37, s[28:31], s78 offen offset:1024  lds
    v_mfma_f32_16x16x32_bf16 v[168:171], v[104:107], a[104:107], v[168:171]
    ds_read_b64_tr_b16 v[120:121], v74 offset:16384
    v_fmac_f32 v25, v6, v14
    v_mfma_f32_16x16x32_bf16 v[168:171], v[108:111], a[120:123], v[168:171]
    ds_read_b64_tr_b16 v[122:123], v74 offset:16896
    buffer_load_dwordx4 v38, s[28:31], s78 offen offset:2048  lds
    v_mfma_f32_16x16x32_bf16 v[172:175], v[104:107], a[108:111], v[172:175]
    ds_read_b64_tr_b16 v[124:125], v74 offset:20480
    v_lshlrev_b32 v28, 16, v10
    v_mfma_f32_16x16x32_bf16 v[172:175], v[108:111], a[124:127], v[172:175]
    s_waitcnt lgkmcnt(7)
    ds_read_b64_tr_b16 v[126:127], v74 offset:20992
    v_mfma_f32_16x16x32_bf16 v[188:191], v[112:115], a[108:111], v[188:191]
    ds_read_b128 a[144:147], v89 offset:49152
    v_and_b32 v10, 0xffff0000, v10
    v_mfma_f32_16x16x32_bf16 v[188:191], v[116:119], a[124:127], v[188:191]
    ds_read_b128 a[148:151], v89 offset:51200
    buffer_load_dwordx4 v39, s[28:31], s78 offen offset:3072  lds
    v_mfma_f32_16x16x32_bf16 v[184:187], v[112:115], a[104:107], v[184:187]
    ds_read_b128 a[152:155], v89 offset:53248
    s_add_u32 m0, s74, 16384
    v_mfma_f32_16x16x32_bf16 v[184:187], v[116:119], a[120:123], v[184:187]
    ds_read_b128 a[156:159], v89 offset:55296
    s_mul_i32 s78, s98, 229376
    s_add_u32 s78, s78, s75
    buffer_load_dwordx4 v40, s[36:39], s78 offen offset:0  lds
    v_mfma_f32_16x16x32_bf16 v[180:183], v[112:115], a[100:103], v[180:183]
    ds_read_b64_tr_b16 v[104:105], v75 offset:16384
    v_fmac_f32 v16, v28, v29
    v_mfma_f32_16x16x32_bf16 v[180:183], v[116:119], a[116:119], v[180:183]
    ds_read_b64_tr_b16 v[106:107], v75 offset:16896
    buffer_load_dwordx4 v41, s[36:39], s78 offen offset:1024  lds
    v_mfma_f32_16x16x32_bf16 v[176:179], v[112:115], a[96:99], v[176:179]
    ds_read_b64_tr_b16 v[108:109], v75 offset:20480
    v_fmac_f32 v16, v10, v14
    v_mfma_f32_16x16x32_bf16 v[176:179], v[116:119], a[112:115], v[176:179]
    s_waitcnt lgkmcnt(3)
    ds_read_b64_tr_b16 v[110:111], v75 offset:20992
    v_mfma_f32_16x16x32_bf16 v[128:131], v[120:123], a[128:131], v[128:131]
    ds_read_b64_tr_b16 v[112:113], v74 offset:24576
    v_lshlrev_b32 v29, 16, v15
    v_mfma_f32_16x16x32_bf16 v[128:131], v[124:127], a[144:147], v[128:131]
    buffer_load_dwordx4 v42, s[36:39], s78 offen offset:2048  lds
    v_mfma_f32_16x16x32_bf16 v[132:135], v[120:123], a[132:135], v[132:135]
    ds_read_b64_tr_b16 v[114:115], v74 offset:25088
    v_and_b32 v15, 0xffff0000, v15
    v_mfma_f32_16x16x32_bf16 v[132:135], v[124:127], a[148:151], v[132:135]
    buffer_load_dwordx4 v43, s[36:39], s78 offen offset:3072  lds
    v_mfma_f32_16x16x32_bf16 v[136:139], v[120:123], a[136:139], v[136:139]
    ds_read_b64_tr_b16 v[116:117], v74 offset:28672
    s_add_u32 m0, s74, 147456
    v_mfma_f32_16x16x32_bf16 v[136:139], v[124:127], a[152:155], v[136:139]
    s_mul_i32 s78, s99, 128
    s_add_u32 s78, s78, s73
    v_lshlrev_b32 v28, 16, v7
    v_mfma_f32_16x16x32_bf16 v[140:143], v[120:123], a[140:143], v[140:143]
    ds_read_b64_tr_b16 v[118:119], v74 offset:29184
    v_and_b32 v7, 0xffff0000, v7
    v_mfma_f32_16x16x32_bf16 v[140:143], v[124:127], a[156:159], v[140:143]
    s_waitcnt lgkmcnt(4)
    v_fmac_f32 v25, v28, v29
    v_fmac_f32 v25, v7, v15
    v_mfma_f32_16x16x32_bf16 v[156:159], v[104:107], a[140:143], v[156:159]
    ds_read_b64_tr_b16 v[120:121], v75 offset:24576
    v_lshlrev_b32 v28, 16, v11
    v_mfma_f32_16x16x32_bf16 v[156:159], v[108:111], a[156:159], v[156:159]
    v_and_b32 v11, 0xffff0000, v11
    v_fmac_f32 v16, v28, v29
    v_mfma_f32_16x16x32_bf16 v[152:155], v[104:107], a[136:139], v[152:155]
    ds_read_b64_tr_b16 v[122:123], v75 offset:25088
    v_fmac_f32 v16, v11, v15
    v_mfma_f32_16x16x32_bf16 v[152:155], v[108:111], a[152:155], v[152:155]
    v_mfma_f32_16x16x32_bf16 v[148:151], v[104:107], a[132:135], v[148:151]
    ds_read_b64_tr_b16 v[124:125], v75 offset:28672
    v_mfma_f32_16x16x32_bf16 v[148:151], v[108:111], a[148:151], v[148:151]
    v_permlane32_swap_b32 v25, v16
    v_add_f32 v25, v25, v16
    v_mfma_f32_16x16x32_bf16 v[144:147], v[104:107], a[128:131], v[144:147]
    ds_read_b64_tr_b16 v[126:127], v75 offset:29184
    v_mfma_f32_16x16x32_bf16 v[144:147], v[108:111], a[144:147], v[144:147]
    s_waitcnt vmcnt(12) lgkmcnt(4)
    s_barrier
    v_add_f32_dpp v25, v25, v25 row_ror:8 row_mask:0xf bank_mask:0xf
    v_mfma_f32_16x16x32_bf16 v[160:163], v[112:115], a[128:131], v[160:163]
    ds_read_b128 a[160:163], v88 offset:16384
    v_mfma_f32_16x16x32_bf16 v[160:163], v[116:119], a[144:147], v[160:163]
    ds_read_b128 a[164:167], v88 offset:18432
    buffer_load_dwordx4 v36, s[28:31], s78 offen offset:0  lds
    v_mfma_f32_16x16x32_bf16 v[164:167], v[112:115], a[132:135], v[164:167]
    ds_read_b128 a[168:171], v88 offset:20480
    v_add_f32_dpp v25, v25, v25 row_ror:4 row_mask:0xf bank_mask:0xf
    v_mfma_f32_16x16x32_bf16 v[164:167], v[116:119], a[148:151], v[164:167]
    ds_read_b128 a[172:175], v88 offset:22528
    buffer_load_dwordx4 v37, s[28:31], s78 offen offset:1024  lds
    v_mfma_f32_16x16x32_bf16 v[168:171], v[112:115], a[136:139], v[168:171]
    ds_read_b64_tr_b16 v[104:105], v74 offset:32768
    v_add_f32_dpp v25, v25, v25 row_ror:2 row_mask:0xf bank_mask:0xf
    v_mfma_f32_16x16x32_bf16 v[168:171], v[116:119], a[152:155], v[168:171]
    ds_read_b64_tr_b16 v[106:107], v74 offset:33280
    buffer_load_dwordx4 v38, s[28:31], s78 offen offset:2048  lds
    v_mfma_f32_16x16x32_bf16 v[172:175], v[112:115], a[140:143], v[172:175]
    ds_read_b64_tr_b16 v[108:109], v74 offset:36864
    v_add_f32_dpp v25, v25, v25 row_ror:1 row_mask:0xf bank_mask:0xf
    v_mfma_f32_16x16x32_bf16 v[172:175], v[116:119], a[156:159], v[172:175]
    s_waitcnt lgkmcnt(7)
    ds_read_b64_tr_b16 v[110:111], v74 offset:37376
    v_mfma_f32_16x16x32_bf16 v[188:191], v[120:123], a[140:143], v[188:191]
    ds_read_b128 a[176:179], v89 offset:16384
    v_mov_b32 v4, v25
    v_mfma_f32_16x16x32_bf16 v[188:191], v[124:127], a[156:159], v[188:191]
    ds_read_b128 a[180:183], v89 offset:18432
    buffer_load_dwordx4 v39, s[28:31], s78 offen offset:3072  lds
    v_mfma_f32_16x16x32_bf16 v[184:187], v[120:123], a[136:139], v[184:187]
    ds_read_b128 a[184:187], v89 offset:20480
    s_add_u32 m0, s74, 32768
    v_mfma_f32_16x16x32_bf16 v[184:187], v[124:127], a[152:155], v[184:187]
    ds_read_b128 a[188:191], v89 offset:22528
    s_mul_i32 s78, s99, 229376
    s_add_u32 s78, s78, s75
    buffer_load_dwordx4 v40, s[36:39], s78 offen offset:0  lds
    v_mfma_f32_16x16x32_bf16 v[180:183], v[120:123], a[132:135], v[180:183]
    ds_read_b64_tr_b16 v[112:113], v75 offset:32768
    v_permlane16_swap_b32 v25, v4
    v_mfma_f32_16x16x32_bf16 v[180:183], v[124:127], a[148:151], v[180:183]
    ds_read_b64_tr_b16 v[114:115], v75 offset:33280
    buffer_load_dwordx4 v41, s[36:39], s78 offen offset:1024  lds
    v_mfma_f32_16x16x32_bf16 v[176:179], v[120:123], a[128:131], v[176:179]
    ds_read_b64_tr_b16 v[116:117], v75 offset:36864
    v_add_f32 v25, v25, v4
    v_mfma_f32_16x16x32_bf16 v[176:179], v[124:127], a[144:147], v[176:179]
    s_waitcnt lgkmcnt(3)
    ds_read_b64_tr_b16 v[118:119], v75 offset:37376
    v_mfma_f32_16x16x32_bf16 v[128:131], v[104:107], a[160:163], v[128:131]
    ds_read_b64_tr_b16 v[120:121], v74 offset:40960
    v_mul_f32 v25, 0xbfb8aa3b, v25
    v_mfma_f32_16x16x32_bf16 v[128:131], v[108:111], a[176:179], v[128:131]
    buffer_load_dwordx4 v42, s[36:39], s78 offen offset:2048  lds
    v_mfma_f32_16x16x32_bf16 v[132:135], v[104:107], a[164:167], v[132:135]
    ds_read_b64_tr_b16 v[122:123], v74 offset:41472
    v_mfma_f32_16x16x32_bf16 v[132:135], v[108:111], a[180:183], v[132:135]
    buffer_load_dwordx4 v43, s[36:39], s78 offen offset:3072  lds
    s_mov_b32 s67, 0
    s_load_dword s67, s[56:57], 0
    v_mfma_f32_16x16x32_bf16 v[136:139], v[104:107], a[168:171], v[136:139]
    ds_read_b64_tr_b16 v[124:125], v74 offset:45056
    s_add_u32 m0, s74, 49152
    v_mfma_f32_16x16x32_bf16 v[136:139], v[108:111], a[184:187], v[136:139]
    s_mul_i32 s78, s94, 229376
    s_add_u32 s78, s78, s76
    buffer_load_dwordx4 v40, s[36:39], s78 offen offset:0  lds
    v_mfma_f32_16x16x32_bf16 v[140:143], v[104:107], a[172:175], v[140:143]
    ds_read_b64_tr_b16 v[126:127], v74 offset:45568
    v_mfma_f32_16x16x32_bf16 v[140:143], v[108:111], a[188:191], v[140:143]
    s_waitcnt lgkmcnt(4)
    v_exp_f32 v25, v25
    v_mfma_f32_16x16x32_bf16 v[156:159], v[112:115], a[172:175], v[156:159]
    ds_read_b64_tr_b16 v[104:105], v75 offset:40960
    v_mfma_f32_16x16x32_bf16 v[156:159], v[116:119], a[188:191], v[156:159]
    buffer_load_dwordx4 v41, s[36:39], s78 offen offset:1024  lds
    v_mfma_f32_16x16x32_bf16 v[152:155], v[112:115], a[168:171], v[152:155]
    ds_read_b64_tr_b16 v[106:107], v75 offset:41472
    v_add_f32 v25, 1.0, v25
    v_mfma_f32_16x16x32_bf16 v[152:155], v[116:119], a[184:187], v[152:155]
    v_mfma_f32_16x16x32_bf16 v[148:151], v[112:115], a[164:167], v[148:151]
    ds_read_b64_tr_b16 v[108:109], v75 offset:45056
    v_mfma_f32_16x16x32_bf16 v[148:151], v[116:119], a[180:183], v[148:151]
    buffer_load_dwordx4 v42, s[36:39], s78 offen offset:2048  lds
    v_mfma_f32_16x16x32_bf16 v[144:147], v[112:115], a[160:163], v[144:147]
    ds_read_b64_tr_b16 v[110:111], v75 offset:45568
    v_mfma_f32_16x16x32_bf16 v[144:147], v[116:119], a[176:179], v[144:147]
    s_waitcnt vmcnt(19) lgkmcnt(4)
    s_barrier
    v_mfma_f32_16x16x32_bf16 v[160:163], v[120:123], a[160:163], v[160:163]
    ds_read_b64_tr_b16 v[112:113], v72 offset:0
    v_mfma_f32_16x16x32_bf16 v[160:163], v[124:127], a[176:179], v[160:163]
    buffer_load_dwordx4 v43, s[36:39], s78 offen offset:3072  lds
    v_mfma_f32_16x16x32_bf16 v[164:167], v[120:123], a[164:167], v[164:167]
    ds_read_b64_tr_b16 v[114:115], v72 offset:512
    s_add_u32 m0, s74, 65536
    v_mfma_f32_16x16x32_bf16 v[164:167], v[124:127], a[180:183], v[164:167]
    s_mul_i32 s78, s95, 229376
    s_add_u32 s78, s78, s76
    v_mfma_f32_16x16x32_bf16 v[168:171], v[120:123], a[168:171], v[168:171]
    ds_read_b64_tr_b16 v[116:117], v72 offset:4096
    v_mfma_f32_16x16x32_bf16 v[168:171], v[124:127], a[184:187], v[168:171]
    buffer_load_dwordx4 v40, s[36:39], s78 offen offset:0  lds
    v_mfma_f32_16x16x32_bf16 v[172:175], v[120:123], a[172:175], v[172:175]
    ds_read_b64_tr_b16 v[118:119], v72 offset:4608
    v_mfma_f32_16x16x32_bf16 v[172:175], v[124:127], a[188:191], v[172:175]
    s_waitcnt lgkmcnt(4)
    v_rcp_f32 v25, v25
    v_mfma_f32_16x16x32_bf16 v[188:191], v[104:107], a[172:175], v[188:191]
    ds_read_b64_tr_b16 v[120:121], v73 offset:0
    v_mfma_f32_16x16x32_bf16 v[188:191], v[108:111], a[188:191], v[188:191]
    buffer_load_dwordx4 v41, s[36:39], s78 offen offset:1024  lds
    v_mfma_f32_16x16x32_bf16 v[184:187], v[104:107], a[168:171], v[184:187]
    ds_read_b64_tr_b16 v[122:123], v73 offset:512
    v_mfma_f32_16x16x32_bf16 v[184:187], v[108:111], a[184:187], v[184:187]
    v_mfma_f32_16x16x32_bf16 v[180:183], v[104:107], a[164:167], v[180:183]
    ds_read_b64_tr_b16 v[124:125], v73 offset:4096
    v_mfma_f32_16x16x32_bf16 v[180:183], v[108:111], a[180:183], v[180:183]
    buffer_load_dwordx4 v42, s[36:39], s78 offen offset:2048  lds
    v_mfma_f32_16x16x32_bf16 v[176:179], v[104:107], a[160:163], v[176:179]
    ds_read_b64_tr_b16 v[126:127], v73 offset:4608
    v_mfma_f32_16x16x32_bf16 v[176:179], v[108:111], a[176:179], v[176:179]
    s_waitcnt lgkmcnt(4)
    v_mfma_f32_16x16x32_bf16 v[192:195], v[112:115], a[32:35], v[192:195]
    ds_read_b64_tr_b16 v[104:105], v72 offset:8192
    v_mfma_f32_16x16x32_bf16 v[192:195], v[116:119], a[48:51], v[192:195]
    buffer_load_dwordx4 v43, s[36:39], s78 offen offset:3072  lds
    v_mfma_f32_16x16x32_bf16 v[196:199], v[112:115], a[36:39], v[196:199]
    ds_read_b64_tr_b16 v[106:107], v72 offset:8704
    s_add_u32 m0, s74, 81920
    v_mfma_f32_16x16x32_bf16 v[196:199], v[116:119], a[52:55], v[196:199]
    s_mul_i32 s78, s96, 229376
    s_add_u32 s78, s78, s76
    v_mfma_f32_16x16x32_bf16 v[200:203], v[112:115], a[40:43], v[200:203]
    ds_read_b64_tr_b16 v[108:109], v72 offset:12288
    v_mfma_f32_16x16x32_bf16 v[200:203], v[116:119], a[56:59], v[200:203]
    buffer_load_dwordx4 v40, s[36:39], s78 offen offset:0  lds
    v_mfma_f32_16x16x32_bf16 v[204:207], v[112:115], a[44:47], v[204:207]
    ds_read_b64_tr_b16 v[110:111], v72 offset:12800
    v_mfma_f32_16x16x32_bf16 v[204:207], v[116:119], a[60:63], v[204:207]
    s_waitcnt lgkmcnt(4)
    v_mfma_f32_16x16x32_bf16 v[220:223], v[120:123], a[44:47], v[220:223]
    ds_read_b64_tr_b16 v[112:113], v73 offset:8192
    v_mfma_f32_16x16x32_bf16 v[220:223], v[124:127], a[60:63], v[220:223]
    buffer_load_dwordx4 v41, s[36:39], s78 offen offset:1024  lds
    v_mfma_f32_16x16x32_bf16 v[216:219], v[120:123], a[40:43], v[216:219]
    ds_read_b64_tr_b16 v[114:115], v73 offset:8704
    v_mfma_f32_16x16x32_bf16 v[216:219], v[124:127], a[56:59], v[216:219]
    v_mfma_f32_16x16x32_bf16 v[212:215], v[120:123], a[36:39], v[212:215]
    ds_read_b64_tr_b16 v[116:117], v73 offset:12288
    v_mfma_f32_16x16x32_bf16 v[212:215], v[124:127], a[52:55], v[212:215]
    buffer_load_dwordx4 v42, s[36:39], s78 offen offset:2048  lds
    v_mfma_f32_16x16x32_bf16 v[208:211], v[120:123], a[32:35], v[208:211]
    ds_read_b64_tr_b16 v[118:119], v73 offset:12800
    v_mfma_f32_16x16x32_bf16 v[208:211], v[124:127], a[48:51], v[208:211]
    s_waitcnt vmcnt(19) lgkmcnt(4)
    s_barrier
    v_mfma_f32_16x16x32_bf16 v[224:227], v[104:107], a[32:35], v[224:227]
    ds_read_b128 a[192:195], v88 offset:32768
    v_mfma_f32_16x16x32_bf16 v[224:227], v[108:111], a[48:51], v[224:227]
    ds_read_b128 a[196:199], v88 offset:34816
    buffer_load_dwordx4 v43, s[36:39], s78 offen offset:3072  lds
    v_mfma_f32_16x16x32_bf16 v[228:231], v[104:107], a[36:39], v[228:231]
    ds_read_b128 a[200:203], v88 offset:36864
    s_add_u32 m0, s74, 114688
    v_mfma_f32_16x16x32_bf16 v[228:231], v[108:111], a[52:55], v[228:231]
    ds_read_b128 a[204:207], v88 offset:38912
    s_mul_i32 s78, s97, 229376
    v_mfma_f32_16x16x32_bf16 v[232:235], v[104:107], a[40:43], v[232:235]
    ds_read_b64_tr_b16 v[120:121], v72 offset:16384
    s_add_u32 s78, s78, s76
    v_mfma_f32_16x16x32_bf16 v[232:235], v[108:111], a[56:59], v[232:235]
    ds_read_b64_tr_b16 v[122:123], v72 offset:16896
    s_cmp_ge_u32 s67, 1
    s_cbranch_scc0 LA_slow0
LA_back0:
    v_mfma_f32_16x16x32_bf16 v[236:239], v[104:107], a[44:47], v[236:239]
    ds_read_b64_tr_b16 v[124:125], v72 offset:20480
    v_mfma_f32_16x16x32_bf16 v[236:239], v[108:111], a[60:63], v[236:239]
    s_waitcnt lgkmcnt(7)
    ds_read_b64_tr_b16 v[126:127], v72 offset:20992
    v_mfma_f32_16x16x32_bf16 v[252:255], v[112:115], a[44:47], v[252:255]
    ds_read_b128 a[208:211], v89 offset:32768
    v_mfma_f32_16x16x32_bf16 v[252:255], v[116:119], a[60:63], v[252:255]
    ds_read_b128 a[212:215], v89 offset:34816
    buffer_load_dwordx4 v40, s[36:39], s78 offen offset:0  lds
    v_mfma_f32_16x16x32_bf16 v[248:251], v[112:115], a[40:43], v[248:251]
    ds_read_b128 a[216:219], v89 offset:36864
    v_mfma_f32_16x16x32_bf16 v[248:251], v[116:119], a[56:59], v[248:251]
    ds_read_b128 a[220:223], v89 offset:38912
    v_mfma_f32_16x16x32_bf16 v[244:247], v[112:115], a[36:39], v[244:247]
    ds_read_b64_tr_b16 v[104:105], v73 offset:16384
    v_mfma_f32_16x16x32_bf16 v[244:247], v[116:119], a[52:55], v[244:247]
    ds_read_b64_tr_b16 v[106:107], v73 offset:16896
    buffer_load_dwordx4 v41, s[36:39], s78 offen offset:1024  lds
    v_mfma_f32_16x16x32_bf16 v[240:243], v[112:115], a[32:35], v[240:243]
    ds_read_b64_tr_b16 v[108:109], v73 offset:20480
    v_mfma_f32_16x16x32_bf16 v[240:243], v[116:119], a[48:51], v[240:243]
    s_waitcnt lgkmcnt(3)
    ds_read_b64_tr_b16 v[110:111], v73 offset:20992
    v_mfma_f32_16x16x32_bf16 v[128:131], v[120:123], a[192:195], v[128:131]
    ds_read_b64_tr_b16 v[112:113], v72 offset:24576
    v_mfma_f32_16x16x32_bf16 v[128:131], v[124:127], a[208:211], v[128:131]
    buffer_load_dwordx4 v42, s[36:39], s78 offen offset:2048  lds
    v_mfma_f32_16x16x32_bf16 v[132:135], v[120:123], a[196:199], v[132:135]
    ds_read_b64_tr_b16 v[114:115], v72 offset:25088
    v_mfma_f32_16x16x32_bf16 v[132:135], v[124:127], a[212:215], v[132:135]
    buffer_load_dwordx4 v43, s[36:39], s78 offen offset:3072  lds
    v_mfma_f32_16x16x32_bf16 v[136:139], v[120:123], a[200:203], v[136:139]
    ds_read_b64_tr_b16 v[116:117], v72 offset:28672
    s_add_u32 m0, s74, 98304
    v_mfma_f32_16x16x32_bf16 v[136:139], v[124:127], a[216:219], v[136:139]
    s_mul_i32 s78, s98, 229376
    s_add_u32 s78, s78, s76
    buffer_load_dwordx4 v40, s[36:39], s78 offen offset:0  lds
    v_mfma_f32_16x16x32_bf16 v[140:143], v[120:123], a[204:207], v[140:143]
    ds_read_b64_tr_b16 v[118:119], v72 offset:29184
    v_mfma_f32_16x16x32_bf16 v[140:143], v[124:127], a[220:223], v[140:143]
    s_waitcnt lgkmcnt(4)
    v_mfma_f32_16x16x32_bf16 v[156:159], v[104:107], a[204:207], v[156:159]
    ds_read_b64_tr_b16 v[120:121], v73 offset:24576
    v_mfma_f32_16x16x32_bf16 v[156:159], v[108:111], a[220:223], v[156:159]
    buffer_load_dwordx4 v41, s[36:39], s78 offen offset:1024  lds
    v_mfma_f32_16x16x32_bf16 v[152:155], v[104:107], a[200:203], v[152:155]
    ds_read_b64_tr_b16 v[122:123], v73 offset:25088
    v_mfma_f32_16x16x32_bf16 v[152:155], v[108:111], a[216:219], v[152:155]
    v_mfma_f32_16x16x32_bf16 v[148:151], v[104:107], a[196:199], v[148:151]
    ds_read_b64_tr_b16 v[124:125], v73 offset:28672
    v_mfma_f32_16x16x32_bf16 v[148:151], v[108:111], a[212:215], v[148:151]
    buffer_load_dwordx4 v42, s[36:39], s78 offen offset:2048  lds
    v_mfma_f32_16x16x32_bf16 v[144:147], v[104:107], a[192:195], v[144:147]
    ds_read_b64_tr_b16 v[126:127], v73 offset:29184
    v_mfma_f32_16x16x32_bf16 v[144:147], v[108:111], a[208:211], v[144:147]
    s_waitcnt vmcnt(19) lgkmcnt(4)
    s_barrier
    v_mfma_f32_16x16x32_bf16 v[160:163], v[112:115], a[192:195], v[160:163]
    ds_read_b128 a[224:227], v88 offset:49152
    v_mfma_f32_16x16x32_bf16 v[160:163], v[116:119], a[208:211], v[160:163]
    ds_read_b128 a[228:231], v88 offset:51200
    buffer_load_dwordx4 v43, s[36:39], s78 offen offset:3072  lds
    v_mfma_f32_16x16x32_bf16 v[164:167], v[112:115], a[196:199], v[164:167]
    ds_read_b128 a[232:235], v88 offset:53248
    s_add_u32 m0, s74, 0
    v_mfma_f32_16x16x32_bf16 v[164:167], v[116:119], a[212:215], v[164:167]
    ds_read_b128 a[236:239], v88 offset:55296
    s_mul_i32 s78, s99, 229376
    v_mfma_f32_16x16x32_bf16 v[168:171], v[112:115], a[200:203], v[168:171]
    ds_read_b64_tr_b16 v[104:105], v72 offset:32768
    s_add_u32 s78, s78, s76
    v_mfma_f32_16x16x32_bf16 v[168:171], v[116:119], a[216:219], v[168:171]
    ds_read_b64_tr_b16 v[106:107], v72 offset:33280
    buffer_load_dwordx4 v40, s[36:39], s78 offen offset:0  lds
    v_mfma_f32_16x16x32_bf16 v[172:175], v[112:115], a[204:207], v[172:175]
    ds_read_b64_tr_b16 v[108:109], v72 offset:36864
    v_mfma_f32_16x16x32_bf16 v[172:175], v[116:119], a[220:223], v[172:175]
    s_waitcnt lgkmcnt(7)
    ds_read_b64_tr_b16 v[110:111], v72 offset:37376
    v_mfma_f32_16x16x32_bf16 v[188:191], v[120:123], a[204:207], v[188:191]
    ds_read_b128 a[240:243], v89 offset:49152
    v_mfma_f32_16x16x32_bf16 v[188:191], v[124:127], a[220:223], v[188:191]
    ds_read_b128 a[244:247], v89 offset:51200
    buffer_load_dwordx4 v41, s[36:39], s78 offen offset:1024  lds
    v_mfma_f32_16x16x32_bf16 v[184:187], v[120:123], a[200:203], v[184:187]
    ds_read_b128 a[248:251], v89 offset:53248
    v_mfma_f32_16x16x32_bf16 v[184:187], v[124:127], a[216:219], v[184:187]
    ds_read_b128 a[252:255], v89 offset:55296
    v_mfma_f32_16x16x32_bf16 v[180:183], v[120:123], a[196:199], v[180:183]
    ds_read_b64_tr_b16 v[112:113], v73 offset:32768
    v_mfma_f32_16x16x32_bf16 v[180:183], v[124:127], a[212:215], v[180:183]
    ds_read_b64_tr_b16 v[114:115], v73 offset:33280
    buffer_load_dwordx4 v42, s[36:39], s78 offen offset:2048  lds
    v_mfma_f32_16x16x32_bf16 v[176:179], v[120:123], a[192:195], v[176:179]
    ds_read_b64_tr_b16 v[116:117], v73 offset:36864
    v_mfma_f32_16x16x32_bf16 v[176:179], v[124:127], a[208:211], v[176:179]
    s_waitcnt lgkmcnt(3)
    ds_read_b64_tr_b16 v[118:119], v73 offset:37376
    v_mfma_f32_16x16x32_bf16 v[128:131], v[104:107], a[224:227], v[128:131]
    ds_read_b64_tr_b16 v[120:121], v72 offset:40960
    v_add_u32 v88, 0x20000, v80
    v_mfma_f32_16x16x32_bf16 v[128:131], v[108:111], a[240:243], v[128:131]
    buffer_load_dwordx4 v43, s[36:39], s78 offen offset:3072  lds
    v_mfma_f32_16x16x32_bf16 v[132:135], v[104:107], a[228:231], v[132:135]
    ds_read_b64_tr_b16 v[122:123], v72 offset:41472
    s_add_u32 m0, s74, 16384
    v_mfma_f32_16x16x32_bf16 v[132:135], v[108:111], a[244:247], v[132:135]
    s_mul_i32 s78, s24, 196608
    s_add_u32 s78, s78, s77
    v_add_u32 v89, 0x20000, v81
    v_mfma_f32_16x16x32_bf16 v[136:139], v[104:107], a[232:235], v[136:139]
    ds_read_b64_tr_b16 v[124:125], v72 offset:45056
    v_add_u32 v90, 0x20000, v82
    v_mfma_f32_16x16x32_bf16 v[136:139], v[108:111], a[248:251], v[136:139]
    v_add_u32 v91, 0x20000, v83
    v_mfma_f32_16x16x32_bf16 v[140:143], v[104:107], a[236:239], v[140:143]
    ds_read_b64_tr_b16 v[126:127], v72 offset:45568
    s_lshl_b32 s86, s72, 1
    v_mfma_f32_16x16x32_bf16 v[140:143], v[108:111], a[252:255], v[140:143]
    s_waitcnt lgkmcnt(4)
    s_add_u32 s86, s86, s66
    s_add_u32 s86, s86, 0
    v_mfma_f32_16x16x32_bf16 v[156:159], v[112:115], a[236:239], v[156:159]
    ds_read_b64_tr_b16 v[104:105], v73 offset:40960
    s_lshl_b32 s86, s86, 12
    v_mfma_f32_16x16x32_bf16 v[156:159], v[116:119], a[252:255], v[156:159]
    s_add_u32 s86, s86, s85
    v_max_f32 v128, 0, v128
    v_max_f32 v129, 0, v129
    v_mfma_f32_16x16x32_bf16 v[152:155], v[112:115], a[232:235], v[152:155]
    ds_read_b64_tr_b16 v[106:107], v73 offset:41472
    v_max_f32 v130, 0, v130
    v_mfma_f32_16x16x32_bf16 v[152:155], v[116:119], a[248:251], v[152:155]
    v_max_f32 v131, 0, v131
    v_max_f32 v132, 0, v132
    v_mfma_f32_16x16x32_bf16 v[148:151], v[112:115], a[228:231], v[148:151]
    ds_read_b64_tr_b16 v[108:109], v73 offset:45056
    v_max_f32 v133, 0, v133
    v_mfma_f32_16x16x32_bf16 v[148:151], v[116:119], a[244:247], v[148:151]
    v_max_f32 v134, 0, v134
    v_max_f32 v135, 0, v135
    v_mfma_f32_16x16x32_bf16 v[144:147], v[112:115], a[224:227], v[144:147]
    ds_read_b64_tr_b16 v[110:111], v73 offset:45568
    v_max_f32 v136, 0, v136
    v_mfma_f32_16x16x32_bf16 v[144:147], v[116:119], a[240:243], v[144:147]
    s_waitcnt vmcnt(20) lgkmcnt(4)
    s_barrier
    v_max_f32 v137, 0, v137
    v_mfma_f32_16x16x32_bf16 v[160:163], v[120:123], a[224:227], v[160:163]
    ds_read_b64_tr_b16 v[112:113], v72 offset:49152
    v_max_f32 v138, 0, v138
    v_mfma_f32_16x16x32_bf16 v[160:163], v[124:127], a[240:243], v[160:163]
    buffer_load_dwordx4 v44, s[32:35], s78 offen offset:0  lds
    v_mfma_f32_16x16x32_bf16 v[164:167], v[120:123], a[228:231], v[164:167]
    ds_read_b64_tr_b16 v[114:115], v72 offset:49664
    v_max_f32 v139, 0, v139
    v_mfma_f32_16x16x32_bf16 v[164:167], v[124:127], a[244:247], v[164:167]
    v_max_f32 v140, 0, v140
    v_max_f32 v141, 0, v141
    v_mfma_f32_16x16x32_bf16 v[168:171], v[120:123], a[232:235], v[168:171]
    ds_read_b64_tr_b16 v[116:117], v72 offset:53248
    v_max_f32 v142, 0, v142
    v_mfma_f32_16x16x32_bf16 v[168:171], v[124:127], a[248:251], v[168:171]
    buffer_load_dwordx4 v45, s[32:35], s78 offen offset:1024  lds
    v_mfma_f32_16x16x32_bf16 v[172:175], v[120:123], a[236:239], v[172:175]
    ds_read_b64_tr_b16 v[118:119], v72 offset:53760
    v_max_f32 v143, 0, v143
    v_mfma_f32_16x16x32_bf16 v[172:175], v[124:127], a[252:255], v[172:175]
    s_waitcnt lgkmcnt(4)
    v_max_f32 v156, 0, v156
    v_max_f32 v157, 0, v157
    v_mfma_f32_16x16x32_bf16 v[188:191], v[104:107], a[236:239], v[188:191]
    ds_read_b64_tr_b16 v[120:121], v73 offset:49152
    v_max_f32 v158, 0, v158
    v_mfma_f32_16x16x32_bf16 v[188:191], v[108:111], a[252:255], v[188:191]
    buffer_load_dwordx4 v46, s[32:35], s78 offen offset:2048  lds
    v_mfma_f32_16x16x32_bf16 v[184:187], v[104:107], a[232:235], v[184:187]
    ds_read_b64_tr_b16 v[122:123], v73 offset:49664
    v_max_f32 v159, 0, v159
    v_mfma_f32_16x16x32_bf16 v[184:187], v[108:111], a[248:251], v[184:187]
    v_max_f32 v152, 0, v152
    v_max_f32 v153, 0, v153
    v_mfma_f32_16x16x32_bf16 v[180:183], v[104:107], a[228:231], v[180:183]
    ds_read_b64_tr_b16 v[124:125], v73 offset:53248
    v_max_f32 v154, 0, v154
    v_mfma_f32_16x16x32_bf16 v[180:183], v[108:111], a[244:247], v[180:183]
    buffer_load_dwordx4 v47, s[32:35], s78 offen offset:3072  lds
    v_mfma_f32_16x16x32_bf16 v[176:179], v[104:107], a[224:227], v[176:179]
    ds_read_b64_tr_b16 v[126:127], v73 offset:53760
    s_add_u32 m0, s74, 32768
    v_mfma_f32_16x16x32_bf16 v[176:179], v[108:111], a[240:243], v[176:179]
    s_waitcnt lgkmcnt(4)
    s_mul_i32 s78, s25, 196608
    s_add_u32 s78, s78, s77
    v_mfma_f32_16x16x32_bf16 v[192:195], v[112:115], a[64:67], v[192:195]
    ds_read_b64_tr_b16 v[104:105], v72 offset:57344
    v_max_f32 v155, 0, v155
    v_mfma_f32_16x16x32_bf16 v[192:195], v[116:119], a[80:83], v[192:195]
    v_max_f32 v148, 0, v148
    v_max_f32 v149, 0, v149
    v_mfma_f32_16x16x32_bf16 v[196:199], v[112:115], a[68:71], v[196:199]
    ds_read_b64_tr_b16 v[106:107], v72 offset:57856
    v_max_f32 v150, 0, v150
    v_mfma_f32_16x16x32_bf16 v[196:199], v[116:119], a[84:87], v[196:199]
    v_max_f32 v151, 0, v151
    v_max_f32 v144, 0, v144
    v_mfma_f32_16x16x32_bf16 v[200:203], v[112:115], a[72:75], v[200:203]
    ds_read_b64_tr_b16 v[108:109], v72 offset:61440
    v_max_f32 v145, 0, v145
    v_mfma_f32_16x16x32_bf16 v[200:203], v[116:119], a[88:91], v[200:203]
    v_max_f32 v146, 0, v146
    v_max_f32 v147, 0, v147
    v_mfma_f32_16x16x32_bf16 v[204:207], v[112:115], a[76:79], v[204:207]
    ds_read_b64_tr_b16 v[110:111], v72 offset:61952
    v_mul_f32 v128, v128, v160
    v_mfma_f32_16x16x32_bf16 v[204:207], v[116:119], a[92:95], v[204:207]
    s_waitcnt lgkmcnt(4)
    v_mul_f32 v129, v129, v161
    v_mul_f32 v130, v130, v162
    v_mfma_f32_16x16x32_bf16 v[220:223], v[120:123], a[76:79], v[220:223]
    ds_read_b64_tr_b16 v[112:113], v73 offset:57344
    v_mul_f32 v131, v131, v163
    v_mfma_f32_16x16x32_bf16 v[220:223], v[124:127], a[92:95], v[220:223]
    v_cvt_pk_bf16_f32 v160, v128, v129
    v_cvt_pk_bf16_f32 v161, v130, v131
    v_mfma_f32_16x16x32_bf16 v[216:219], v[120:123], a[72:75], v[216:219]
    ds_read_b64_tr_b16 v[114:115], v73 offset:57856
    v_mul_f32 v132, v132, v164
    v_mfma_f32_16x16x32_bf16 v[216:219], v[124:127], a[88:91], v[216:219]
    v_mul_f32 v133, v133, v165
    v_mul_f32 v134, v134, v166
    v_mfma_f32_16x16x32_bf16 v[212:215], v[120:123], a[68:71], v[212:215]
    ds_read_b64_tr_b16 v[116:117], v73 offset:61440
    v_mul_f32 v135, v135, v167
    v_mfma_f32_16x16x32_bf16 v[212:215], v[124:127], a[84:87], v[212:215]
    v_cvt_pk_bf16_f32 v164, v132, v133
    v_cvt_pk_bf16_f32 v165, v134, v135
    v_mfma_f32_16x16x32_bf16 v[208:211], v[120:123], a[64:67], v[208:211]
    ds_read_b64_tr_b16 v[118:119], v73 offset:61952
    v_mul_f32 v136, v136, v168
    v_mfma_f32_16x16x32_bf16 v[208:211], v[124:127], a[80:83], v[208:211]
    s_waitcnt vmcnt(20) lgkmcnt(4)
    s_barrier
    v_mul_f32 v137, v137, v169
    v_mfma_f32_16x16x32_bf16 v[224:227], v[104:107], a[64:67], v[224:227]
    ds_read_b64_tr_b16 v[120:121], v74 offset:0
    v_mul_f32 v138, v138, v170
    v_mfma_f32_16x16x32_bf16 v[224:227], v[108:111], a[80:83], v[224:227]
    buffer_load_dwordx4 v44, s[32:35], s78 offen offset:0  lds
    v_mfma_f32_16x16x32_bf16 v[228:231], v[104:107], a[68:71], v[228:231]
    ds_read_b64_tr_b16 v[122:123], v74 offset:512
    v_mul_f32 v139, v139, v171
    v_mfma_f32_16x16x32_bf16 v[228:231], v[108:111], a[84:87], v[228:231]
    v_cvt_pk_bf16_f32 v168, v136, v137
    v_cvt_pk_bf16_f32 v169, v138, v139
    v_mfma_f32_16x16x32_bf16 v[232:235], v[104:107], a[72:75], v[232:235]
    ds_read_b64_tr_b16 v[124:125], v74 offset:4096
    v_mul_f32 v140, v140, v172
    v_mfma_f32_16x16x32_bf16 v[232:235], v[108:111], a[88:91], v[232:235]
    buffer_load_dwordx4 v45, s[32:35], s78 offen offset:1024  lds
    v_mfma_f32_16x16x32_bf16 v[236:239], v[104:107], a[76:79], v[236:239]
    ds_read_b64_tr_b16 v[126:127], v74 offset:4608
    v_mul_f32 v141, v141, v173
    v_mfma_f32_16x16x32_bf16 v[236:239], v[108:111], a[92:95], v[236:239]
    s_waitcnt lgkmcnt(4)
    v_mul_f32 v142, v142, v174
    v_mul_f32 v143, v143, v175
    v_mfma_f32_16x16x32_bf16 v[252:255], v[112:115], a[76:79], v[252:255]
    ds_read_b64_tr_b16 v[104:105], v75 offset:0
    v_cvt_pk_bf16_f32 v172, v140, v141
    v_mfma_f32_16x16x32_bf16 v[252:255], v[116:119], a[92:95], v[252:255]
    buffer_load_dwordx4 v46, s[32:35], s78 offen offset:2048  lds
    v_mfma_f32_16x16x32_bf16 v[248:251], v[112:115], a[72:75], v[248:251]
    ds_read_b64_tr_b16 v[106:107], v75 offset:512
    v_cvt_pk_bf16_f32 v173, v142, v143
    v_mfma_f32_16x16x32_bf16 v[248:251], v[116:119], a[88:91], v[248:251]
    v_mul_f32 v156, v156, v188
    v_mul_f32 v157, v157, v189
    v_mfma_f32_16x16x32_bf16 v[244:247], v[112:115], a[68:71], v[244:247]
    ds_read_b64_tr_b16 v[108:109], v75 offset:4096
    v_mul_f32 v158, v158, v190
    v_mfma_f32_16x16x32_bf16 v[244:247], v[116:119], a[84:87], v[244:247]
    buffer_load_dwordx4 v47, s[32:35], s78 offen offset:3072  lds
    v_mfma_f32_16x16x32_bf16 v[240:243], v[112:115], a[64:67], v[240:243]
    ds_read_b64_tr_b16 v[110:111], v75 offset:4608
    s_add_u32 m0, s74, 49152
    v_mfma_f32_16x16x32_bf16 v[240:243], v[116:119], a[80:83], v[240:243]
LA_pg2:
    s_cbranch_execz LA_walked
    s_waitcnt lgkmcnt(4)
    s_mul_i32 s78, s26, 196608
    s_add_u32 s78, s78, s77
    v_mfma_f32_16x16x32_bf16 v[192:195], v[120:123], a[96:99], v[192:195]
    ds_read_b64_tr_b16 v[112:113], v74 offset:8192
    v_mul_f32 v159, v159, v191
    v_mfma_f32_16x16x32_bf16 v[192:195], v[124:127], a[112:115], v[192:195]
    v_cvt_pk_bf16_f32 v174, v156, v157
    v_cvt_pk_bf16_f32 v175, v158, v159
    v_mfma_f32_16x16x32_bf16 v[196:199], v[120:123], a[100:103], v[196:199]
    ds_read_b64_tr_b16 v[114:115], v74 offset:8704
    buffer_store_dword v25, v24, s[48:51], s3 offen sc1
    v_mfma_f32_16x16x32_bf16 v[196:199], v[124:127], a[116:119], v[196:199]
    buffer_store_dwordx4 v[172:175], v21, s[48:51], s86 offen offset:3072 sc1
    v_mfma_f32_16x16x32_bf16 v[200:203], v[120:123], a[104:107], v[200:203]
    ds_read_b64_tr_b16 v[116:117], v74 offset:12288
    v_mul_f32 v152, v152, v184
    v_mfma_f32_16x16x32_bf16 v[200:203], v[124:127], a[120:123], v[200:203]
    v_mul_f32 v153, v153, v185
    v_mul_f32 v154, v154, v186
    v_mfma_f32_16x16x32_bf16 v[204:207], v[120:123], a[108:111], v[204:207]
    ds_read_b64_tr_b16 v[118:119], v74 offset:12800
    v_mul_f32 v155, v155, v187
    v_mfma_f32_16x16x32_bf16 v[204:207], v[124:127], a[124:127], v[204:207]
    s_waitcnt lgkmcnt(4)
    v_cvt_pk_bf16_f32 v170, v152, v153
    v_cvt_pk_bf16_f32 v171, v154, v155
    v_mfma_f32_16x16x32_bf16 v[220:223], v[104:107], a[108:111], v[220:223]
    ds_read_b64_tr_b16 v[120:121], v75 offset:8192
    buffer_store_dwordx4 v[168:171], v21, s[48:51], s86 offen offset:2048 sc1
    v_mfma_f32_16x16x32_bf16 v[220:223], v[108:111], a[124:127], v[220:223]
    v_mul_f32 v148, v148, v180
    v_mul_f32 v149, v149, v181
    v_mfma_f32_16x16x32_bf16 v[216:219], v[104:107], a[104:107], v[216:219]
    ds_read_b64_tr_b16 v[122:123], v75 offset:8704
    v_mul_f32 v150, v150, v182
    v_mfma_f32_16x16x32_bf16 v[216:219], v[108:111], a[120:123], v[216:219]
    v_mul_f32 v151, v151, v183
    v_cvt_pk_bf16_f32 v166, v148, v149
    v_mfma_f32_16x16x32_bf16 v[212:215], v[104:107], a[100:103], v[212:215]
    ds_read_b64_tr_b16 v[124:125], v75 offset:12288
    v_cvt_pk_bf16_f32 v167, v150, v151
    v_mfma_f32_16x16x32_bf16 v[212:215], v[108:111], a[116:119], v[212:215]
    buffer_store_dwordx4 v[164:167], v21, s[48:51], s86 offen offset:1024 sc1
    v_mfma_f32_16x16x32_bf16 v[208:211], v[104:107], a[96:99], v[208:211]
    ds_read_b64_tr_b16 v[126:127], v75 offset:12800
    v_mul_f32 v144, v144, v176
    v_mfma_f32_16x16x32_bf16 v[208:211], v[108:111], a[112:115], v[208:211]
    s_waitcnt vmcnt(24) lgkmcnt(4)
    s_barrier
    v_mul_f32 v145, v145, v177
    v_mfma_f32_16x16x32_bf16 v[224:227], v[112:115], a[96:99], v[224:227]
    ds_read_b64_tr_b16 v[104:105], v74 offset:16384
    v_mul_f32 v146, v146, v178
    v_mfma_f32_16x16x32_bf16 v[224:227], v[116:119], a[112:115], v[224:227]
    v_mul_f32 v147, v147, v179
    v_cvt_pk_bf16_f32 v162, v144, v145
    v_mfma_f32_16x16x32_bf16 v[228:231], v[112:115], a[100:103], v[228:231]
    ds_read_b64_tr_b16 v[106:107], v74 offset:16896
    v_cvt_pk_bf16_f32 v163, v146, v147
    v_mfma_f32_16x16x32_bf16 v[228:231], v[116:119], a[116:119], v[228:231]
    buffer_store_dwordx4 v[160:163], v21, s[48:51], s86 offen offset:0 sc1
    v_mfma_f32_16x16x32_bf16 v[232:235], v[112:115], a[104:107], v[232:235]
    ds_read_b64_tr_b16 v[108:109], v74 offset:20480
    v_mfma_f32_16x16x32_bf16 v[232:235], v[116:119], a[120:123], v[232:235]
    v_mfma_f32_16x16x32_bf16 v[236:239], v[112:115], a[108:111], v[236:239]
    ds_read_b64_tr_b16 v[110:111], v74 offset:20992
    v_mfma_f32_16x16x32_bf16 v[236:239], v[116:119], a[124:127], v[236:239]
    s_waitcnt lgkmcnt(4)
    v_mfma_f32_16x16x32_bf16 v[252:255], v[120:123], a[108:111], v[252:255]
    ds_read_b64_tr_b16 v[112:113], v75 offset:16384
    v_mfma_f32_16x16x32_bf16 v[252:255], v[124:127], a[124:127], v[252:255]
    v_mfma_f32_16x16x32_bf16 v[248:251], v[120:123], a[104:107], v[248:251]
    ds_read_b64_tr_b16 v[114:115], v75 offset:16896
    v_mfma_f32_16x16x32_bf16 v[248:251], v[124:127], a[120:123], v[248:251]
    v_mfma_f32_16x16x32_bf16 v[244:247], v[120:123], a[100:103], v[244:247]
    ds_read_b64_tr_b16 v[116:117], v75 offset:20480
    v_mfma_f32_16x16x32_bf16 v[244:247], v[124:127], a[116:119], v[244:247]
    v_mfma_f32_16x16x32_bf16 v[240:243], v[120:123], a[96:99], v[240:243]
    ds_read_b64_tr_b16 v[118:119], v75 offset:20992
    v_mfma_f32_16x16x32_bf16 v[240:243], v[124:127], a[112:115], v[240:243]
    s_waitcnt lgkmcnt(4)
    v_mfma_f32_16x16x32_bf16 v[192:195], v[104:107], a[128:131], v[192:195]
    ds_read_b64_tr_b16 v[120:121], v74 offset:24576
    v_mfma_f32_16x16x32_bf16 v[192:195], v[108:111], a[144:147], v[192:195]
    v_mfma_f32_16x16x32_bf16 v[196:199], v[104:107], a[132:135], v[196:199]
    ds_read_b64_tr_b16 v[122:123], v74 offset:25088
    v_mfma_f32_16x16x32_bf16 v[196:199], v[108:111], a[148:151], v[196:199]
    v_mfma_f32_16x16x32_bf16 v[200:203], v[104:107], a[136:139], v[200:203]
    ds_read_b64_tr_b16 v[124:125], v74 offset:28672
    v_mfma_f32_16x16x32_bf16 v[200:203], v[108:111], a[152:155], v[200:203]
    v_mfma_f32_16x16x32_bf16 v[204:207], v[104:107], a[140:143], v[204:207]
    ds_read_b64_tr_b16 v[126:127], v74 offset:29184
    v_mfma_f32_16x16x32_bf16 v[204:207], v[108:111], a[156:159], v[204:207]
    s_waitcnt lgkmcnt(4)
    v_mfma_f32_16x16x32_bf16 v[220:223], v[112:115], a[140:143], v[220:223]
    ds_read_b64_tr_b16 v[104:105], v75 offset:24576
    v_mfma_f32_16x16x32_bf16 v[220:223], v[116:119], a[156:159], v[220:223]
    ds_read_b64_tr_b16 v[106:107], v75 offset:25088
    v_mfma_f32_16x16x32_bf16 v[216:219], v[112:115], a[136:139], v[216:219]
    ds_read_b64_tr_b16 v[108:109], v75 offset:28672
    v_mfma_f32_16x16x32_bf16 v[216:219], v[116:119], a[152:155], v[216:219]
    ds_read_b64_tr_b16 v[110:111], v75 offset:29184
    v_mfma_f32_16x16x32_bf16 v[212:215], v[112:115], a[132:135], v[212:215]
    v_mfma_f32_16x16x32_bf16 v[212:215], v[116:119], a[148:151], v[212:215]
    v_mfma_f32_16x16x32_bf16 v[208:211], v[112:115], a[128:131], v[208:211]
    v_mfma_f32_16x16x32_bf16 v[208:211], v[116:119], a[144:147], v[208:211]
    s_waitcnt vmcnt(21) lgkmcnt(0)
    s_barrier
    v_mfma_f32_16x16x32_bf16 v[224:227], v[120:123], a[128:131], v[224:227]
    ds_read_b64_tr_b16 v[112:113], v74 offset:49152
    v_mfma_f32_16x16x32_bf16 v[224:227], v[124:127], a[144:147], v[224:227]
    buffer_load_dwordx4 v44, s[32:35], s78 offen offset:0  lds
    v_mfma_f32_16x16x32_bf16 v[228:231], v[120:123], a[132:135], v[228:231]
    ds_read_b64_tr_b16 v[114:115], v74 offset:49664
    v_mfma_f32_16x16x32_bf16 v[228:231], v[124:127], a[148:151], v[228:231]
    v_mfma_f32_16x16x32_bf16 v[232:235], v[120:123], a[136:139], v[232:235]
    ds_read_b64_tr_b16 v[116:117], v74 offset:53248
    v_mfma_f32_16x16x32_bf16 v[232:235], v[124:127], a[152:155], v[232:235]
    buffer_load_dwordx4 v45, s[32:35], s78 offen offset:1024  lds
    v_mfma_f32_16x16x32_bf16 v[236:239], v[120:123], a[140:143], v[236:239]
    ds_read_b64_tr_b16 v[118:119], v74 offset:53760
    v_mfma_f32_16x16x32_bf16 v[236:239], v[124:127], a[156:159], v[236:239]
    v_mfma_f32_16x16x32_bf16 v[252:255], v[104:107], a[140:143], v[252:255]
    ds_read_b64_tr_b16 v[120:121], v75 offset:49152
    v_mfma_f32_16x16x32_bf16 v[252:255], v[108:111], a[156:159], v[252:255]
    buffer_load_dwordx4 v46, s[32:35], s78 offen offset:2048  lds
    v_mfma_f32_16x16x32_bf16 v[248:251], v[104:107], a[136:139], v[248:251]
    ds_read_b64_tr_b16 v[122:123], v75 offset:49664
    v_mfma_f32_16x16x32_bf16 v[248:251], v[108:111], a[152:155], v[248:251]
    v_mfma_f32_16x16x32_bf16 v[244:247], v[104:107], a[132:135], v[244:247]
    ds_read_b64_tr_b16 v[124:125], v75 offset:53248
    v_mfma_f32_16x16x32_bf16 v[244:247], v[108:111], a[148:151], v[244:247]
    buffer_load_dwordx4 v47, s[32:35], s78 offen offset:3072  lds
    v_mfma_f32_16x16x32_bf16 v[240:243], v[104:107], a[128:131], v[240:243]
    ds_read_b64_tr_b16 v[126:127], v75 offset:53760
    s_add_u32 m0, s74, 65536
    v_mfma_f32_16x16x32_bf16 v[240:243], v[108:111], a[144:147], v[240:243]
    s_waitcnt lgkmcnt(4)
    s_mul_i32 s78, s27, 196608
    s_add_u32 s78, s78, s77
    v_mfma_f32_16x16x32_bf16 v[192:195], v[112:115], a[160:163], v[192:195]
    ds_read_b64_tr_b16 v[104:105], v74 offset:57344
    v_mfma_f32_16x16x32_bf16 v[192:195], v[116:119], a[176:179], v[192:195]
    buffer_load_dwordx4 v44, s[32:35], s78 offen offset:0  lds
    v_mfma_f32_16x16x32_bf16 v[196:199], v[112:115], a[164:167], v[196:199]
    ds_read_b64_tr_b16 v[106:107], v74 offset:57856
    v_mfma_f32_16x16x32_bf16 v[196:199], v[116:119], a[180:183], v[196:199]
    v_mfma_f32_16x16x32_bf16 v[200:203], v[112:115], a[168:171], v[200:203]
    ds_read_b64_tr_b16 v[108:109], v74 offset:61440
    v_mfma_f32_16x16x32_bf16 v[200:203], v[116:119], a[184:187], v[200:203]
    buffer_load_dwordx4 v45, s[32:35], s78 offen offset:1024  lds
    v_mfma_f32_16x16x32_bf16 v[204:207], v[112:115], a[172:175], v[204:207]
    ds_read_b64_tr_b16 v[110:111], v74 offset:61952
    v_mfma_f32_16x16x32_bf16 v[204:207], v[116:119], a[188:191], v[204:207]
    s_waitcnt lgkmcnt(4)
    v_mfma_f32_16x16x32_bf16 v[220:223], v[120:123], a[172:175], v[220:223]
    ds_read_b64_tr_b16 v[112:113], v75 offset:57344
    v_mfma_f32_16x16x32_bf16 v[220:223], v[124:127], a[188:191], v[220:223]
    ds_read_b64_tr_b16 v[114:115], v75 offset:57856
    v_mfma_f32_16x16x32_bf16 v[216:219], v[120:123], a[168:171], v[216:219]
    ds_read_b64_tr_b16 v[116:117], v75 offset:61440
    v_mfma_f32_16x16x32_bf16 v[216:219], v[124:127], a[184:187], v[216:219]
    ds_read_b64_tr_b16 v[118:119], v75 offset:61952
    v_mfma_f32_16x16x32_bf16 v[212:215], v[120:123], a[164:167], v[212:215]
    buffer_load_dwordx4 v46, s[32:35], s78 offen offset:2048  lds
    v_mfma_f32_16x16x32_bf16 v[212:215], v[124:127], a[180:183], v[212:215]
    v_mfma_f32_16x16x32_bf16 v[208:211], v[120:123], a[160:163], v[208:211]
    buffer_load_dwordx4 v47, s[32:35], s78 offen offset:3072  lds
    v_mfma_f32_16x16x32_bf16 v[208:211], v[124:127], a[176:179], v[208:211]
    s_waitcnt vmcnt(25) lgkmcnt(0)
    s_barrier
    s_add_u32 m0, s74, 131072
    v_mfma_f32_16x16x32_bf16 v[224:227], v[104:107], a[160:163], v[224:227]
    ds_read_b64_tr_b16 v[120:121], v74 offset:32768
    s_add_u32 s78, s10, 0
    v_mfma_f32_16x16x32_bf16 v[224:227], v[108:111], a[176:179], v[224:227]
    buffer_load_dwordx4 v52, s[40:43], s78 offen offset:0  lds
    v_mfma_f32_16x16x32_bf16 v[228:231], v[104:107], a[164:167], v[228:231]
    ds_read_b64_tr_b16 v[122:123], v74 offset:33280
    v_mfma_f32_16x16x32_bf16 v[228:231], v[108:111], a[180:183], v[228:231]
    v_mfma_f32_16x16x32_bf16 v[232:235], v[104:107], a[168:171], v[232:235]
    ds_read_b64_tr_b16 v[124:125], v74 offset:36864
    v_mfma_f32_16x16x32_bf16 v[232:235], v[108:111], a[184:187], v[232:235]
    buffer_load_dwordx4 v53, s[40:43], s78 offen offset:1024  lds
    s_waitcnt vmcnt(10)
    s_atomic_add s12, s[48:49], s88 offset:0 glc
    s_bfe_u32 s3, s3, 0x50008
    s_lshl_b32 s3, s3, 7
    s_add_u32 s3, s3, 9846784
    s_atomic_add s15, s[48:49], s3 glc
    v_mfma_f32_16x16x32_bf16 v[236:239], v[104:107], a[172:175], v[236:239]
    ds_read_b64_tr_b16 v[126:127], v74 offset:37376
    v_mfma_f32_16x16x32_bf16 v[236:239], v[108:111], a[188:191], v[236:239]
    v_mfma_f32_16x16x32_bf16 v[252:255], v[112:115], a[172:175], v[252:255]
    ds_read_b64_tr_b16 v[104:105], v75 offset:32768
    v_mfma_f32_16x16x32_bf16 v[252:255], v[116:119], a[188:191], v[252:255]
    buffer_load_dwordx4 v54, s[40:43], s78 offen offset:2048  lds
    v_mfma_f32_16x16x32_bf16 v[248:251], v[112:115], a[168:171], v[248:251]
    ds_read_b64_tr_b16 v[106:107], v75 offset:33280
    v_mfma_f32_16x16x32_bf16 v[248:251], v[116:119], a[184:187], v[248:251]
    v_mfma_f32_16x16x32_bf16 v[244:247], v[112:115], a[164:167], v[244:247]
    ds_read_b64_tr_b16 v[108:109], v75 offset:36864
    v_mfma_f32_16x16x32_bf16 v[244:247], v[116:119], a[180:183], v[244:247]
    buffer_load_dwordx4 v55, s[40:43], s78 offen offset:3072  lds
    v_mfma_f32_16x16x32_bf16 v[240:243], v[112:115], a[160:163], v[240:243]
    ds_read_b64_tr_b16 v[110:111], v75 offset:37376
    s_add_u32 m0, s74, 81920
    v_mfma_f32_16x16x32_bf16 v[240:243], v[116:119], a[176:179], v[240:243]
    s_waitcnt lgkmcnt(4)
    s_add_u32 s78, s10, 32768
    v_mfma_f32_16x16x32_bf16 v[192:195], v[120:123], a[192:195], v[192:195]
    ds_read_b64_tr_b16 v[112:113], v74 offset:40960
    v_mfma_f32_16x16x32_bf16 v[192:195], v[124:127], a[208:211], v[192:195]
    buffer_load_dwordx4 v52, s[40:43], s78 offen offset:0  lds
    v_mfma_f32_16x16x32_bf16 v[196:199], v[120:123], a[196:199], v[196:199]
    ds_read_b64_tr_b16 v[114:115], v74 offset:41472
    v_mfma_f32_16x16x32_bf16 v[196:199], v[124:127], a[212:215], v[196:199]
    v_mfma_f32_16x16x32_bf16 v[200:203], v[120:123], a[200:203], v[200:203]
    ds_read_b64_tr_b16 v[116:117], v74 offset:45056
    v_mfma_f32_16x16x32_bf16 v[200:203], v[124:127], a[216:219], v[200:203]
    buffer_load_dwordx4 v53, s[40:43], s78 offen offset:1024  lds
    v_mfma_f32_16x16x32_bf16 v[204:207], v[120:123], a[204:207], v[204:207]
    ds_read_b64_tr_b16 v[118:119], v74 offset:45568
    v_mfma_f32_16x16x32_bf16 v[204:207], v[124:127], a[220:223], v[204:207]
    s_waitcnt lgkmcnt(4)
    v_mfma_f32_16x16x32_bf16 v[220:223], v[104:107], a[204:207], v[220:223]
    ds_read_b64_tr_b16 v[120:121], v75 offset:40960
    v_mfma_f32_16x16x32_bf16 v[220:223], v[108:111], a[220:223], v[220:223]
    ds_read_b64_tr_b16 v[122:123], v75 offset:41472
    v_mfma_f32_16x16x32_bf16 v[216:219], v[104:107], a[200:203], v[216:219]
    ds_read_b64_tr_b16 v[124:125], v75 offset:45056
    v_mfma_f32_16x16x32_bf16 v[216:219], v[108:111], a[216:219], v[216:219]
    ds_read_b64_tr_b16 v[126:127], v75 offset:45568
    v_mfma_f32_16x16x32_bf16 v[212:215], v[104:107], a[196:199], v[212:215]
    buffer_load_dwordx4 v54, s[40:43], s78 offen offset:2048  lds
    v_mfma_f32_16x16x32_bf16 v[212:215], v[108:111], a[212:215], v[212:215]
    v_mfma_f32_16x16x32_bf16 v[208:211], v[104:107], a[192:195], v[208:211]
    buffer_load_dwordx4 v55, s[40:43], s78 offen offset:3072  lds
    v_mfma_f32_16x16x32_bf16 v[208:211], v[108:111], a[208:211], v[208:211]
    ds_read_b32 v27, v22
    ds_read_b32 v27, v22
    s_waitcnt lgkmcnt(2)
    s_barrier
    s_add_u32 m0, s74, 114688
    v_mfma_f32_16x16x32_bf16 v[224:227], v[112:115], a[192:195], v[224:227]
    ds_read_b64_tr_b16 v[160:161], v72 offset:0
    s_add_u32 s78, vcc_lo, 0
    v_mfma_f32_16x16x32_bf16 v[224:227], v[116:119], a[208:211], v[224:227]
    ds_read_b64_tr_b16 v[162:163], v72 offset:512
    buffer_load_dwordx4 v52, s[40:43], s78 offen offset:0  lds
    v_mfma_f32_16x16x32_bf16 v[228:231], v[112:115], a[196:199], v[228:231]
    ds_read_b64_tr_b16 v[164:165], v72 offset:4096
    v_mfma_f32_16x16x32_bf16 v[228:231], v[116:119], a[212:215], v[228:231]
    ds_read_b64_tr_b16 v[166:167], v72 offset:4608
    v_mfma_f32_16x16x32_bf16 v[232:235], v[112:115], a[200:203], v[232:235]
    ds_read_b64_tr_b16 v[168:169], v73 offset:0
    v_mfma_f32_16x16x32_bf16 v[232:235], v[116:119], a[216:219], v[232:235]
    ds_read_b64_tr_b16 v[170:171], v73 offset:512
    buffer_load_dwordx4 v53, s[40:43], s78 offen offset:1024  lds
    v_mfma_f32_16x16x32_bf16 v[236:239], v[112:115], a[204:207], v[236:239]
    ds_read_b64_tr_b16 v[172:173], v73 offset:4096
    v_mfma_f32_16x16x32_bf16 v[236:239], v[116:119], a[220:223], v[236:239]
    ds_read_b64_tr_b16 v[174:175], v73 offset:4608
    v_mfma_f32_16x16x32_bf16 v[252:255], v[120:123], a[204:207], v[252:255]
    ds_read_b64_tr_b16 v[176:177], v72 offset:8192
    v_mfma_f32_16x16x32_bf16 v[252:255], v[124:127], a[220:223], v[252:255]
    ds_read_b64_tr_b16 v[178:179], v72 offset:8704
    buffer_load_dwordx4 v54, s[40:43], s78 offen offset:2048  lds
    v_mfma_f32_16x16x32_bf16 v[248:251], v[120:123], a[200:203], v[248:251]
    ds_read_b64_tr_b16 v[180:181], v72 offset:12288
    v_mfma_f32_16x16x32_bf16 v[248:251], v[124:127], a[216:219], v[248:251]
    ds_read_b64_tr_b16 v[182:183], v72 offset:12800
    v_mfma_f32_16x16x32_bf16 v[244:247], v[120:123], a[196:199], v[244:247]
    ds_read_b64_tr_b16 v[184:185], v73 offset:8192
    v_mfma_f32_16x16x32_bf16 v[244:247], v[124:127], a[212:215], v[244:247]
    ds_read_b64_tr_b16 v[186:187], v73 offset:8704
    buffer_load_dwordx4 v55, s[40:43], s78 offen offset:3072  lds
    v_mfma_f32_16x16x32_bf16 v[240:243], v[120:123], a[192:195], v[240:243]
    ds_read_b64_tr_b16 v[188:189], v73 offset:12288
    s_add_u32 m0, s74, 98304
    v_mfma_f32_16x16x32_bf16 v[240:243], v[124:127], a[208:211], v[240:243]
    s_waitcnt lgkmcnt(11)
    ds_read_b64_tr_b16 v[190:191], v73 offset:12800
    v_mfma_f32_16x16x32_bf16 v[192:195], v[160:163], a[224:227], v[192:195]
    s_add_u32 s78, vcc_lo, 32768
    s_lshl_b32 s86, s72, 1
    s_add_u32 s86, s86, s66
    v_mfma_f32_16x16x32_bf16 v[192:195], v[164:167], a[240:243], v[192:195]
    buffer_load_dwordx4 v52, s[40:43], s78 offen offset:0  lds
    s_waitcnt lgkmcnt(6)
    v_mfma_f32_16x16x32_bf16 v[224:227], v[176:179], a[224:227], v[224:227]
    s_add_u32 s86, s86, 16
    s_lshl_b32 s86, s86, 12
    s_add_u32 s86, s86, s85
    s_waitcnt lgkmcnt(4)
    v_mfma_f32_16x16x32_bf16 v[224:227], v[180:183], a[240:243], v[224:227]
    v_mfma_f32_16x16x32_bf16 v[208:211], v[168:171], a[224:227], v[208:211]
    v_mfma_f32_16x16x32_bf16 v[208:211], v[172:175], a[240:243], v[208:211]
    buffer_load_dwordx4 v53, s[40:43], s78 offen offset:1024  lds
    s_waitcnt lgkmcnt(2)
    v_mfma_f32_16x16x32_bf16 v[240:243], v[184:187], a[224:227], v[240:243]
    ds_read_b32 v27, v22
    ds_read_b32 v27, v22
    s_waitcnt lgkmcnt(2)
    v_mfma_f32_16x16x32_bf16 v[240:243], v[188:191], a[240:243], v[240:243]
    v_mfma_f32_16x16x32_bf16 v[196:199], v[160:163], a[228:231], v[196:199]
    v_max_f32 v192, 0, v192
    v_max_f32 v193, 0, v193
    v_max_f32 v194, 0, v194
    v_max_f32 v195, 0, v195
    v_mul_f32 v192, v192, v224
    v_mfma_f32_16x16x32_bf16 v[196:199], v[164:167], a[244:247], v[196:199]
    buffer_load_dwordx4 v54, s[40:43], s78 offen offset:2048  lds
    v_mul_f32 v193, v193, v225
    v_mul_f32 v194, v194, v226
    v_mul_f32 v195, v195, v227
    v_mfma_f32_16x16x32_bf16 v[228:231], v[176:179], a[228:231], v[228:231]
    v_cvt_pk_bf16_f32 v224, v192, v193
    v_cvt_pk_bf16_f32 v225, v194, v195
    v_max_f32 v208, 0, v208
    v_max_f32 v209, 0, v209
    v_max_f32 v210, 0, v210
    v_mfma_f32_16x16x32_bf16 v[228:231], v[180:183], a[244:247], v[228:231]
    v_max_f32 v211, 0, v211
    v_mul_f32 v208, v208, v240
    v_mul_f32 v209, v209, v241
    v_mul_f32 v210, v210, v242
    v_mul_f32 v211, v211, v243
    v_mfma_f32_16x16x32_bf16 v[212:215], v[168:171], a[228:231], v[212:215]
    v_cvt_pk_bf16_f32 v226, v208, v209
    v_cvt_pk_bf16_f32 v227, v210, v211
    v_mfma_f32_16x16x32_bf16 v[212:215], v[172:175], a[244:247], v[212:215]
    buffer_load_dwordx4 v55, s[40:43], s78 offen offset:3072  lds
    buffer_store_dwordx4 v[224:227], v21, s[48:51], s86 offen offset:0 sc1
    v_mfma_f32_16x16x32_bf16 v[244:247], v[184:187], a[228:231], v[244:247]
    s_add_u32 m0, s74, 0
    s_add_u32 s78, s10, s11
    v_mfma_f32_16x16x32_bf16 v[244:247], v[188:191], a[244:247], v[244:247]
    s_barrier
    v_mfma_f32_16x16x32_bf16 v[200:203], v[160:163], a[232:235], v[200:203]
    ds_read_b64_tr_b16 v[104:105], v72 offset:16384
    v_max_f32 v196, 0, v196
    v_max_f32 v197, 0, v197
    v_max_f32 v198, 0, v198
    v_max_f32 v199, 0, v199
    v_mfma_f32_16x16x32_bf16 v[200:203], v[164:167], a[248:251], v[200:203]
    v_mul_f32 v196, v196, v228
    v_mul_f32 v197, v197, v229
    v_mul_f32 v198, v198, v230
    v_mul_f32 v199, v199, v231
    v_cvt_pk_bf16_f32 v228, v196, v197
    v_mfma_f32_16x16x32_bf16 v[232:235], v[176:179], a[232:235], v[232:235]
    ds_read_b64_tr_b16 v[106:107], v72 offset:16896
    v_cvt_pk_bf16_f32 v229, v198, v199
    v_max_f32 v212, 0, v212
    v_max_f32 v213, 0, v213
    v_max_f32 v214, 0, v214
    v_mfma_f32_16x16x32_bf16 v[232:235], v[180:183], a[248:251], v[232:235]
    v_max_f32 v215, 0, v215
    v_mul_f32 v212, v212, v244
    v_mul_f32 v213, v213, v245
    v_mul_f32 v214, v214, v246
    v_mul_f32 v215, v215, v247
    v_mfma_f32_16x16x32_bf16 v[216:219], v[168:171], a[232:235], v[216:219]
    ds_read_b64_tr_b16 v[108:109], v72 offset:20480
    v_cvt_pk_bf16_f32 v230, v212, v213
    v_cvt_pk_bf16_f32 v231, v214, v215
    v_mfma_f32_16x16x32_bf16 v[216:219], v[172:175], a[248:251], v[216:219]
    buffer_store_dwordx4 v[228:231], v21, s[48:51], s86 offen offset:1024 sc1
    v_mfma_f32_16x16x32_bf16 v[248:251], v[184:187], a[232:235], v[248:251]
    ds_read_b64_tr_b16 v[110:111], v72 offset:20992
    v_mfma_f32_16x16x32_bf16 v[248:251], v[188:191], a[248:251], v[248:251]
    v_mfma_f32_16x16x32_bf16 v[204:207], v[160:163], a[236:239], v[204:207]
    ds_read_b64_tr_b16 v[112:113], v73 offset:16384
    v_max_f32 v200, 0, v200
    v_max_f32 v201, 0, v201
    v_max_f32 v202, 0, v202
    v_max_f32 v203, 0, v203
    v_mfma_f32_16x16x32_bf16 v[204:207], v[164:167], a[252:255], v[204:207]
    v_mul_f32 v200, v200, v232
    v_mul_f32 v201, v201, v233
    v_mul_f32 v202, v202, v234
    v_mul_f32 v203, v203, v235
    v_cvt_pk_bf16_f32 v232, v200, v201
    v_mfma_f32_16x16x32_bf16 v[236:239], v[176:179], a[236:239], v[236:239]
    ds_read_b64_tr_b16 v[114:115], v73 offset:16896
    v_cvt_pk_bf16_f32 v233, v202, v203
    v_max_f32 v216, 0, v216
    v_max_f32 v217, 0, v217
    v_max_f32 v218, 0, v218
    v_mfma_f32_16x16x32_bf16 v[236:239], v[180:183], a[252:255], v[236:239]
    v_max_f32 v219, 0, v219
    v_mul_f32 v216, v216, v248
    v_mul_f32 v217, v217, v249
    v_mul_f32 v218, v218, v250
    v_mul_f32 v219, v219, v251
    v_mfma_f32_16x16x32_bf16 v[220:223], v[168:171], a[236:239], v[220:223]
    ds_read_b64_tr_b16 v[116:117], v73 offset:20480
    v_cvt_pk_bf16_f32 v234, v216, v217
    v_cvt_pk_bf16_f32 v235, v218, v219
    v_mfma_f32_16x16x32_bf16 v[220:223], v[172:175], a[252:255], v[220:223]
    buffer_store_dwordx4 v[232:235], v21, s[48:51], s86 offen offset:2048 sc1
    v_mfma_f32_16x16x32_bf16 v[252:255], v[184:187], a[236:239], v[252:255]
    ds_read_b64_tr_b16 v[118:119], v73 offset:20992
    v_mfma_f32_16x16x32_bf16 v[252:255], v[188:191], a[252:255], v[252:255]
    s_waitcnt lgkmcnt(4)
    v_mfma_f32_16x16x32_bf16 v[128:131], v[104:107], a[0:3], 0
    ds_read_b64_tr_b16 v[120:121], v72 offset:24576
    v_max_f32 v204, 0, v204
    v_max_f32 v205, 0, v205
    v_max_f32 v206, 0, v206
    v_max_f32 v207, 0, v207
    v_mfma_f32_16x16x32_bf16 v[128:131], v[108:111], a[16:19], v[128:131]
    v_mul_f32 v204, v204, v236
    v_mul_f32 v205, v205, v237
    v_mul_f32 v206, v206, v238
    v_mul_f32 v207, v207, v239
    v_cvt_pk_bf16_f32 v236, v204, v205
    v_mfma_f32_16x16x32_bf16 v[132:135], v[104:107], a[4:7], 0
    ds_read_b64_tr_b16 v[122:123], v72 offset:25088
    v_cvt_pk_bf16_f32 v237, v206, v207
    v_max_f32 v220, 0, v220
    v_max_f32 v221, 0, v221
    v_max_f32 v222, 0, v222
    v_mfma_f32_16x16x32_bf16 v[132:135], v[108:111], a[20:23], v[132:135]
    v_max_f32 v223, 0, v223
    v_mul_f32 v220, v220, v252
    v_mul_f32 v221, v221, v253
    v_mul_f32 v222, v222, v254
    v_mul_f32 v223, v223, v255
    v_mfma_f32_16x16x32_bf16 v[136:139], v[104:107], a[8:11], 0
    ds_read_b64_tr_b16 v[124:125], v72 offset:28672
    v_cvt_pk_bf16_f32 v238, v220, v221
    v_cvt_pk_bf16_f32 v239, v222, v223
    v_mfma_f32_16x16x32_bf16 v[136:139], v[108:111], a[24:27], v[136:139]
    buffer_store_dwordx4 v[236:239], v21, s[48:51], s86 offen offset:3072 sc1
    v_mfma_f32_16x16x32_bf16 v[140:143], v[104:107], a[12:15], 0
    ds_read_b64_tr_b16 v[126:127], v72 offset:29184
    s_lshl_b32 s87, s64, 10
    s_add_u32 s87, s87, 147456
    v_add_u32 v8, s87, v21
    v_and_b32 v9, 0xfffff7ff, v8
    v_mfma_f32_16x16x32_bf16 v[140:143], v[108:111], a[28:31], v[140:143]
    s_waitcnt lgkmcnt(4)
    s_lshl_b32 s86, s72, 1
    s_add_u32 s86, s86, s66
    s_add_u32 s86, s86, 56
    s_lshl_b32 s86, s86, 12
    s_add_u32 s86, s86, s85
    v_mfma_f32_16x16x32_bf16 v[156:159], v[112:115], a[12:15], 0
    ds_read_b64_tr_b16 v[104:105], v73 offset:24576
    v_mfma_f32_16x16x32_bf16 v[156:159], v[116:119], a[28:31], v[156:159]
    ds_read_b64_tr_b16 v[106:107], v73 offset:25088
    v_mfma_f32_16x16x32_bf16 v[152:155], v[112:115], a[8:11], 0
    ds_read_b64_tr_b16 v[108:109], v73 offset:28672
    v_mfma_f32_16x16x32_bf16 v[152:155], v[116:119], a[24:27], v[152:155]
    ds_read_b64_tr_b16 v[110:111], v73 offset:29184
    s_mov_b32 s69, 0
    s_atomic_add s69, s[48:49], s89 offset:0 glc
    v_mfma_f32_16x16x32_bf16 v[148:151], v[112:115], a[4:7], 0
    v_mfma_f32_16x16x32_bf16 v[148:151], v[116:119], a[20:23], v[148:151]
    v_mfma_f32_16x16x32_bf16 v[144:147], v[112:115], a[0:3], 0
    v_mfma_f32_16x16x32_bf16 v[144:147], v[116:119], a[16:19], v[144:147]
    ds_read_b32 v27, v22
    s_waitcnt lgkmcnt(1)
    s_barrier
    v_mfma_f32_16x16x32_bf16 v[128:131], v[120:123], a[32:35], v[128:131]
    ds_read_b64_tr_b16 v[112:113], v72 offset:32768
    v_mfma_f32_16x16x32_bf16 v[128:131], v[124:127], a[48:51], v[128:131]
    v_mfma_f32_16x16x32_bf16 v[132:135], v[120:123], a[36:39], v[132:135]
    ds_read_b64_tr_b16 v[114:115], v72 offset:33280
    v_mfma_f32_16x16x32_bf16 v[132:135], v[124:127], a[52:55], v[132:135]
    v_mfma_f32_16x16x32_bf16 v[136:139], v[120:123], a[40:43], v[136:139]
    ds_read_b64_tr_b16 v[116:117], v72 offset:36864
    v_mfma_f32_16x16x32_bf16 v[136:139], v[124:127], a[56:59], v[136:139]
    v_mfma_f32_16x16x32_bf16 v[140:143], v[120:123], a[44:47], v[140:143]
    ds_read_b64_tr_b16 v[118:119], v72 offset:37376
    v_mfma_f32_16x16x32_bf16 v[140:143], v[124:127], a[60:63], v[140:143]
    v_mfma_f32_16x16x32_bf16 v[156:159], v[104:107], a[44:47], v[156:159]
    ds_read_b64_tr_b16 v[120:121], v73 offset:32768
    v_mfma_f32_16x16x32_bf16 v[156:159], v[108:111], a[60:63], v[156:159]
    v_mfma_f32_16x16x32_bf16 v[152:155], v[104:107], a[40:43], v[152:155]
    ds_read_b64_tr_b16 v[122:123], v73 offset:33280
    v_mfma_f32_16x16x32_bf16 v[152:155], v[108:111], a[56:59], v[152:155]
    v_mfma_f32_16x16x32_bf16 v[148:151], v[104:107], a[36:39], v[148:151]
    ds_read_b64_tr_b16 v[124:125], v73 offset:36864
    v_mfma_f32_16x16x32_bf16 v[148:151], v[108:111], a[52:55], v[148:151]
    v_mfma_f32_16x16x32_bf16 v[144:147], v[104:107], a[32:35], v[144:147]
    ds_read_b64_tr_b16 v[126:127], v73 offset:37376
    v_mfma_f32_16x16x32_bf16 v[144:147], v[108:111], a[48:51], v[144:147]
    s_waitcnt lgkmcnt(4)
    v_mfma_f32_16x16x32_bf16 v[128:131], v[112:115], a[64:67], v[128:131]
    ds_read_b64_tr_b16 v[104:105], v72 offset:40960
    v_mfma_f32_16x16x32_bf16 v[128:131], v[116:119], a[80:83], v[128:131]
    buffer_load_dwordx4 v52, s[40:43], s78 offen offset:0  lds
    v_mfma_f32_16x16x32_bf16 v[132:135], v[112:115], a[68:71], v[132:135]
    ds_read_b64_tr_b16 v[106:107], v72 offset:41472
    v_mfma_f32_16x16x32_bf16 v[132:135], v[116:119], a[84:87], v[132:135]
    v_mfma_f32_16x16x32_bf16 v[136:139], v[112:115], a[72:75], v[136:139]
    ds_read_b64_tr_b16 v[108:109], v72 offset:45056
    v_mfma_f32_16x16x32_bf16 v[136:139], v[116:119], a[88:91], v[136:139]
    buffer_load_dwordx4 v53, s[40:43], s78 offen offset:1024  lds
    v_mfma_f32_16x16x32_bf16 v[140:143], v[112:115], a[76:79], v[140:143]
    ds_read_b64_tr_b16 v[110:111], v72 offset:45568
    v_mfma_f32_16x16x32_bf16 v[140:143], v[116:119], a[92:95], v[140:143]
    s_waitcnt lgkmcnt(4)
    v_mfma_f32_16x16x32_bf16 v[156:159], v[120:123], a[76:79], v[156:159]
    ds_read_b64_tr_b16 v[112:113], v73 offset:40960
    v_mfma_f32_16x16x32_bf16 v[156:159], v[124:127], a[92:95], v[156:159]
    ds_read_b64_tr_b16 v[114:115], v73 offset:41472
    v_mfma_f32_16x16x32_bf16 v[152:155], v[120:123], a[72:75], v[152:155]
    ds_read_b64_tr_b16 v[116:117], v73 offset:45056
    v_mfma_f32_16x16x32_bf16 v[152:155], v[124:127], a[88:91], v[152:155]
    ds_read_b64_tr_b16 v[118:119], v73 offset:45568
    v_mfma_f32_16x16x32_bf16 v[148:151], v[120:123], a[68:71], v[148:151]
    buffer_load_dwordx4 v54, s[40:43], s78 offen offset:2048  lds
    v_mfma_f32_16x16x32_bf16 v[148:151], v[124:127], a[84:87], v[148:151]
    v_mfma_f32_16x16x32_bf16 v[144:147], v[120:123], a[64:67], v[144:147]
    buffer_load_dwordx4 v55, s[40:43], s78 offen offset:3072  lds
    v_mfma_f32_16x16x32_bf16 v[144:147], v[124:127], a[80:83], v[144:147]
    ds_read_b32 v27, v22
    s_waitcnt vmcnt(28) lgkmcnt(1)
    s_barrier
    s_add_u32 m0, s74, 16384
    v_mfma_f32_16x16x32_bf16 v[128:131], v[104:107], a[96:99], v[128:131]
    ds_read_b64_tr_b16 v[120:121], v72 offset:49152
    s_add_u32 s78, s10, s11
    v_mfma_f32_16x16x32_bf16 v[128:131], v[108:111], a[112:115], v[128:131]
    s_add_u32 s78, s78, 32768
    buffer_load_dwordx4 v52, s[40:43], s78 offen offset:0  lds
    v_mfma_f32_16x16x32_bf16 v[132:135], v[104:107], a[100:103], v[132:135]
    ds_read_b64_tr_b16 v[122:123], v72 offset:49664
    v_mfma_f32_16x16x32_bf16 v[132:135], v[108:111], a[116:119], v[132:135]
    s_lshl_b32 s75, s90, 7
    s_add_u32 s75, s75, 9850880
    s_mov_b32 s67, 0
    s_atomic_add s67, s[48:49], s75 offset:0 glc
    v_mfma_f32_16x16x32_bf16 v[136:139], v[104:107], a[104:107], v[136:139]
    ds_read_b64_tr_b16 v[124:125], v72 offset:53248
    v_mfma_f32_16x16x32_bf16 v[136:139], v[108:111], a[120:123], v[136:139]
    buffer_load_dwordx4 v53, s[40:43], s78 offen offset:1024  lds
    s_waitcnt vmcnt(6)
    s_atomic_add s13, s[48:49], s88 offset:4 glc
    v_mfma_f32_16x16x32_bf16 v[140:143], v[104:107], a[108:111], v[140:143]
    ds_read_b64_tr_b16 v[126:127], v72 offset:53760
    v_mfma_f32_16x16x32_bf16 v[140:143], v[108:111], a[124:127], v[140:143]
    v_mfma_f32_16x16x32_bf16 v[156:159], v[112:115], a[108:111], v[156:159]
    ds_read_b64_tr_b16 v[104:105], v73 offset:49152
    v_mfma_f32_16x16x32_bf16 v[156:159], v[116:119], a[124:127], v[156:159]
    buffer_load_dwordx4 v54, s[40:43], s78 offen offset:2048  lds
    v_mfma_f32_16x16x32_bf16 v[152:155], v[112:115], a[104:107], v[152:155]
    ds_read_b64_tr_b16 v[106:107], v73 offset:49664
    v_mfma_f32_16x16x32_bf16 v[152:155], v[116:119], a[120:123], v[152:155]
    s_cmp_ge_u32 s69, 4
    s_cbranch_scc0 LA_slow1
LA_back1:
    s_add_u32 s80, s81, 0
    v_mfma_f32_16x16x32_bf16 v[148:151], v[112:115], a[100:103], v[148:151]
    ds_read_b64_tr_b16 v[108:109], v73 offset:53248
    v_mfma_f32_16x16x32_bf16 v[148:151], v[116:119], a[116:119], v[148:151]
    buffer_load_dwordx4 a[0:3], v56, s[48:51], s80 offen sc1
    v_mfma_f32_16x16x32_bf16 v[144:147], v[112:115], a[96:99], v[144:147]
    ds_read_b64_tr_b16 v[110:111], v73 offset:53760
    v_mfma_f32_16x16x32_bf16 v[144:147], v[116:119], a[112:115], v[144:147]
    s_waitcnt lgkmcnt(4)
    v_mfma_f32_16x16x32_bf16 v[128:131], v[120:123], a[128:131], v[128:131]
    ds_read_b64_tr_b16 v[112:113], v72 offset:57344
    v_mfma_f32_16x16x32_bf16 v[128:131], v[124:127], a[144:147], v[128:131]
    buffer_load_dwordx4 a[4:7], v57, s[48:51], s80 offen sc1
    v_mfma_f32_16x16x32_bf16 v[132:135], v[120:123], a[132:135], v[132:135]
    ds_read_b64_tr_b16 v[114:115], v72 offset:57856
    v_mfma_f32_16x16x32_bf16 v[132:135], v[124:127], a[148:151], v[132:135]
    buffer_load_dwordx4 a[8:11], v58, s[48:51], s80 offen sc1
    v_mfma_f32_16x16x32_bf16 v[136:139], v[120:123], a[136:139], v[136:139]
    ds_read_b64_tr_b16 v[116:117], v72 offset:61440
    v_mfma_f32_16x16x32_bf16 v[136:139], v[124:127], a[152:155], v[136:139]
    buffer_load_dwordx4 a[12:15], v59, s[48:51], s80 offen sc1
    v_mfma_f32_16x16x32_bf16 v[140:143], v[120:123], a[140:143], v[140:143]
    ds_read_b64_tr_b16 v[118:119], v72 offset:61952
    s_add_u32 s80, s81, 4096
LA_pg3:
    s_cbranch_execz LA_walked
    v_mfma_f32_16x16x32_bf16 v[140:143], v[124:127], a[156:159], v[140:143]
    s_waitcnt lgkmcnt(4)
    v_mfma_f32_16x16x32_bf16 v[156:159], v[104:107], a[140:143], v[156:159]
    ds_read_b64_tr_b16 v[120:121], v73 offset:57344
    v_mfma_f32_16x16x32_bf16 v[156:159], v[108:111], a[156:159], v[156:159]
    ds_read_b64_tr_b16 v[122:123], v73 offset:57856
    v_mfma_f32_16x16x32_bf16 v[152:155], v[104:107], a[136:139], v[152:155]
    ds_read_b64_tr_b16 v[124:125], v73 offset:61440
    v_mfma_f32_16x16x32_bf16 v[152:155], v[108:111], a[152:155], v[152:155]
    ds_read_b64_tr_b16 v[126:127], v73 offset:61952
    v_mfma_f32_16x16x32_bf16 v[148:151], v[104:107], a[132:135], v[148:151]
    buffer_load_dwordx4 a[16:19], v56, s[48:51], s80 offen sc1
    v_mfma_f32_16x16x32_bf16 v[148:151], v[108:111], a[148:151], v[148:151]
    v_mfma_f32_16x16x32_bf16 v[144:147], v[104:107], a[128:131], v[144:147]
    buffer_load_dwordx4 a[20:23], v57, s[48:51], s80 offen sc1
    v_mfma_f32_16x16x32_bf16 v[144:147], v[108:111], a[144:147], v[144:147]
    ds_read_b32 v27, v22
    ds_read_b32 v27, v22
    s_waitcnt lgkmcnt(2)
    s_barrier
    v_mfma_f32_16x16x32_bf16 v[128:131], v[112:115], a[160:163], v[128:131]
    ds_read_b64_tr_b16 v[104:105], v74 offset:0
    v_mfma_f32_16x16x32_bf16 v[128:131], v[116:119], a[176:179], v[128:131]
    buffer_load_dwordx4 a[24:27], v58, s[48:51], s80 offen sc1
    v_mfma_f32_16x16x32_bf16 v[132:135], v[112:115], a[164:167], v[132:135]
    ds_read_b64_tr_b16 v[106:107], v74 offset:512
    v_mfma_f32_16x16x32_bf16 v[132:135], v[116:119], a[180:183], v[132:135]
    buffer_load_dwordx4 a[28:31], v59, s[48:51], s80 offen sc1
    v_mfma_f32_16x16x32_bf16 v[136:139], v[112:115], a[168:171], v[136:139]
    ds_read_b64_tr_b16 v[108:109], v74 offset:4096
    v_mfma_f32_16x16x32_bf16 v[136:139], v[116:119], a[184:187], v[136:139]
    buffer_load_dwordx4 v55, s[40:43], s78 offen offset:3072  lds
    v_mfma_f32_16x16x32_bf16 v[140:143], v[112:115], a[172:175], v[140:143]
    ds_read_b64_tr_b16 v[110:111], v74 offset:4608
    s_add_u32 m0, s74, 32768
    v_mfma_f32_16x16x32_bf16 v[140:143], v[116:119], a[188:191], v[140:143]
    s_add_u32 s78, vcc_lo, vcc_hi
    v_mfma_f32_16x16x32_bf16 v[156:159], v[120:123], a[172:175], v[156:159]
    ds_read_b64_tr_b16 v[112:113], v75 offset:0
    v_mfma_f32_16x16x32_bf16 v[156:159], v[124:127], a[188:191], v[156:159]
    buffer_load_dwordx4 v52, s[40:43], s78 offen offset:0  lds
    v_mfma_f32_16x16x32_bf16 v[152:155], v[120:123], a[168:171], v[152:155]
    ds_read_b64_tr_b16 v[114:115], v75 offset:512
    s_cmp_ge_u32 s67, 16
    s_cbranch_scc0 LA_slow6
LA_back6:
    v_mfma_f32_16x16x32_bf16 v[152:155], v[124:127], a[184:187], v[152:155]
    s_lshl_b32 s73, s90, 10
    s_add_u32 s73, s73, 9699328
    v_and_b32 v26, 48, v20
    v_lshl_add_u32 v26, v22, 4, v26
    buffer_load_dwordx4 v[4:7], v26, s[48:51], s73 offen sc1
    v_mfma_f32_16x16x32_bf16 v[148:151], v[120:123], a[164:167], v[148:151]
    ds_read_b64_tr_b16 v[116:117], v75 offset:4096
    s_lshl_b32 s73, s90, 13
    v_mfma_f32_16x16x32_bf16 v[148:151], v[124:127], a[180:183], v[148:151]
    s_add_u32 s73, s73, 9437184
    buffer_load_dwordx4 v[160:163], v21, s[48:51], s73 offen offset:0 sc1
    v_mfma_f32_16x16x32_bf16 v[144:147], v[120:123], a[160:163], v[144:147]
    ds_read_b64_tr_b16 v[118:119], v75 offset:4608
    v_mfma_f32_16x16x32_bf16 v[144:147], v[124:127], a[176:179], v[144:147]
    s_waitcnt lgkmcnt(4)
    v_mfma_f32_16x16x32_bf16 v[128:131], v[104:107], a[192:195], v[128:131]
    ds_read_b64_tr_b16 v[120:121], v74 offset:8192
    v_mfma_f32_16x16x32_bf16 v[128:131], v[108:111], a[208:211], v[128:131]
    buffer_load_dwordx4 v[164:167], v21, s[48:51], s73 offen offset:1024 sc1
    v_mfma_f32_16x16x32_bf16 v[132:135], v[104:107], a[196:199], v[132:135]
    ds_read_b64_tr_b16 v[122:123], v74 offset:8704
    v_mfma_f32_16x16x32_bf16 v[132:135], v[108:111], a[212:215], v[132:135]
    buffer_load_dwordx4 v[168:171], v21, s[48:51], s73 offen offset:2048 sc1
    v_mfma_f32_16x16x32_bf16 v[136:139], v[104:107], a[200:203], v[136:139]
    ds_read_b64_tr_b16 v[124:125], v74 offset:12288
    v_mfma_f32_16x16x32_bf16 v[136:139], v[108:111], a[216:219], v[136:139]
    buffer_load_dwordx4 v[172:175], v21, s[48:51], s73 offen offset:3072 sc1
    v_mfma_f32_16x16x32_bf16 v[140:143], v[104:107], a[204:207], v[140:143]
    ds_read_b64_tr_b16 v[126:127], v74 offset:12800
    s_add_u32 s73, s73, 4096
    v_mfma_f32_16x16x32_bf16 v[140:143], v[108:111], a[220:223], v[140:143]
    s_waitcnt lgkmcnt(4)
    v_mfma_f32_16x16x32_bf16 v[156:159], v[112:115], a[204:207], v[156:159]
    ds_read_b64_tr_b16 v[104:105], v75 offset:8192
    v_mfma_f32_16x16x32_bf16 v[156:159], v[116:119], a[220:223], v[156:159]
    ds_read_b64_tr_b16 v[106:107], v75 offset:8704
    v_mfma_f32_16x16x32_bf16 v[152:155], v[112:115], a[200:203], v[152:155]
    ds_read_b64_tr_b16 v[108:109], v75 offset:12288
    v_mfma_f32_16x16x32_bf16 v[152:155], v[116:119], a[216:219], v[152:155]
    ds_read_b64_tr_b16 v[110:111], v75 offset:12800
    v_mfma_f32_16x16x32_bf16 v[148:151], v[112:115], a[196:199], v[148:151]
    buffer_load_dwordx4 v[176:179], v21, s[48:51], s73 offen offset:0 sc1
    v_mfma_f32_16x16x32_bf16 v[148:151], v[116:119], a[212:215], v[148:151]
    buffer_load_dwordx4 v[180:183], v21, s[48:51], s73 offen offset:1024 sc1
    v_mfma_f32_16x16x32_bf16 v[144:147], v[112:115], a[192:195], v[144:147]
    buffer_load_dwordx4 v[184:187], v21, s[48:51], s73 offen offset:2048 sc1
    v_mfma_f32_16x16x32_bf16 v[144:147], v[116:119], a[208:211], v[144:147]
    s_waitcnt lgkmcnt(0)
    s_barrier
    v_mfma_f32_16x16x32_bf16 v[128:131], v[120:123], a[224:227], v[128:131]
    ds_read_b64_tr_b16 v[112:113], v88 offset:0
    v_mfma_f32_16x16x32_bf16 v[128:131], v[124:127], a[240:243], v[128:131]
    buffer_load_dwordx4 v[188:191], v21, s[48:51], s73 offen offset:3072 sc1
    v_mfma_f32_16x16x32_bf16 v[132:135], v[120:123], a[228:231], v[132:135]
    ds_read_b64_tr_b16 v[114:115], v88 offset:512
    s_add_u32 s80, s18, 8192
    v_mfma_f32_16x16x32_bf16 v[132:135], v[124:127], a[244:247], v[132:135]
    buffer_load_dwordx4 a[32:35], v56, s[48:51], s80 offen sc1
    v_mfma_f32_16x16x32_bf16 v[136:139], v[120:123], a[232:235], v[136:139]
    ds_read_b64_tr_b16 v[116:117], v84 offset:16384
    v_mfma_f32_16x16x32_bf16 v[136:139], v[124:127], a[248:251], v[136:139]
    buffer_load_dwordx4 a[36:39], v57, s[48:51], s80 offen sc1
    v_mfma_f32_16x16x32_bf16 v[140:143], v[120:123], a[236:239], v[140:143]
    ds_read_b64_tr_b16 v[118:119], v84 offset:16896
    v_mfma_f32_16x16x32_bf16 v[140:143], v[124:127], a[252:255], v[140:143]
    v_mfma_f32_16x16x32_bf16 v[156:159], v[104:107], a[236:239], v[156:159]
    ds_read_b64_tr_b16 v[120:121], v89 offset:0
    v_mfma_f32_16x16x32_bf16 v[156:159], v[108:111], a[252:255], v[156:159]
    buffer_load_dwordx4 a[40:43], v58, s[48:51], s80 offen sc1
    v_mfma_f32_16x16x32_bf16 v[152:155], v[104:107], a[232:235], v[152:155]
    ds_read_b64_tr_b16 v[122:123], v89 offset:512
    v_mfma_f32_16x16x32_bf16 v[152:155], v[108:111], a[248:251], v[152:155]
    buffer_load_dwordx4 a[44:47], v59, s[48:51], s80 offen sc1
    s_mov_b32 s65, 0
    s_atomic_add s65, s[48:49], s89 offset:4 glc
    v_mfma_f32_16x16x32_bf16 v[148:151], v[104:107], a[228:231], v[148:151]
    ds_read_b64_tr_b16 v[124:125], v85 offset:16384
    s_add_u32 s80, s18, 12288
    v_mfma_f32_16x16x32_bf16 v[148:151], v[108:111], a[244:247], v[148:151]
    buffer_load_dwordx4 a[48:51], v56, s[48:51], s80 offen sc1
    v_mfma_f32_16x16x32_bf16 v[144:147], v[104:107], a[224:227], v[144:147]
    ds_read_b64_tr_b16 v[126:127], v85 offset:16896
    v_mfma_f32_16x16x32_bf16 v[144:147], v[108:111], a[240:243], v[144:147]
    s_waitcnt vmcnt(16) lgkmcnt(4)
    s_barrier
    v_mfma_f32_16x16x32_bf16 v[192:195], v[112:115], a[0:3], 0
    ds_read_b64_tr_b16 v[104:105], v90 offset:0
    v_mfma_f32_16x16x32_bf16 v[192:195], v[116:119], a[16:19], v[192:195]
    buffer_load_dwordx4 a[52:55], v57, s[48:51], s80 offen sc1
    v_mfma_f32_16x16x32_bf16 v[196:199], v[112:115], a[4:7], 0
    ds_read_b64_tr_b16 v[106:107], v90 offset:512
    v_mfma_f32_16x16x32_bf16 v[196:199], v[116:119], a[20:23], v[196:199]
    buffer_load_dwordx4 a[56:59], v58, s[48:51], s80 offen sc1
    s_waitcnt vmcnt(15)
    v_add_f32_dpp v4, v4, v4 row_ror:8 row_mask:0xf bank_mask:0xf
    v_add_f32_dpp v5, v5, v5 row_ror:8 row_mask:0xf bank_mask:0xf
    v_add_f32_dpp v6, v6, v6 row_ror:8 row_mask:0xf bank_mask:0xf
    v_add_f32_dpp v7, v7, v7 row_ror:8 row_mask:0xf bank_mask:0xf
    v_add_f32_dpp v4, v4, v4 row_ror:4 row_mask:0xf bank_mask:0xf
    v_add_f32_dpp v5, v5, v5 row_ror:4 row_mask:0xf bank_mask:0xf
    v_mfma_f32_16x16x32_bf16 v[200:203], v[112:115], a[8:11], 0
    ds_read_b64_tr_b16 v[108:109], v86 offset:16384
    v_add_f32_dpp v6, v6, v6 row_ror:4 row_mask:0xf bank_mask:0xf
    v_add_f32_dpp v7, v7, v7 row_ror:4 row_mask:0xf bank_mask:0xf
    v_add_f32_dpp v4, v4, v4 row_ror:2 row_mask:0xf bank_mask:0xf
    v_add_f32_dpp v5, v5, v5 row_ror:2 row_mask:0xf bank_mask:0xf
    v_add_f32_dpp v6, v6, v6 row_ror:2 row_mask:0xf bank_mask:0xf
    v_add_f32_dpp v7, v7, v7 row_ror:2 row_mask:0xf bank_mask:0xf
    v_add_f32_dpp v4, v4, v4 row_ror:1 row_mask:0xf bank_mask:0xf
    v_mfma_f32_16x16x32_bf16 v[200:203], v[116:119], a[24:27], v[200:203]
    buffer_load_dwordx4 a[60:63], v59, s[48:51], s80 offen sc1
    v_add_f32_dpp v5, v5, v5 row_ror:1 row_mask:0xf bank_mask:0xf
    v_add_f32_dpp v6, v6, v6 row_ror:1 row_mask:0xf bank_mask:0xf
    v_add_f32_dpp v7, v7, v7 row_ror:1 row_mask:0xf bank_mask:0xf
    v_mfma_f32_16x16x32_bf16 v[204:207], v[112:115], a[12:15], 0
    ds_read_b64_tr_b16 v[110:111], v86 offset:16896
    s_waitcnt vmcnt(15)
    v_mfma_f32_16x16x32_bf16 v[12:15], v[92:95], v[160:163], 0
    v_mfma_f32_16x16x32_bf16 v[204:207], v[116:119], a[28:31], v[204:207]
    s_waitcnt lgkmcnt(4)
    buffer_load_dwordx4 v53, s[40:43], s78 offen offset:1024  lds
    s_waitcnt vmcnt(15)
    v_mfma_f32_16x16x32_bf16 v[12:15], v[92:95], v[164:167], v[12:15]
    v_mfma_f32_16x16x32_bf16 v[220:223], v[120:123], a[12:15], 0
    ds_read_b64_tr_b16 v[112:113], v91 offset:0
    s_waitcnt vmcnt(14)
    v_mfma_f32_16x16x32_bf16 v[12:15], v[92:95], v[168:171], v[12:15]
    v_mfma_f32_16x16x32_bf16 v[220:223], v[124:127], a[28:31], v[220:223]
    buffer_load_dwordx4 v54, s[40:43], s78 offen offset:2048  lds
    s_waitcnt vmcnt(14)
    v_mfma_f32_16x16x32_bf16 v[12:15], v[92:95], v[172:175], v[12:15]
    v_mfma_f32_16x16x32_bf16 v[216:219], v[120:123], a[8:11], 0
    ds_read_b64_tr_b16 v[114:115], v91 offset:512
    v_mfma_f32_16x16x32_bf16 v[216:219], v[124:127], a[24:27], v[216:219]
    buffer_load_dwordx4 v55, s[40:43], s78 offen offset:3072  lds
    s_waitcnt vmcnt(14)
    v_mfma_f32_16x16x32_bf16 v[12:15], v[92:95], v[176:179], v[12:15]
    v_mfma_f32_16x16x32_bf16 v[212:215], v[120:123], a[4:7], 0
    ds_read_b64_tr_b16 v[116:117], v87 offset:16384
    s_add_u32 m0, s74, 49152
    v_mfma_f32_16x16x32_bf16 v[212:215], v[124:127], a[20:23], v[212:215]
    s_add_u32 s78, vcc_lo, vcc_hi
    s_add_u32 s78, s78, 32768
    buffer_load_dwordx4 v52, s[40:43], s78 offen offset:0  lds
    s_waitcnt vmcnt(14)
    v_mfma_f32_16x16x32_bf16 v[12:15], v[92:95], v[180:183], v[12:15]
    v_mfma_f32_16x16x32_bf16 v[208:211], v[120:123], a[0:3], 0
    ds_read_b64_tr_b16 v[118:119], v87 offset:16896
    v_mfma_f32_16x16x32_bf16 v[208:211], v[124:127], a[16:19], v[208:211]
    s_waitcnt lgkmcnt(4)
    v_mfma_f32_16x16x32_bf16 v[224:227], v[104:107], a[0:3], 0
    ds_read_b64_tr_b16 v[120:121], v84 offset:49152
    v_mfma_f32_16x16x32_bf16 v[224:227], v[108:111], a[16:19], v[224:227]
    buffer_load_dwordx4 v53, s[40:43], s78 offen offset:1024  lds
    s_waitcnt vmcnt(14)
    v_mfma_f32_16x16x32_bf16 v[12:15], v[92:95], v[184:187], v[12:15]
    v_mfma_f32_16x16x32_bf16 v[228:231], v[104:107], a[4:7], 0
    ds_read_b64_tr_b16 v[122:123], v84 offset:49664
    v_mfma_f32_16x16x32_bf16 v[228:231], v[108:111], a[20:23], v[228:231]
    buffer_load_dwordx4 v54, s[40:43], s78 offen offset:2048  lds
    s_waitcnt vmcnt(14)
    v_mfma_f32_16x16x32_bf16 v[12:15], v[92:95], v[188:191], v[12:15]
    v_cvt_pk_bf16_f32 v18, v4, v5
    v_cvt_pk_bf16_f32 v19, v6, v7
    v_mfma_f32_16x16x32_bf16 v[232:235], v[104:107], a[8:11], 0
    ds_read_b64_tr_b16 v[124:125], v84 offset:32768
    v_mfma_f32_16x16x32_bf16 v[232:235], v[108:111], a[24:27], v[232:235]
    buffer_load_dwordx4 v55, s[40:43], s78 offen offset:3072  lds
    s_nop 1
    v_cvt_pk_bf16_f32 v16, v12, v13
    v_cvt_pk_bf16_f32 v17, v14, v15
    v_mfma_f32_16x16x32_bf16 v[236:239], v[104:107], a[12:15], 0
    ds_read_b64_tr_b16 v[126:127], v84 offset:33280
    s_add_u32 m0, s74, 65536
    ds_write_b128 v8, v[16:19]
    v_mfma_f32_16x16x32_bf16 v[236:239], v[108:111], a[28:31], v[236:239]
    s_waitcnt lgkmcnt(5)
    s_mul_i32 s78, s11, 3
    s_add_u32 s78, s78, s10
    buffer_load_dwordx4 v52, s[40:43], s78 offen offset:0  lds
    v_mfma_f32_16x16x32_bf16 v[252:255], v[112:115], a[12:15], 0
    ds_read_b64_tr_b16 v[104:105], v85 offset:49152
    s_cmp_ge_u32 s65, 8
    s_cbranch_scc0 LA_slow2
LA_back2:
    s_waitcnt lgkmcnt(1)
    s_barrier
    ds_read_b128 v[96:99], v9
    ds_read_b128 v[100:103], v9 offset:2048
    v_mfma_f32_16x16x32_bf16 v[252:255], v[116:119], a[28:31], v[252:255]
    s_add_u32 s80, s81, 131072
    buffer_load_dwordx4 a[64:67], v56, s[48:51], s80 offen sc1
    v_mul_f32 v28, 0x3fb8aa3b, v128
    v_mul_f32 v29, 0x3fb8aa3b, v129
    v_mul_f32 v30, 0x3fb8aa3b, v130
    v_mul_f32 v31, 0x3fb8aa3b, v131
    v_mfma_f32_16x16x32_bf16 v[248:251], v[112:115], a[8:11], 0
    ds_read_b64_tr_b16 v[106:107], v85 offset:49664
    v_exp_f32 v28, v28 clamp
    v_max_f32 v128, 0x358637bd, v128
    v_exp_f32 v29, v29 clamp
    v_max_f32 v129, 0x358637bd, v129
    v_mfma_f32_16x16x32_bf16 v[248:251], v[116:119], a[24:27], v[248:251]
    buffer_load_dwordx4 a[68:71], v57, s[48:51], s80 offen sc1
    v_exp_f32 v30, v30 clamp
    v_max_f32 v130, 0x358637bd, v130
    v_exp_f32 v31, v31 clamp
    v_max_f32 v131, 0x358637bd, v131
    v_mfma_f32_16x16x32_bf16 v[244:247], v[112:115], a[4:7], 0
    ds_read_b64_tr_b16 v[108:109], v85 offset:32768
    v_add_f32 v128, v128, v28
    v_add_f32 v129, v129, v29
    v_add_f32 v130, v130, v30
    v_add_f32 v131, v131, v31
    v_cvt_pk_bf16_f32 v128, v128, v129
    v_cvt_pk_bf16_f32 v129, v130, v131
    v_mul_f32 v28, 0x3fb8aa3b, v132
    v_mfma_f32_16x16x32_bf16 v[244:247], v[116:119], a[20:23], v[244:247]
    buffer_load_dwordx4 a[72:75], v58, s[48:51], s80 offen sc1
    v_mul_f32 v29, 0x3fb8aa3b, v133
    v_mul_f32 v30, 0x3fb8aa3b, v134
    v_mul_f32 v31, 0x3fb8aa3b, v135
    v_exp_f32 v28, v28 clamp
    v_max_f32 v132, 0x358637bd, v132
    v_mfma_f32_16x16x32_bf16 v[240:243], v[112:115], a[0:3], 0
    ds_read_b64_tr_b16 v[110:111], v85 offset:33280
    v_exp_f32 v29, v29 clamp
    v_max_f32 v133, 0x358637bd, v133
    v_exp_f32 v30, v30 clamp
    v_max_f32 v134, 0x358637bd, v134
    v_mfma_f32_16x16x32_bf16 v[240:243], v[116:119], a[16:19], v[240:243]
    s_waitcnt vmcnt(11)
    buffer_load_dwordx4 a[76:79], v59, s[48:51], s80 offen sc1
    v_exp_f32 v31, v31 clamp
    v_max_f32 v135, 0x358637bd, v135
    v_add_f32 v132, v132, v28
    v_add_f32 v133, v133, v29
    v_mfma_f32_16x16x32_bf16 v[192:195], v[120:123], a[32:35], v[192:195]
    ds_read_b64_tr_b16 v[112:113], v86 offset:49152
    s_add_u32 s80, s81, 135168
    v_add_f32 v134, v134, v30
    v_add_f32 v135, v135, v31
    v_cvt_pk_bf16_f32 v132, v132, v133
    v_cvt_pk_bf16_f32 v133, v134, v135
    v_mul_f32 v28, 0x3fb8aa3b, v136
    v_mul_f32 v29, 0x3fb8aa3b, v137
    v_mfma_f32_16x16x32_bf16 v[192:195], v[124:127], a[48:51], v[192:195]
    buffer_load_dwordx4 a[80:83], v56, s[48:51], s80 offen sc1
    v_mul_f32 v30, 0x3fb8aa3b, v138
    v_mul_f32 v31, 0x3fb8aa3b, v139
    v_exp_f32 v28, v28 clamp
    v_max_f32 v136, 0x358637bd, v136
    v_mfma_f32_16x16x32_bf16 v[196:199], v[120:123], a[36:39], v[196:199]
    ds_read_b64_tr_b16 v[114:115], v86 offset:49664
    v_exp_f32 v29, v29 clamp
    v_max_f32 v137, 0x358637bd, v137
    v_exp_f32 v30, v30 clamp
    v_max_f32 v138, 0x358637bd, v138
    v_mfma_f32_16x16x32_bf16 v[196:199], v[124:127], a[52:55], v[196:199]
    buffer_load_dwordx4 a[84:87], v57, s[48:51], s80 offen sc1
    v_exp_f32 v31, v31 clamp
    v_max_f32 v139, 0x358637bd, v139
    v_add_f32 v136, v136, v28
    v_add_f32 v137, v137, v29
    v_add_f32 v138, v138, v30
    v_mfma_f32_16x16x32_bf16 v[200:203], v[120:123], a[40:43], v[200:203]
    ds_read_b64_tr_b16 v[116:117], v86 offset:32768
    v_add_f32 v139, v139, v31
    v_cvt_pk_bf16_f32 v136, v136, v137
    v_cvt_pk_bf16_f32 v137, v138, v139
    v_mul_f32 v28, 0x3fb8aa3b, v140
    v_mul_f32 v29, 0x3fb8aa3b, v141
    v_mul_f32 v30, 0x3fb8aa3b, v142
    v_mul_f32 v31, 0x3fb8aa3b, v143
    v_mfma_f32_16x16x32_bf16 v[200:203], v[124:127], a[56:59], v[200:203]
    buffer_load_dwordx4 a[88:91], v58, s[48:51], s80 offen sc1
    v_exp_f32 v28, v28 clamp
    v_max_f32 v140, 0x358637bd, v140
    v_exp_f32 v29, v29 clamp
    v_max_f32 v141, 0x358637bd, v141
    v_mfma_f32_16x16x32_bf16 v[204:207], v[120:123], a[44:47], v[204:207]
    ds_read_b64_tr_b16 v[118:119], v86 offset:33280
    v_exp_f32 v30, v30 clamp
    v_max_f32 v142, 0x358637bd, v142
    v_exp_f32 v31, v31 clamp
    v_max_f32 v143, 0x358637bd, v143
    v_add_f32 v140, v140, v28
    v_mfma_f32_16x16x32_bf16 v[204:207], v[124:127], a[60:63], v[204:207]
    s_waitcnt lgkmcnt(4)
    buffer_load_dwordx4 a[92:95], v59, s[48:51], s80 offen sc1
    v_add_f32 v141, v141, v29
    v_add_f32 v142, v142, v30
    v_add_f32 v143, v143, v31
    v_cvt_pk_bf16_f32 v140, v140, v141
    v_cvt_pk_bf16_f32 v141, v142, v143
    v_mfma_f32_16x16x32_bf16 v[220:223], v[104:107], a[44:47], v[220:223]
    ds_read_b64_tr_b16 v[120:121], v87 offset:49152
    s_add_u32 s80, s18, 139264
    v_mul_f32 v28, 0x3fb8aa3b, v156
    v_mul_f32 v29, 0x3fb8aa3b, v157
    v_mul_f32 v30, 0x3fb8aa3b, v158
    v_mul_f32 v31, 0x3fb8aa3b, v159
    v_exp_f32 v28, v28 clamp
    v_mfma_f32_16x16x32_bf16 v[220:223], v[108:111], a[60:63], v[220:223]
    buffer_load_dwordx4 a[96:99], v56, s[48:51], s80 offen sc1
    v_max_f32 v156, 0x358637bd, v156
    v_exp_f32 v29, v29 clamp
    v_max_f32 v157, 0x358637bd, v157
    v_exp_f32 v30, v30 clamp
    v_mfma_f32_16x16x32_bf16 v[216:219], v[104:107], a[40:43], v[216:219]
    ds_read_b64_tr_b16 v[122:123], v87 offset:49664
    v_max_f32 v158, 0x358637bd, v158
    v_exp_f32 v31, v31 clamp
    v_max_f32 v159, 0x358637bd, v159
    v_add_f32 v156, v156, v28
    v_add_f32 v157, v157, v29
    v_add_f32 v158, v158, v30
    v_mfma_f32_16x16x32_bf16 v[216:219], v[108:111], a[56:59], v[216:219]
    buffer_load_dwordx4 a[100:103], v57, s[48:51], s80 offen sc1
    v_add_f32 v159, v159, v31
    v_cvt_pk_bf16_f32 v156, v156, v157
    v_cvt_pk_bf16_f32 v157, v158, v159
    v_mul_f32 v28, 0x3fb8aa3b, v152
    v_mul_f32 v29, 0x3fb8aa3b, v153
    v_mul_f32 v30, 0x3fb8aa3b, v154
    v_mfma_f32_16x16x32_bf16 v[212:215], v[104:107], a[36:39], v[212:215]
    ds_read_b64_tr_b16 v[124:125], v87 offset:32768
    v_mul_f32 v31, 0x3fb8aa3b, v155
    v_exp_f32 v28, v28 clamp
    v_max_f32 v152, 0x358637bd, v152
    v_exp_f32 v29, v29 clamp
    v_max_f32 v153, 0x358637bd, v153
    v_mfma_f32_16x16x32_bf16 v[212:215], v[108:111], a[52:55], v[212:215]
    buffer_load_dwordx4 a[104:107], v58, s[48:51], s80 offen sc1
    v_exp_f32 v30, v30 clamp
    v_max_f32 v154, 0x358637bd, v154
    v_exp_f32 v31, v31 clamp
    v_max_f32 v155, 0x358637bd, v155
    v_mfma_f32_16x16x32_bf16 v[208:211], v[104:107], a[32:35], v[208:211]
    ds_read_b64_tr_b16 v[126:127], v87 offset:33280
    v_add_f32 v152, v152, v28
    v_add_f32 v153, v153, v29
    v_add_f32 v154, v154, v30
    v_add_f32 v155, v155, v31
    v_cvt_pk_bf16_f32 v152, v152, v153
    v_cvt_pk_bf16_f32 v153, v154, v155
    v_mul_f32 v28, 0x3fb8aa3b, v148
    v_mfma_f32_16x16x32_bf16 v[208:211], v[108:111], a[48:51], v[208:211]
    s_waitcnt lgkmcnt(4)
    buffer_load_dwordx4 a[108:111], v59, s[48:51], s80 offen sc1
    v_mul_f32 v29, 0x3fb8aa3b, v149
    v_mul_f32 v30, 0x3fb8aa3b, v150
    v_mul_f32 v31, 0x3fb8aa3b, v151
    v_exp_f32 v28, v28 clamp
    v_mfma_f32_16x16x32_bf16 v[224:227], v[112:115], a[32:35], v[224:227]
    ds_read_b64_tr_b16 v[104:105], v80 offset:0
    s_add_u32 s80, s18, 143360
    v_max_f32 v148, 0x358637bd, v148
    v_exp_f32 v29, v29 clamp
    v_max_f32 v149, 0x358637bd, v149
    v_exp_f32 v30, v30 clamp
    v_mfma_f32_16x16x32_bf16 v[224:227], v[116:119], a[48:51], v[224:227]
    buffer_load_dwordx4 a[112:115], v56, s[48:51], s80 offen sc1
    v_max_f32 v150, 0x358637bd, v150
    v_exp_f32 v31, v31 clamp
    v_max_f32 v151, 0x358637bd, v151
    v_add_f32 v148, v148, v28
    v_add_f32 v149, v149, v29
    v_mfma_f32_16x16x32_bf16 v[228:231], v[112:115], a[36:39], v[228:231]
    ds_read_b64_tr_b16 v[106:107], v80 offset:512
    v_add_f32 v150, v150, v30
    v_add_f32 v151, v151, v31
    v_cvt_pk_bf16_f32 v148, v148, v149
    v_cvt_pk_bf16_f32 v149, v150, v151
    v_mul_f32 v28, 0x3fb8aa3b, v144
    v_mul_f32 v29, 0x3fb8aa3b, v145
    v_mul_f32 v30, 0x3fb8aa3b, v146
    v_mfma_f32_16x16x32_bf16 v[228:231], v[116:119], a[52:55], v[228:231]
    buffer_load_dwordx4 a[116:119], v57, s[48:51], s80 offen sc1
    v_mul_f32 v31, 0x3fb8aa3b, v147
    v_exp_f32 v28, v28 clamp
    v_max_f32 v144, 0x358637bd, v144
    v_exp_f32 v29, v29 clamp
    v_mfma_f32_16x16x32_bf16 v[232:235], v[112:115], a[40:43], v[232:235]
    ds_read_b64_tr_b16 v[108:109], v80 offset:16384
    v_max_f32 v145, 0x358637bd, v145
    v_exp_f32 v30, v30 clamp
    v_max_f32 v146, 0x358637bd, v146
    v_exp_f32 v31, v31 clamp
    v_max_f32 v147, 0x358637bd, v147
    v_mfma_f32_16x16x32_bf16 v[232:235], v[116:119], a[56:59], v[232:235]
    buffer_load_dwordx4 a[120:123], v58, s[48:51], s80 offen sc1
    v_add_f32 v144, v144, v28
    v_add_f32 v145, v145, v29
    v_add_f32 v146, v146, v30
    v_add_f32 v147, v147, v31
    v_cvt_pk_bf16_f32 v144, v144, v145
    v_cvt_pk_bf16_f32 v145, v146, v147
    v_mfma_f32_16x16x32_bf16 v[236:239], v[112:115], a[44:47], v[236:239]
    ds_read_b64_tr_b16 v[110:111], v80 offset:16896
    v_mfma_f32_16x16x16_bf16 v[164:167], v[98:99], v[128:129], 0
    v_mfma_f32_16x16x16_bf16 v[172:175], v[102:103], v[144:145], 0
    v_mfma_f32_16x16x16_bf16 v[180:183], v[98:99], v[132:133], 0
    v_mfma_f32_16x16x16_bf16 v[188:191], v[102:103], v[148:149], 0
    v_mfma_f32_16x16x16_bf16 v[160:163], v[96:97], v[128:129], 0
    v_mfma_f32_16x16x16_bf16 v[168:171], v[100:101], v[144:145], 0
    v_mfma_f32_16x16x16_bf16 v[176:179], v[96:97], v[132:133], 0
    v_mfma_f32_16x16x16_bf16 v[184:187], v[100:101], v[148:149], 0
    v_mfma_f32_16x16x32_bf16 v[236:239], v[116:119], a[60:63], v[236:239]
    s_waitcnt lgkmcnt(4)
    buffer_load_dwordx4 a[124:127], v59, s[48:51], s80 offen sc1
    v_add_f32 v164, 0x358637bd, v164
    v_add_f32 v172, 0x358637bd, v172
    v_add_f32 v180, 0x358637bd, v180
    v_add_f32 v188, 0x358637bd, v188
    v_mfma_f32_16x16x32_bf16 v[252:255], v[120:123], a[44:47], v[252:255]
    ds_read_b64_tr_b16 v[112:113], v81 offset:0
    s_add_u32 s80, s81, 65536
    v_rcp_f32 v164, v164
    v_rcp_f32 v172, v172
    v_rcp_f32 v180, v180
    v_mfma_f32_16x16x32_bf16 v[252:255], v[124:127], a[60:63], v[252:255]
    buffer_load_dwordx4 v53, s[40:43], s78 offen offset:1024  lds
    v_rcp_f32 v188, v188
    v_mul_f32 v160, v160, v164
    v_mul_f32 v161, v161, v164
    v_mul_f32 v162, v162, v164
    v_mul_f32 v163, v163, v164
    v_mfma_f32_16x16x32_bf16 v[248:251], v[120:123], a[40:43], v[248:251]
    ds_read_b64_tr_b16 v[114:115], v81 offset:512
    buffer_load_dwordx4 v54, s[40:43], s78 offen offset:2048  lds
    v_mul_f32 v168, v168, v172
    v_mul_f32 v169, v169, v172
    v_mul_f32 v170, v170, v172
    v_mul_f32 v171, v171, v172
    v_mfma_f32_16x16x32_bf16 v[248:251], v[124:127], a[56:59], v[248:251]
    buffer_load_dwordx4 v55, s[40:43], s78 offen offset:3072  lds
    s_lshl_b32 s76, s70, 7
    s_add_u32 s76, s76, 9846784
    s_mov_b32 s67, 0
    s_atomic_add s67, s[48:49], s76 offset:0 glc
    v_mul_f32 v176, v176, v180
    v_mul_f32 v177, v177, v180
    v_mfma_f32_16x16x32_bf16 v[244:247], v[120:123], a[36:39], v[244:247]
    ds_read_b64_tr_b16 v[116:117], v81 offset:16384
    s_add_u32 m0, s74, 81920
    v_mul_f32 v178, v178, v180
    v_mul_f32 v179, v179, v180
    v_mul_f32 v184, v184, v188
    v_mul_f32 v185, v185, v188
    v_mul_f32 v186, v186, v188
    v_mul_f32 v187, v187, v188
    v_mfma_f32_16x16x32_bf16 v[244:247], v[124:127], a[52:55], v[244:247]
    s_mul_i32 s78, s11, 3
    s_add_u32 s78, s78, s10
    s_add_u32 s78, s78, 32768
    buffer_load_dwordx4 v52, s[40:43], s78 offen offset:0  lds
    v_cvt_pk_bf16_f32 v128, v160, v161
    v_cvt_pk_bf16_f32 v129, v162, v163
    v_cvt_pk_bf16_f32 v130, v168, v169
    v_mfma_f32_16x16x32_bf16 v[240:243], v[120:123], a[32:35], v[240:243]
    ds_read_b64_tr_b16 v[118:119], v81 offset:16896
    buffer_load_dwordx4 v53, s[40:43], s78 offen offset:1024  lds
    v_cvt_pk_bf16_f32 v131, v170, v171
    v_mfma_f32_16x16x32_bf16 v[240:243], v[124:127], a[48:51], v[240:243]
    s_waitcnt vmcnt(13) lgkmcnt(4)
    buffer_load_dwordx4 v54, s[40:43], s78 offen offset:2048  lds
    v_mfma_f32_16x16x32_bf16 v[192:195], v[104:107], a[64:67], v[192:195]
    ds_read_b64_tr_b16 v[120:121], v82 offset:0
    buffer_store_dwordx4 v[128:131], v21, s[48:51], s86 offen offset:0 sc1
    v_mfma_f32_16x16x32_bf16 v[192:195], v[108:111], a[80:83], v[192:195]
    buffer_load_dwordx4 v55, s[40:43], s78 offen offset:3072  lds
    v_cvt_pk_bf16_f32 v132, v176, v177
    v_cvt_pk_bf16_f32 v133, v178, v179
    v_cvt_pk_bf16_f32 v134, v184, v185
    v_cvt_pk_bf16_f32 v135, v186, v187
    v_mfma_f32_16x16x32_bf16 v[196:199], v[104:107], a[68:71], v[196:199]
    ds_read_b64_tr_b16 v[122:123], v82 offset:512
    s_add_u32 m0, s74, 131072
    buffer_store_dwordx4 v[132:135], v21, s[48:51], s86 offen offset:1024 sc1
    v_mfma_f32_16x16x32_bf16 v[196:199], v[108:111], a[84:87], v[196:199]
    buffer_load_dwordx4 a[128:131], v56, s[48:51], s80 offen sc1
    v_mfma_f32_16x16x16_bf16 v[164:167], v[98:99], v[136:137], 0
    v_mfma_f32_16x16x16_bf16 v[172:175], v[102:103], v[152:153], 0
    v_mfma_f32_16x16x16_bf16 v[180:183], v[98:99], v[140:141], 0
    v_mfma_f32_16x16x16_bf16 v[188:191], v[102:103], v[156:157], 0
    v_mfma_f32_16x16x16_bf16 v[160:163], v[96:97], v[136:137], 0
    v_mfma_f32_16x16x16_bf16 v[168:171], v[100:101], v[152:153], 0
    v_mfma_f32_16x16x16_bf16 v[176:179], v[96:97], v[140:141], 0
    v_mfma_f32_16x16x16_bf16 v[184:187], v[100:101], v[156:157], 0
    v_mfma_f32_16x16x32_bf16 v[200:203], v[104:107], a[72:75], v[200:203]
    ds_read_b64_tr_b16 v[124:125], v82 offset:16384
    s_mul_i32 s78, vcc_hi, 3
    v_add_f32 v164, 0x358637bd, v164
    v_add_f32 v172, 0x358637bd, v172
    v_add_f32 v180, 0x358637bd, v180
    v_add_f32 v188, 0x358637bd, v188
    v_rcp_f32 v164, v164
    v_mfma_f32_16x16x32_bf16 v[200:203], v[108:111], a[88:91], v[200:203]
    buffer_load_dwordx4 a[132:135], v57, s[48:51], s80 offen sc1
    v_rcp_f32 v172, v172
    v_rcp_f32 v180, v180
    v_rcp_f32 v188, v188
    v_mfma_f32_16x16x32_bf16 v[204:207], v[104:107], a[76:79], v[204:207]
    ds_read_b64_tr_b16 v[126:127], v82 offset:16896
    s_add_u32 s78, s78, vcc_lo
    v_mul_f32 v160, v160, v164
    v_mul_f32 v161, v161, v164
    v_mul_f32 v162, v162, v164
    v_mul_f32 v163, v163, v164
    v_mul_f32 v168, v168, v172
    v_mul_f32 v169, v169, v172
    v_mfma_f32_16x16x32_bf16 v[204:207], v[108:111], a[92:95], v[204:207]
    s_waitcnt lgkmcnt(4)
    v_mul_f32 v170, v170, v172
    v_mul_f32 v171, v171, v172
    v_mul_f32 v176, v176, v180
    v_mul_f32 v177, v177, v180
    v_mul_f32 v178, v178, v180
    v_mul_f32 v179, v179, v180
    v_mul_f32 v184, v184, v188
    v_mul_f32 v185, v185, v188
    v_mfma_f32_16x16x32_bf16 v[220:223], v[112:115], a[76:79], v[220:223]
    ds_read_b64_tr_b16 v[104:105], v83 offset:0
    v_mul_f32 v186, v186, v188
    v_mul_f32 v187, v187, v188
LA_pg4:
    s_cbranch_execz LA_walked
    v_cvt_pk_bf16_f32 v136, v160, v161
    v_cvt_pk_bf16_f32 v137, v162, v163
    v_cvt_pk_bf16_f32 v138, v168, v169
    v_cvt_pk_bf16_f32 v139, v170, v171
    v_mfma_f32_16x16x32_bf16 v[220:223], v[116:119], a[92:95], v[220:223]
    buffer_load_dwordx4 a[136:139], v58, s[48:51], s80 offen sc1
    buffer_store_dwordx4 v[136:139], v21, s[48:51], s86 offen offset:2048 sc1
    v_mfma_f32_16x16x32_bf16 v[216:219], v[112:115], a[72:75], v[216:219]
    ds_read_b64_tr_b16 v[106:107], v83 offset:512
    v_cvt_pk_bf16_f32 v140, v176, v177
    v_cvt_pk_bf16_f32 v141, v178, v179
    v_cvt_pk_bf16_f32 v142, v184, v185
    v_cvt_pk_bf16_f32 v143, v186, v187
    v_mfma_f32_16x16x32_bf16 v[216:219], v[116:119], a[88:91], v[216:219]
    buffer_load_dwordx4 a[140:143], v59, s[48:51], s80 offen sc1
    buffer_store_dwordx4 v[140:143], v21, s[48:51], s86 offen offset:3072 sc1
    v_mfma_f32_16x16x32_bf16 v[212:215], v[112:115], a[68:71], v[212:215]
    ds_read_b64_tr_b16 v[108:109], v83 offset:16384
    s_add_u32 s80, s81, 69632
    v_mfma_f32_16x16x32_bf16 v[212:215], v[116:119], a[84:87], v[212:215]
    buffer_load_dwordx4 a[144:147], v56, s[48:51], s80 offen sc1
    v_mfma_f32_16x16x32_bf16 v[208:211], v[112:115], a[64:67], v[208:211]
    ds_read_b64_tr_b16 v[110:111], v83 offset:16896
    v_mfma_f32_16x16x32_bf16 v[208:211], v[116:119], a[80:83], v[208:211]
    s_waitcnt lgkmcnt(4)
    buffer_load_dwordx4 a[148:151], v57, s[48:51], s80 offen sc1
    v_mfma_f32_16x16x32_bf16 v[224:227], v[120:123], a[64:67], v[224:227]
    ds_read_b64_tr_b16 v[112:113], v80 offset:32768
    v_mfma_f32_16x16x32_bf16 v[224:227], v[124:127], a[80:83], v[224:227]
    buffer_load_dwordx4 a[152:155], v58, s[48:51], s80 offen sc1
    v_mfma_f32_16x16x32_bf16 v[228:231], v[120:123], a[68:71], v[228:231]
    ds_read_b64_tr_b16 v[114:115], v80 offset:33280
    v_mfma_f32_16x16x32_bf16 v[228:231], v[124:127], a[84:87], v[228:231]
    buffer_load_dwordx4 a[156:159], v59, s[48:51], s80 offen sc1
    v_mfma_f32_16x16x32_bf16 v[232:235], v[120:123], a[72:75], v[232:235]
    ds_read_b64_tr_b16 v[116:117], v80 offset:49152
    s_add_u32 s80, s18, 73728
    v_mfma_f32_16x16x32_bf16 v[232:235], v[124:127], a[88:91], v[232:235]
    buffer_load_dwordx4 v52, s[40:43], s78 offen offset:0  lds
    v_mfma_f32_16x16x32_bf16 v[236:239], v[120:123], a[76:79], v[236:239]
    ds_read_b64_tr_b16 v[118:119], v80 offset:49664
    v_mfma_f32_16x16x32_bf16 v[236:239], v[124:127], a[92:95], v[236:239]
    s_waitcnt lgkmcnt(4)
    v_mfma_f32_16x16x32_bf16 v[252:255], v[104:107], a[76:79], v[252:255]
    ds_read_b64_tr_b16 v[120:121], v81 offset:32768
    v_mfma_f32_16x16x32_bf16 v[252:255], v[108:111], a[92:95], v[252:255]
    buffer_load_dwordx4 v53, s[40:43], s78 offen offset:1024  lds
    v_mfma_f32_16x16x32_bf16 v[248:251], v[104:107], a[72:75], v[248:251]
    ds_read_b64_tr_b16 v[122:123], v81 offset:33280
    v_mfma_f32_16x16x32_bf16 v[248:251], v[108:111], a[88:91], v[248:251]
    buffer_load_dwordx4 v54, s[40:43], s78 offen offset:2048  lds
    v_mfma_f32_16x16x32_bf16 v[244:247], v[104:107], a[68:71], v[244:247]
    ds_read_b64_tr_b16 v[124:125], v81 offset:49152
    v_mfma_f32_16x16x32_bf16 v[244:247], v[108:111], a[84:87], v[244:247]
    buffer_load_dwordx4 v55, s[40:43], s78 offen offset:3072  lds
    v_mfma_f32_16x16x32_bf16 v[240:243], v[104:107], a[64:67], v[240:243]
    ds_read_b64_tr_b16 v[126:127], v81 offset:49664
    s_add_u32 m0, s74, 98304
    v_mfma_f32_16x16x32_bf16 v[240:243], v[108:111], a[80:83], v[240:243]
    s_waitcnt vmcnt(23) lgkmcnt(4)
    s_mul_i32 s78, vcc_hi, 3
    s_add_u32 s78, s78, vcc_lo
    s_add_u32 s78, s78, 32768
    buffer_load_dwordx4 v52, s[40:43], s78 offen offset:0  lds
    v_mfma_f32_16x16x32_bf16 v[192:195], v[112:115], a[96:99], v[192:195]
    ds_read_b64_tr_b16 v[104:105], v82 offset:32768
    v_add_u32 v4, s74, v21
    v_add_u32 v13, 0, v4
    v_xor_b32 v5, 4096, v13
    v_add_u32 v14, 81920, v4
    v_xor_b32 v6, 8192, v14
    v_add_u32 v15, 98304, v4
    v_xor_b32 v7, 12288, v15
    v_mfma_f32_16x16x32_bf16 v[192:195], v[116:119], a[112:115], v[192:195]
    buffer_load_dwordx4 v53, s[40:43], s78 offen offset:1024  lds
    v_and_b32 v28, 7, v20
    v_lshlrev_b32 v28, 10, v28
    v_bfe_u32 v29, v20, 3, 1
    v_lshl_add_u32 v28, v29, 6, v28
    v_bfe_u32 v29, v20, 4, 1
    v_lshl_add_u32 v28, v29, 5, v28
    v_mfma_f32_16x16x32_bf16 v[196:199], v[112:115], a[100:103], v[196:199]
    ds_read_b64_tr_b16 v[106:107], v82 offset:33280
    v_lshrrev_b32 v29, 5, v20
    v_lshl_add_u32 v12, v29, 4, v28
    v_mfma_f32_16x16x32_bf16 v[196:199], v[116:119], a[116:119], v[196:199]
    buffer_load_dwordx4 v54, s[40:43], s78 offen offset:2048  lds
    s_mov_b32 s69, 0
    s_atomic_add s69, s[48:49], s89 offset:8 glc
    s_lshl_b32 s86, s70, 2
    s_add_u32 s86, s86, s64
    s_lshl_b32 s86, s86, 14
    s_lshl_b32 s79, s71, 7
    v_mfma_f32_16x16x32_bf16 v[200:203], v[112:115], a[104:107], v[200:203]
    ds_read_b64_tr_b16 v[108:109], v82 offset:49152
    s_add_u32 s86, s86, s79
    s_add_u32 s87, s86, 8192
    v_mfma_f32_16x16x32_bf16 v[200:203], v[116:119], a[120:123], v[200:203]
    buffer_load_dwordx4 v55, s[40:43], s78 offen offset:3072  lds
    s_waitcnt vmcnt(12)
    s_atomic_add s14, s[48:49], s88 offset:12 glc
    v_mfma_f32_16x16x32_bf16 v[204:207], v[112:115], a[108:111], v[204:207]
    ds_read_b64_tr_b16 v[110:111], v82 offset:49664
    s_add_u32 m0, s74, 114688
    v_mfma_f32_16x16x32_bf16 v[204:207], v[116:119], a[124:127], v[204:207]
    s_waitcnt lgkmcnt(4)
    buffer_load_dwordx4 a[160:163], v56, s[48:51], s80 offen sc1
    v_mfma_f32_16x16x32_bf16 v[220:223], v[120:123], a[108:111], v[220:223]
    ds_read_b64_tr_b16 v[112:113], v83 offset:32768
    s_add_u32 s78, s84, 0
    v_mfma_f32_16x16x32_bf16 v[220:223], v[124:127], a[124:127], v[220:223]
    buffer_load_dwordx4 a[164:167], v57, s[48:51], s80 offen sc1
    v_mfma_f32_16x16x32_bf16 v[216:219], v[120:123], a[104:107], v[216:219]
    ds_read_b64_tr_b16 v[114:115], v83 offset:33280
    v_mfma_f32_16x16x32_bf16 v[216:219], v[124:127], a[120:123], v[216:219]
    buffer_load_dwordx4 a[168:171], v58, s[48:51], s80 offen sc1
    v_mfma_f32_16x16x32_bf16 v[212:215], v[120:123], a[100:103], v[212:215]
    ds_read_b64_tr_b16 v[116:117], v83 offset:49152
    v_mfma_f32_16x16x32_bf16 v[212:215], v[124:127], a[116:119], v[212:215]
    buffer_load_dwordx4 a[172:175], v59, s[48:51], s80 offen sc1
    v_mfma_f32_16x16x32_bf16 v[208:211], v[120:123], a[96:99], v[208:211]
    ds_read_b64_tr_b16 v[118:119], v83 offset:49664
    s_add_u32 s80, s18, 77824
    v_mfma_f32_16x16x32_bf16 v[208:211], v[124:127], a[112:115], v[208:211]
    s_waitcnt lgkmcnt(4)
    v_mfma_f32_16x16x32_bf16 v[224:227], v[104:107], a[96:99], v[224:227]
    ds_read_b64_tr_b16 v[120:121], v84 offset:0
    v_mfma_f32_16x16x32_bf16 v[224:227], v[108:111], a[112:115], v[224:227]
    buffer_load_dwordx4 a[176:179], v56, s[48:51], s80 offen sc1
    v_mfma_f32_16x16x32_bf16 v[228:231], v[104:107], a[100:103], v[228:231]
    ds_read_b64_tr_b16 v[122:123], v84 offset:512
    v_mfma_f32_16x16x32_bf16 v[228:231], v[108:111], a[116:119], v[228:231]
    buffer_load_dwordx4 a[180:183], v57, s[48:51], s80 offen sc1
    v_mfma_f32_16x16x32_bf16 v[232:235], v[104:107], a[104:107], v[232:235]
    ds_read_b64_tr_b16 v[124:125], v84 offset:16384
    v_mfma_f32_16x16x32_bf16 v[232:235], v[108:111], a[120:123], v[232:235]
    buffer_load_dwordx4 a[184:187], v58, s[48:51], s80 offen sc1
    v_mfma_f32_16x16x32_bf16 v[236:239], v[104:107], a[108:111], v[236:239]
    ds_read_b64_tr_b16 v[126:127], v84 offset:16896
    v_mfma_f32_16x16x32_bf16 v[236:239], v[108:111], a[124:127], v[236:239]
    s_waitcnt lgkmcnt(4)
    buffer_load_dwordx4 a[188:191], v59, s[48:51], s80 offen sc1
    v_mfma_f32_16x16x32_bf16 v[252:255], v[112:115], a[108:111], v[252:255]
    ds_read_b64_tr_b16 v[104:105], v85 offset:0
    s_cmp_ge_u32 s67, 32
    s_cbranch_scc0 LA_slow5
LA_back5:
    v_mfma_f32_16x16x32_bf16 v[252:255], v[116:119], a[124:127], v[252:255]
    s_lshl_b32 s77, s64, 8
    v_xor_b32 v64, s77, v21
    v_lshrrev_b32 v64, 2, v64
    s_lshl_b32 s77, s70, 8
    s_add_u32 s77, s77, 9764864
    buffer_load_dword v60, v64, s[48:51], s77 offen sc1
    v_mfma_f32_16x16x32_bf16 v[248:251], v[112:115], a[104:107], v[248:251]
    ds_read_b64_tr_b16 v[106:107], v85 offset:512
    v_mfma_f32_16x16x32_bf16 v[248:251], v[116:119], a[120:123], v[248:251]
    buffer_load_dwordx4 v52, s[40:43], s78 offen offset:0  lds
    v_mfma_f32_16x16x32_bf16 v[244:247], v[112:115], a[100:103], v[244:247]
    ds_read_b64_tr_b16 v[108:109], v85 offset:16384
    v_mfma_f32_16x16x32_bf16 v[244:247], v[116:119], a[116:119], v[244:247]
    buffer_load_dwordx4 v53, s[40:43], s78 offen offset:1024  lds
    v_mfma_f32_16x16x32_bf16 v[240:243], v[112:115], a[96:99], v[240:243]
    ds_read_b64_tr_b16 v[110:111], v85 offset:16896
    s_cmp_ge_u32 s69, 4
    s_cbranch_scc0 LA_slow3
LA_back3:
    v_mfma_f32_16x16x32_bf16 v[240:243], v[116:119], a[112:115], v[240:243]
    s_waitcnt vmcnt(19) lgkmcnt(4)
    s_add_u32 s80, s82, 196608
    v_mfma_f32_16x16x32_bf16 v[192:195], v[120:123], a[128:131], v[192:195]
    ds_read_b64_tr_b16 v[112:113], v86 offset:0
    v_mfma_f32_16x16x32_bf16 v[192:195], v[124:127], a[144:147], v[192:195]
    buffer_load_dwordx4 v54, s[40:43], s78 offen offset:2048  lds
    v_mfma_f32_16x16x32_bf16 v[196:199], v[120:123], a[132:135], v[196:199]
    ds_read_b64_tr_b16 v[114:115], v86 offset:512
    v_mfma_f32_16x16x32_bf16 v[196:199], v[124:127], a[148:151], v[196:199]
    buffer_load_dwordx4 v55, s[40:43], s78 offen offset:3072  lds
    v_mfma_f32_16x16x32_bf16 v[200:203], v[120:123], a[136:139], v[200:203]
    ds_read_b64_tr_b16 v[116:117], v86 offset:16384
    s_add_u32 m0, s74, 0
    v_mfma_f32_16x16x32_bf16 v[200:203], v[124:127], a[152:155], v[200:203]
    s_add_u32 s78, s21, 32768
    buffer_load_dwordx4 v52, s[40:43], s78 offen offset:0  lds
    v_mfma_f32_16x16x32_bf16 v[204:207], v[120:123], a[140:143], v[204:207]
    ds_read_b64_tr_b16 v[118:119], v86 offset:16896
    v_mfma_f32_16x16x32_bf16 v[204:207], v[124:127], a[156:159], v[204:207]
    s_waitcnt lgkmcnt(4)
    buffer_load_dwordx4 v53, s[40:43], s78 offen offset:1024  lds
    v_mfma_f32_16x16x32_bf16 v[220:223], v[104:107], a[140:143], v[220:223]
    ds_read_b64_tr_b16 v[120:121], v87 offset:0
    v_mfma_f32_16x16x32_bf16 v[220:223], v[108:111], a[156:159], v[220:223]
    buffer_load_dwordx4 v54, s[40:43], s78 offen offset:2048  lds
    v_mfma_f32_16x16x32_bf16 v[216:219], v[104:107], a[136:139], v[216:219]
    ds_read_b64_tr_b16 v[122:123], v87 offset:512
    v_mfma_f32_16x16x32_bf16 v[216:219], v[108:111], a[152:155], v[216:219]
    buffer_load_dwordx4 v55, s[40:43], s78 offen offset:3072  lds
    v_mfma_f32_16x16x32_bf16 v[212:215], v[104:107], a[132:135], v[212:215]
    ds_read_b64_tr_b16 v[124:125], v87 offset:16384
    s_add_u32 m0, s74, 16384
    v_mfma_f32_16x16x32_bf16 v[212:215], v[108:111], a[148:151], v[212:215]
    s_add_u32 s78, s83, 0
    buffer_load_dwordx4 v52, s[44:47], s78 offen offset:0  lds
    v_mfma_f32_16x16x32_bf16 v[208:211], v[104:107], a[128:131], v[208:211]
    ds_read_b64_tr_b16 v[126:127], v87 offset:16896
    v_mfma_f32_16x16x32_bf16 v[208:211], v[108:111], a[144:147], v[208:211]
    s_waitcnt lgkmcnt(4)
    buffer_load_dwordx4 v53, s[44:47], s78 offen offset:1024  lds
    v_mfma_f32_16x16x32_bf16 v[224:227], v[112:115], a[128:131], v[224:227]
    s_waitcnt vmcnt(23)
    ds_read_b64_tr_b16 v[104:105], v88 offset:0
    v_mfma_f32_16x16x32_bf16 v[224:227], v[116:119], a[144:147], v[224:227]
    buffer_load_dwordx4 v54, s[44:47], s78 offen offset:2048  lds
    v_mfma_f32_16x16x32_bf16 v[228:231], v[112:115], a[132:135], v[228:231]
    ds_read_b64_tr_b16 v[106:107], v88 offset:512
    v_mfma_f32_16x16x32_bf16 v[228:231], v[116:119], a[148:151], v[228:231]
    buffer_load_dwordx4 v55, s[44:47], s78 offen offset:3072  lds
    s_mov_b32 s65, 0
    s_atomic_add s65, s[48:49], s89 offset:12 glc
    v_mfma_f32_16x16x32_bf16 v[232:235], v[112:115], a[136:139], v[232:235]
    s_waitcnt vmcnt(21)
    ds_read_b64_tr_b16 v[108:109], v84 offset:32768
    s_add_u32 m0, s74, 32768
    v_mfma_f32_16x16x32_bf16 v[232:235], v[116:119], a[152:155], v[232:235]
    buffer_load_dwordx4 a[192:195], v56, s[48:51], s80 offen sc1
    v_mfma_f32_16x16x32_bf16 v[236:239], v[112:115], a[140:143], v[236:239]
    ds_read_b64_tr_b16 v[110:111], v84 offset:33280
    s_add_u32 s78, s83, 32768
    v_mfma_f32_16x16x32_bf16 v[236:239], v[116:119], a[156:159], v[236:239]
    s_waitcnt lgkmcnt(4)
    v_mfma_f32_16x16x32_bf16 v[252:255], v[120:123], a[140:143], v[252:255]
    ds_read_b64_tr_b16 v[112:113], v89 offset:0
    v_mfma_f32_16x16x32_bf16 v[252:255], v[124:127], a[156:159], v[252:255]
    buffer_load_dwordx4 a[196:199], v57, s[48:51], s80 offen sc1
    v_mfma_f32_16x16x32_bf16 v[248:251], v[120:123], a[136:139], v[248:251]
    ds_read_b64_tr_b16 v[114:115], v89 offset:512
    v_mfma_f32_16x16x32_bf16 v[248:251], v[124:127], a[152:155], v[248:251]
    buffer_load_dwordx4 a[200:203], v58, s[48:51], s80 offen sc1
    v_mfma_f32_16x16x32_bf16 v[244:247], v[120:123], a[132:135], v[244:247]
    ds_read_b64_tr_b16 v[116:117], v85 offset:32768
    v_mfma_f32_16x16x32_bf16 v[244:247], v[124:127], a[148:151], v[244:247]
    buffer_load_dwordx4 a[204:207], v59, s[48:51], s80 offen sc1
    v_mfma_f32_16x16x32_bf16 v[240:243], v[120:123], a[128:131], v[240:243]
    ds_read_b64_tr_b16 v[118:119], v85 offset:33280
    s_add_u32 s80, s19, 200704
    v_mfma_f32_16x16x32_bf16 v[240:243], v[124:127], a[144:147], v[240:243]
    s_waitcnt vmcnt(17) lgkmcnt(4)
    buffer_load_dwordx4 a[208:211], v56, s[48:51], s80 offen sc1
    v_mfma_f32_16x16x32_bf16 v[192:195], v[104:107], a[160:163], v[192:195]
    ds_read_b64_tr_b16 v[120:121], v90 offset:0
    s_waitcnt vmcnt(17)
    v_mov_b32 v61, v60
    s_nop 1
    v_permlane16_swap_b32 v60, v61
    v_mov_b32 v62, v60
    v_mov_b32 v63, v61
    s_nop 0
    v_permlane32_swap_b32 v60, v62
    v_permlane32_swap_b32 v61, v63
    v_sub_f32 v64, 1.0, v60
    v_mfma_f32_16x16x32_bf16 v[192:195], v[108:111], a[176:179], v[192:195]
    buffer_load_dwordx4 a[212:215], v57, s[48:51], s80 offen sc1
    v_sub_f32 v65, 1.0, v61
    v_sub_f32 v66, 1.0, v62
    v_sub_f32 v67, 1.0, v63
    v_mfma_f32_16x16x32_bf16 v[196:199], v[104:107], a[164:167], v[196:199]
    ds_read_b64_tr_b16 v[122:123], v90 offset:512
    v_mfma_f32_16x16x32_bf16 v[196:199], v[108:111], a[180:183], v[196:199]
    buffer_load_dwordx4 a[216:219], v58, s[48:51], s80 offen sc1
    v_mfma_f32_16x16x32_bf16 v[200:203], v[104:107], a[168:171], v[200:203]
    ds_read_b64_tr_b16 v[124:125], v86 offset:32768
    v_mfma_f32_16x16x32_bf16 v[200:203], v[108:111], a[184:187], v[200:203]
    buffer_load_dwordx4 a[220:223], v59, s[48:51], s80 offen sc1
    v_mfma_f32_16x16x32_bf16 v[204:207], v[104:107], a[172:175], v[204:207]
    ds_read_b64_tr_b16 v[126:127], v86 offset:33280
    v_mfma_f32_16x16x32_bf16 v[204:207], v[108:111], a[188:191], v[204:207]
    s_waitcnt lgkmcnt(4)
    v_mfma_f32_16x16x32_bf16 v[220:223], v[112:115], a[172:175], v[220:223]
    ds_read_b64_tr_b16 v[104:105], v91 offset:0
    v_mfma_f32_16x16x32_bf16 v[220:223], v[116:119], a[188:191], v[220:223]
    buffer_load_dwordx4 v52, s[44:47], s78 offen offset:0  lds
    v_mfma_f32_16x16x32_bf16 v[216:219], v[112:115], a[168:171], v[216:219]
    ds_read_b64_tr_b16 v[106:107], v91 offset:512
    v_mfma_f32_16x16x32_bf16 v[216:219], v[116:119], a[184:187], v[216:219]
    buffer_load_dwordx4 v53, s[44:47], s78 offen offset:1024  lds
    v_mfma_f32_16x16x32_bf16 v[212:215], v[112:115], a[164:167], v[212:215]
    ds_read_b64_tr_b16 v[108:109], v87 offset:32768
    v_mfma_f32_16x16x32_bf16 v[212:215], v[116:119], a[180:183], v[212:215]
    buffer_load_dwordx4 v54, s[44:47], s78 offen offset:2048  lds
    v_mfma_f32_16x16x32_bf16 v[208:211], v[112:115], a[160:163], v[208:211]
    ds_read_b64_tr_b16 v[110:111], v87 offset:33280
    v_mfma_f32_16x16x32_bf16 v[208:211], v[116:119], a[176:179], v[208:211]
    s_waitcnt lgkmcnt(4)
    buffer_load_dwordx4 v55, s[44:47], s78 offen offset:3072  lds
    v_mfma_f32_16x16x32_bf16 v[224:227], v[120:123], a[160:163], v[224:227]
    s_waitcnt vmcnt(20)
    ds_read_b64_tr_b16 v[112:113], v84 offset:49152
    s_add_u32 m0, s74, 49152
    v_mfma_f32_16x16x32_bf16 v[224:227], v[124:127], a[176:179], v[224:227]
    ds_read_b64_tr_b16 v[114:115], v84 offset:49664
    s_add_u32 s78, s20, 65536
    buffer_load_dwordx4 v52, s[44:47], s78 offen offset:0  lds
    v_mfma_f32_16x16x32_bf16 v[228:231], v[120:123], a[164:167], v[228:231]
    s_waitcnt vmcnt(17)
    ds_read_b64_tr_b16 v[116:117], v80 offset:0
    s_cmp_ge_u32 s65, 4
    s_cbranch_scc0 LA_slow4
LA_back4:
    v_mfma_f32_16x16x32_bf16 v[228:231], v[124:127], a[180:183], v[228:231]
    ds_read_b64_tr_b16 v[118:119], v80 offset:512
    buffer_load_dwordx4 v53, s[44:47], s78 offen offset:1024  lds
    v_mfma_f32_16x16x32_bf16 v[232:235], v[120:123], a[168:171], v[232:235]
    s_waitcnt vmcnt(14)
    ds_read_b64_tr_b16 a[32:33], v80 offset:16384
    s_add_u32 s92, s81, 229376
    v_mfma_f32_16x16x32_bf16 v[232:235], v[124:127], a[184:187], v[232:235]
    ds_read_b64_tr_b16 a[34:35], v80 offset:16896
    buffer_load_dwordx4 v54, s[44:47], s78 offen offset:2048  lds
    v_mfma_f32_16x16x32_bf16 v[236:239], v[120:123], a[172:175], v[236:239]
    ds_read_b64_tr_b16 a[36:37], v81 offset:16384
    s_add_u32 s93, s81, 233472
    v_mfma_f32_16x16x32_bf16 v[236:239], v[124:127], a[188:191], v[236:239]
    s_waitcnt lgkmcnt(7)
    ds_read_b64_tr_b16 a[38:39], v81 offset:16896
    v_mfma_f32_16x16x32_bf16 v[252:255], v[104:107], a[172:175], v[252:255]
    ds_read_b64_tr_b16 v[120:121], v85 offset:49152
    s_add_u32 s94, s18, 237568
    v_mfma_f32_16x16x32_bf16 v[252:255], v[108:111], a[188:191], v[252:255]
    ds_read_b64_tr_b16 v[122:123], v85 offset:49664
    buffer_load_dwordx4 v55, s[44:47], s78 offen offset:3072  lds
    v_mfma_f32_16x16x32_bf16 v[248:251], v[104:107], a[168:171], v[248:251]
    ds_read_b64_tr_b16 v[124:125], v81 offset:0
    s_add_u32 m0, s74, 65536
    v_mfma_f32_16x16x32_bf16 v[248:251], v[108:111], a[184:187], v[248:251]
    ds_read_b64_tr_b16 v[126:127], v81 offset:512
    s_add_u32 s78, s20, 98304
    buffer_load_dwordx4 v52, s[44:47], s78 offen offset:0  lds
    v_mfma_f32_16x16x32_bf16 v[244:247], v[104:107], a[164:167], v[244:247]
    ds_read_b64_tr_b16 a[40:41], v82 offset:16384
    s_add_u32 s95, s18, 241664
    v_mfma_f32_16x16x32_bf16 v[244:247], v[108:111], a[180:183], v[244:247]
    ds_read_b64_tr_b16 a[42:43], v82 offset:16896
    buffer_load_dwordx4 v53, s[44:47], s78 offen offset:1024  lds
    v_mfma_f32_16x16x32_bf16 v[240:243], v[104:107], a[160:163], v[240:243]
    ds_read_b64_tr_b16 a[44:45], v83 offset:16384
    v_mfma_f32_16x16x32_bf16 v[240:243], v[108:111], a[176:179], v[240:243]
    s_waitcnt vmcnt(10) lgkmcnt(11)
    ds_read_b64_tr_b16 a[46:47], v83 offset:16896
    v_mfma_f32_16x16x32_bf16 v[192:195], v[112:115], a[192:195], v[192:195]
    ds_read_b64_tr_b16 v[104:105], v86 offset:49152
    v_mfma_f32_16x16x32_bf16 v[192:195], v[116:119], a[208:211], v[192:195]
    ds_read_b64_tr_b16 v[106:107], v86 offset:49664
    buffer_load_dwordx4 v54, s[44:47], s78 offen offset:2048  lds
    v_mfma_f32_16x16x32_bf16 v[196:199], v[112:115], a[196:199], v[196:199]
    ds_read_b64_tr_b16 v[108:109], v82 offset:0
    v_mfma_f32_16x16x32_bf16 v[196:199], v[116:119], a[212:215], v[196:199]
    ds_read_b64_tr_b16 v[110:111], v82 offset:512
    buffer_load_dwordx4 v55, s[44:47], s78 offen offset:3072  lds
    v_mfma_f32_16x16x32_bf16 v[200:203], v[112:115], a[200:203], v[200:203]
    s_waitcnt vmcnt(8)
    ds_read_b64_tr_b16 a[48:49], v80 offset:32768
    v_mfma_f32_16x16x32_bf16 v[200:203], v[116:119], a[216:219], v[200:203]
    ds_read_b64_tr_b16 a[50:51], v80 offset:33280
    buffer_load_dwordx4 a[228:231], v57, s[48:51], s92 offen sc1
    v_mfma_f32_16x16x32_bf16 v[204:207], v[112:115], a[204:207], v[204:207]
    ds_read_b64_tr_b16 a[52:53], v81 offset:32768
    v_mfma_f32_16x16x32_bf16 v[204:207], v[116:119], a[220:223], v[204:207]
    s_waitcnt lgkmcnt(11)
    ds_read_b64_tr_b16 a[54:55], v81 offset:33280
    v_mfma_f32_16x16x32_bf16 v[220:223], v[120:123], a[204:207], v[220:223]
    ds_read_b64_tr_b16 v[112:113], v87 offset:49152
    v_mul_f32 v196, v196, v65
    v_mul_f32 v197, v197, v65
    v_mfma_f32_16x16x32_bf16 v[220:223], v[124:127], a[220:223], v[220:223]
    ds_read_b64_tr_b16 v[114:115], v87 offset:49664
    buffer_load_dwordx4 a[244:247], v57, s[48:51], s93 offen sc1
    v_mfma_f32_16x16x32_bf16 v[216:219], v[120:123], a[200:203], v[216:219]
    ds_read_b64_tr_b16 v[116:117], v83 offset:0
    v_mul_f32 v198, v198, v65
    v_mul_f32 v199, v199, v65
    v_mfma_f32_16x16x32_bf16 v[216:219], v[124:127], a[216:219], v[216:219]
    ds_read_b64_tr_b16 v[118:119], v83 offset:512
    buffer_load_dwordx4 a[4:7], v57, s[48:51], s94 offen sc1
    v_mfma_f32_16x16x32_bf16 v[212:215], v[120:123], a[196:199], v[212:215]
    ds_read_b64_tr_b16 a[56:57], v82 offset:32768
    v_mul_f32 v200, v200, v66
    v_mul_f32 v201, v201, v66
    v_mfma_f32_16x16x32_bf16 v[212:215], v[124:127], a[212:215], v[212:215]
    ds_read_b64_tr_b16 a[58:59], v82 offset:33280
    buffer_load_dwordx4 a[20:23], v57, s[48:51], s95 offen sc1
    v_mfma_f32_16x16x32_bf16 v[208:211], v[120:123], a[192:195], v[208:211]
    ds_read_b64_tr_b16 a[60:61], v83 offset:32768
    v_mul_f32 v202, v202, v66
    v_mul_f32 v203, v203, v66
    v_mfma_f32_16x16x32_bf16 v[208:211], v[124:127], a[208:211], v[208:211]
    s_waitcnt lgkmcnt(11)
    ds_read_b64_tr_b16 a[62:63], v83 offset:33280
    v_mfma_f32_16x16x32_bf16 v[224:227], v[104:107], a[192:195], v[224:227]
    s_waitcnt vmcnt(8)
    ds_read_b64_tr_b16 a[64:65], v80 offset:49152
    v_mul_f32 v216, v216, v66
    v_mul_f32 v217, v217, v66
    v_mfma_f32_16x16x32_bf16 v[224:227], v[108:111], a[208:211], v[224:227]
    ds_read_b64_tr_b16 a[66:67], v80 offset:49664
    buffer_load_dwordx4 a[232:235], v58, s[48:51], s92 offen sc1
    v_mfma_f32_16x16x32_bf16 v[228:231], v[104:107], a[196:199], v[228:231]
    ds_read_b64_tr_b16 a[68:69], v81 offset:49152
    v_mul_f32 v218, v218, v66
    v_mul_f32 v219, v219, v66
    v_mfma_f32_16x16x32_bf16 v[228:231], v[108:111], a[212:215], v[228:231]
    ds_read_b64_tr_b16 a[70:71], v81 offset:49664
    v_mul_f32 v212, v212, v65
    v_mul_f32 v213, v213, v65
    v_mfma_f32_16x16x32_bf16 v[232:235], v[104:107], a[200:203], v[232:235]
    ds_read_b64_tr_b16 a[72:73], v82 offset:49152
    v_mul_f32 v214, v214, v65
    v_mul_f32 v215, v215, v65
    v_mfma_f32_16x16x32_bf16 v[232:235], v[108:111], a[216:219], v[232:235]
    ds_read_b64_tr_b16 a[74:75], v82 offset:49664
    buffer_load_dwordx4 a[248:251], v58, s[48:51], s93 offen sc1
    v_mfma_f32_16x16x32_bf16 v[236:239], v[104:107], a[204:207], v[236:239]
    ds_read_b64_tr_b16 a[76:77], v83 offset:49152
    v_mfma_f32_16x16x32_bf16 v[236:239], v[108:111], a[220:223], v[236:239]
    s_waitcnt lgkmcnt(11)
    ds_read_b64_tr_b16 a[78:79], v83 offset:49664
    v_mfma_f32_16x16x32_bf16 v[252:255], v[112:115], a[204:207], v[252:255]
    s_waitcnt vmcnt(6)
    ds_read_b64_tr_b16 a[80:81], v84 offset:0
    v_mul_f32 v228, v228, v65
    v_mul_f32 v229, v229, v65
    v_mfma_f32_16x16x32_bf16 v[252:255], v[116:119], a[220:223], v[252:255]
    ds_read_b64_tr_b16 a[82:83], v84 offset:512
    buffer_load_dwordx4 a[8:11], v58, s[48:51], s94 offen sc1
    v_mfma_f32_16x16x32_bf16 v[248:251], v[112:115], a[200:203], v[248:251]
    ds_read_b64_tr_b16 a[84:85], v85 offset:0
    v_mul_f32 v230, v230, v65
    v_mul_f32 v231, v231, v65
    v_mfma_f32_16x16x32_bf16 v[248:251], v[116:119], a[216:219], v[248:251]
    ds_read_b64_tr_b16 a[86:87], v85 offset:512
    v_mul_f32 v232, v232, v66
    v_mul_f32 v233, v233, v66
    v_mfma_f32_16x16x32_bf16 v[244:247], v[112:115], a[196:199], v[244:247]
    ds_read_b64_tr_b16 a[88:89], v86 offset:0
    v_mul_f32 v234, v234, v66
    v_mul_f32 v235, v235, v66
    v_mfma_f32_16x16x32_bf16 v[244:247], v[116:119], a[212:215], v[244:247]
    ds_read_b64_tr_b16 a[90:91], v86 offset:512
    buffer_load_dwordx4 a[24:27], v58, s[48:51], s95 offen sc1
    v_mfma_f32_16x16x32_bf16 v[240:243], v[112:115], a[192:195], v[240:243]
    ds_read_b64_tr_b16 a[92:93], v87 offset:0
    v_mfma_f32_16x16x32_bf16 v[240:243], v[116:119], a[208:211], v[240:243]
    s_waitcnt vmcnt(4) lgkmcnt(13)
    ds_read_b64_tr_b16 a[94:95], v87 offset:512
    v_mfma_f32_16x16x32_bf16 v[132:135], a[32:35], a[228:231], 0
    v_mul_f32 v248, v248, v66
    v_mul_f32 v249, v249, v66
    v_mul_f32 v250, v250, v66
    v_mul_f32 v251, v251, v66
    v_mfma_f32_16x16x32_bf16 v[132:135], a[48:51], a[244:247], v[132:135]
    buffer_load_dwordx4 a[236:239], v59, s[48:51], s92 offen sc1
    v_mul_f32 v244, v244, v65
    v_mul_f32 v245, v245, v65
    v_mfma_f32_16x16x32_bf16 v[132:135], a[64:67], a[4:7], v[132:135]
    v_mul_f32 v246, v246, v65
    v_mul_f32 v247, v247, v65
    v_mul_f32 v204, v204, v67
    v_mul_f32 v205, v205, v67
    s_waitcnt lgkmcnt(6)
    v_mfma_f32_16x16x32_bf16 v[132:135], a[80:83], a[20:23], v[132:135]
    v_mul_f32 v206, v206, v67
    v_mul_f32 v207, v207, v67
    v_mul_f32 v220, v220, v67
    v_mul_f32 v221, v221, v67
    v_mfma_f32_16x16x32_bf16 v[148:151], a[36:39], a[228:231], 0
    v_mul_f32 v222, v222, v67
    v_mul_f32 v223, v223, v67
    v_mfma_f32_16x16x32_bf16 v[148:151], a[52:55], a[244:247], v[148:151]
    buffer_load_dwordx4 a[252:255], v59, s[48:51], s93 offen sc1
    v_mfma_f32_16x16x32_bf16 v[148:151], a[68:71], a[4:7], v[148:151]
    s_waitcnt lgkmcnt(4)
    v_mfma_f32_16x16x32_bf16 v[148:151], a[84:87], a[20:23], v[148:151]
    s_waitcnt lgkmcnt(0)
    v_mfma_f32_16x16x32_bf16 v[164:167], a[40:43], a[228:231], 0
    v_fmac_f32 v196, v132, v61
    v_fmac_f32 v197, v133, v61
    v_fmac_f32 v198, v134, v61
    v_fmac_f32 v199, v135, v61
    v_mfma_f32_16x16x32_bf16 v[164:167], a[56:59], a[244:247], v[164:167]
    buffer_load_dwordx4 a[12:15], v59, s[48:51], s94 offen sc1
    ds_write_b128 v13, v[196:199] offset:0
    v_mfma_f32_16x16x32_bf16 v[164:167], a[72:75], a[4:7], v[164:167]
    v_mfma_f32_16x16x32_bf16 v[164:167], a[88:91], a[20:23], v[164:167]
    v_fmac_f32 v212, v148, v61
    v_fmac_f32 v213, v149, v61
    v_fmac_f32 v214, v150, v61
    v_fmac_f32 v215, v151, v61
    v_mfma_f32_16x16x32_bf16 v[180:183], a[44:47], a[228:231], 0
    ds_write_b128 v13, v[212:215] offset:1024
    v_mfma_f32_16x16x32_bf16 v[180:183], a[60:63], a[244:247], v[180:183]
    buffer_load_dwordx4 a[28:31], v59, s[48:51], s95 offen sc1
    v_mul_f32 v236, v236, v67
    v_mul_f32 v237, v237, v67
    v_mfma_f32_16x16x32_bf16 v[180:183], a[76:79], a[4:7], v[180:183]
    v_mul_f32 v238, v238, v67
    v_mul_f32 v239, v239, v67
    v_mul_f32 v252, v252, v67
    v_mul_f32 v253, v253, v67
    v_mfma_f32_16x16x32_bf16 v[180:183], a[92:95], a[20:23], v[180:183]
    s_waitcnt vmcnt(4)
    v_mul_f32 v254, v254, v67
    v_mul_f32 v255, v255, v67
    v_mfma_f32_16x16x32_bf16 v[136:139], a[32:35], a[232:235], 0
    v_fmac_f32 v228, v164, v61
    v_fmac_f32 v229, v165, v61
    v_fmac_f32 v230, v166, v61
    v_fmac_f32 v231, v167, v61
    v_mfma_f32_16x16x32_bf16 v[136:139], a[48:51], a[248:251], v[136:139]
    buffer_load_dwordx4 a[224:227], v56, s[48:51], s92 offen sc1
    ds_write_b128 v13, v[228:231] offset:2048
    v_mfma_f32_16x16x32_bf16 v[136:139], a[64:67], a[8:11], v[136:139]
    v_mfma_f32_16x16x32_bf16 v[136:139], a[80:83], a[24:27], v[136:139]
    v_fmac_f32 v244, v180, v61
    v_fmac_f32 v245, v181, v61
    v_fmac_f32 v246, v182, v61
    v_fmac_f32 v247, v183, v61
    v_mfma_f32_16x16x32_bf16 v[152:155], a[36:39], a[232:235], 0
    ds_write_b128 v13, v[244:247] offset:3072
    v_mfma_f32_16x16x32_bf16 v[152:155], a[52:55], a[248:251], v[152:155]
    buffer_load_dwordx4 a[240:243], v56, s[48:51], s93 offen sc1
    v_mul_f32 v192, v192, v64
    v_mul_f32 v193, v193, v64
    v_mfma_f32_16x16x32_bf16 v[152:155], a[68:71], a[8:11], v[152:155]
    v_mul_f32 v194, v194, v64
    v_mul_f32 v195, v195, v64
    v_mul_f32 v208, v208, v64
    v_mul_f32 v209, v209, v64
    v_mfma_f32_16x16x32_bf16 v[152:155], a[84:87], a[24:27], v[152:155]
    v_mul_f32 v210, v210, v64
    v_mul_f32 v211, v211, v64
    v_mfma_f32_16x16x32_bf16 v[168:171], a[40:43], a[232:235], 0
    s_waitcnt lgkmcnt(0)
    s_barrier
    ds_read_b128 v[132:135], v5 offset:0
    ds_read_b128 v[148:151], v5 offset:1024
    v_mfma_f32_16x16x32_bf16 v[168:171], a[56:59], a[248:251], v[168:171]
    buffer_load_dwordx4 a[0:3], v56, s[48:51], s94 offen sc1
    ds_read_b128 v[164:167], v5 offset:2048
    v_mfma_f32_16x16x32_bf16 v[168:171], a[72:75], a[8:11], v[168:171]
    ds_read_b128 v[180:183], v5 offset:3072
    v_fmac_f32 v200, v136, v62
    v_fmac_f32 v201, v137, v62
    v_fmac_f32 v202, v138, v62
    v_mfma_f32_16x16x32_bf16 v[168:171], a[88:91], a[24:27], v[168:171]
    buffer_load_dwordx4 a[16:19], v56, s[48:51], s95 offen sc1
    v_fmac_f32 v203, v139, v62
    v_mfma_f32_16x16x32_bf16 v[184:187], a[44:47], a[232:235], 0
    ds_write_b128 v14, v[200:203] offset:0
    v_mfma_f32_16x16x32_bf16 v[184:187], a[60:63], a[248:251], v[184:187]
    v_fmac_f32 v216, v152, v62
    v_fmac_f32 v217, v153, v62
    v_fmac_f32 v218, v154, v62
    v_fmac_f32 v219, v155, v62
    v_mfma_f32_16x16x32_bf16 v[184:187], a[76:79], a[8:11], v[184:187]
    ds_write_b128 v14, v[216:219] offset:1024
    v_mfma_f32_16x16x32_bf16 v[184:187], a[92:95], a[24:27], v[184:187]
    s_waitcnt vmcnt(4)
    v_mul_f32 v224, v224, v64
    v_mul_f32 v225, v225, v64
    v_mul_f32 v226, v226, v64
    v_mul_f32 v227, v227, v64
    v_mfma_f32_16x16x32_bf16 v[140:143], a[32:35], a[236:239], 0
    v_mul_f32 v240, v240, v64
    v_mul_f32 v241, v241, v64
    v_mul_f32 v242, v242, v64
    v_mul_f32 v243, v243, v64
    v_mfma_f32_16x16x32_bf16 v[140:143], a[48:51], a[252:255], v[140:143]
    v_fmac_f32 v232, v168, v62
    v_fmac_f32 v233, v169, v62
    v_fmac_f32 v234, v170, v62
    v_fmac_f32 v235, v171, v62
    v_mfma_f32_16x16x32_bf16 v[140:143], a[64:67], a[12:15], v[140:143]
    ds_write_b128 v14, v[232:235] offset:2048
    v_mfma_f32_16x16x32_bf16 v[140:143], a[80:83], a[28:31], v[140:143]
    v_fmac_f32 v248, v184, v62
    v_fmac_f32 v249, v185, v62
    v_fmac_f32 v250, v186, v62
    v_fmac_f32 v251, v187, v62
    v_mfma_f32_16x16x32_bf16 v[156:159], a[36:39], a[236:239], 0
    ds_write_b128 v14, v[248:251] offset:3072
    v_mfma_f32_16x16x32_bf16 v[156:159], a[52:55], a[252:255], v[156:159]
    s_waitcnt lgkmcnt(7)
    v_add_f32 v192, v192, v132
    v_add_f32 v193, v193, v133
    v_add_f32 v194, v194, v134
    v_add_f32 v195, v195, v135
    v_mfma_f32_16x16x32_bf16 v[156:159], a[68:71], a[12:15], v[156:159]
    s_waitcnt lgkmcnt(6)
    v_add_f32 v208, v208, v148
    v_add_f32 v209, v209, v149
    v_add_f32 v210, v210, v150
    v_add_f32 v211, v211, v151
    v_mfma_f32_16x16x32_bf16 v[156:159], a[84:87], a[28:31], v[156:159]
    s_waitcnt lgkmcnt(0)
    s_barrier
    ds_read_b128 v[136:139], v6 offset:0
    v_mfma_f32_16x16x32_bf16 v[172:175], a[40:43], a[236:239], 0
LA_pg5:
    s_cbranch_execz LA_walked
    ds_read_b128 v[152:155], v6 offset:1024
    ds_read_b128 v[168:171], v6 offset:2048
    v_mfma_f32_16x16x32_bf16 v[172:175], a[56:59], a[252:255], v[172:175]
    ds_read_b128 v[184:187], v6 offset:3072
    v_fmac_f32 v204, v140, v63
    v_fmac_f32 v205, v141, v63
    v_fmac_f32 v206, v142, v63
    v_mfma_f32_16x16x32_bf16 v[172:175], a[72:75], a[12:15], v[172:175]
    v_fmac_f32 v207, v143, v63
    v_mfma_f32_16x16x32_bf16 v[172:175], a[88:91], a[28:31], v[172:175]
    ds_write_b128 v15, v[204:207] offset:0
    v_mfma_f32_16x16x32_bf16 v[188:191], a[44:47], a[236:239], 0
    v_fmac_f32 v220, v156, v63
    v_fmac_f32 v221, v157, v63
    v_fmac_f32 v222, v158, v63
    v_fmac_f32 v223, v159, v63
    v_mfma_f32_16x16x32_bf16 v[188:191], a[60:63], a[252:255], v[188:191]
    ds_write_b128 v15, v[220:223] offset:1024
    v_mfma_f32_16x16x32_bf16 v[188:191], a[76:79], a[12:15], v[188:191]
    v_add_f32 v224, v224, v164
    v_add_f32 v225, v225, v165
    v_add_f32 v226, v226, v166
    v_add_f32 v227, v227, v167
    v_mfma_f32_16x16x32_bf16 v[188:191], a[92:95], a[28:31], v[188:191]
    s_waitcnt vmcnt(0)
    v_add_f32 v240, v240, v180
    v_add_f32 v241, v241, v181
    v_add_f32 v242, v242, v182
    v_add_f32 v243, v243, v183
    v_mfma_f32_16x16x32_bf16 v[128:131], a[32:35], a[224:227], 0
    s_waitcnt lgkmcnt(5)
    v_add_f32 v192, v192, v136
    v_add_f32 v193, v193, v137
    v_add_f32 v194, v194, v138
    v_add_f32 v195, v195, v139
    v_mfma_f32_16x16x32_bf16 v[128:131], a[48:51], a[240:243], v[128:131]
    v_fmac_f32 v236, v172, v63
    v_fmac_f32 v237, v173, v63
    v_fmac_f32 v238, v174, v63
    v_fmac_f32 v239, v175, v63
    v_mfma_f32_16x16x32_bf16 v[128:131], a[64:67], a[0:3], v[128:131]
    ds_write_b128 v15, v[236:239] offset:2048
    v_mfma_f32_16x16x32_bf16 v[128:131], a[80:83], a[16:19], v[128:131]
    v_fmac_f32 v252, v188, v63
    v_fmac_f32 v253, v189, v63
    v_fmac_f32 v254, v190, v63
    v_fmac_f32 v255, v191, v63
    v_mfma_f32_16x16x32_bf16 v[144:147], a[36:39], a[224:227], 0
    ds_write_b128 v15, v[252:255] offset:3072
    v_mfma_f32_16x16x32_bf16 v[144:147], a[52:55], a[240:243], v[144:147]
    s_waitcnt lgkmcnt(6)
    v_add_f32 v208, v208, v152
    v_add_f32 v209, v209, v153
    v_add_f32 v210, v210, v154
    v_add_f32 v211, v211, v155
    v_mfma_f32_16x16x32_bf16 v[144:147], a[68:71], a[0:3], v[144:147]
    s_waitcnt lgkmcnt(5)
    v_add_f32 v224, v224, v168
    v_add_f32 v225, v225, v169
    v_add_f32 v226, v226, v170
    v_add_f32 v227, v227, v171
    v_mfma_f32_16x16x32_bf16 v[144:147], a[84:87], a[16:19], v[144:147]
    s_waitcnt lgkmcnt(0)
    s_barrier
    ds_read_b128 v[140:143], v7 offset:0
    v_mfma_f32_16x16x32_bf16 v[160:163], a[40:43], a[224:227], 0
    ds_read_b128 v[156:159], v7 offset:1024
    ds_read_b128 v[172:175], v7 offset:2048
    v_mfma_f32_16x16x32_bf16 v[160:163], a[56:59], a[240:243], v[160:163]
    ds_read_b128 v[188:191], v7 offset:3072
    v_add_f32 v240, v240, v184
    v_add_f32 v241, v241, v185
    v_add_f32 v242, v242, v186
    v_mfma_f32_16x16x32_bf16 v[160:163], a[72:75], a[0:3], v[160:163]
    v_add_f32 v243, v243, v187
    v_fmac_f32 v192, v128, v60
    v_fmac_f32 v193, v129, v60
    v_fmac_f32 v194, v130, v60
    v_mfma_f32_16x16x32_bf16 v[160:163], a[88:91], a[16:19], v[160:163]
    v_fmac_f32 v195, v131, v60
    v_fmac_f32 v208, v144, v60
    v_fmac_f32 v209, v145, v60
    v_fmac_f32 v210, v146, v60
    v_mfma_f32_16x16x32_bf16 v[176:179], a[44:47], a[224:227], 0
    v_fmac_f32 v211, v147, v60
    s_waitcnt lgkmcnt(3)
    v_add_f32 v192, v192, v140
    v_add_f32 v193, v193, v141
    v_add_f32 v194, v194, v142
    v_mfma_f32_16x16x32_bf16 v[176:179], a[60:63], a[240:243], v[176:179]
    v_add_f32 v195, v195, v143
    s_waitcnt lgkmcnt(2)
    v_add_f32 v208, v208, v156
    v_add_f32 v209, v209, v157
    v_add_f32 v210, v210, v158
    v_mfma_f32_16x16x32_bf16 v[176:179], a[76:79], a[0:3], v[176:179]
    v_add_f32 v211, v211, v159
    s_waitcnt lgkmcnt(1)
    v_add_f32 v224, v224, v172
    v_add_f32 v225, v225, v173
    v_add_f32 v226, v226, v174
    v_mfma_f32_16x16x32_bf16 v[176:179], a[92:95], a[16:19], v[176:179]
    v_add_f32 v227, v227, v175
    s_waitcnt lgkmcnt(0)
    v_add_f32 v240, v240, v188
    v_add_f32 v241, v241, v189
    v_add_f32 v242, v242, v190
    v_add_f32 v243, v243, v191
    v_cvt_pk_bf16_f32 v196, v192, v193
    v_cvt_pk_bf16_f32 v197, v194, v195
    v_cvt_pk_bf16_f32 v198, v208, v209
    v_cvt_pk_bf16_f32 v199, v210, v211
    s_nop 0
    v_permlane16_swap_b32 v196, v198
    v_permlane16_swap_b32 v197, v199
    v_mov_b32 v212, v196
    v_mov_b32 v213, v197
    v_mov_b32 v214, v198
    v_mov_b32 v215, v199
    v_fmac_f32 v224, v160, v60
    v_fmac_f32 v225, v161, v60
    v_fmac_f32 v226, v162, v60
    v_fmac_f32 v227, v163, v60
    v_fmac_f32 v240, v176, v60
    v_fmac_f32 v241, v177, v60
    v_fmac_f32 v242, v178, v60
    v_fmac_f32 v243, v179, v60
    v_cvt_pk_bf16_f32 v228, v224, v225
    v_cvt_pk_bf16_f32 v229, v226, v227
    v_cvt_pk_bf16_f32 v230, v240, v241
    v_cvt_pk_bf16_f32 v231, v242, v243
    s_nop 0
    v_permlane16_swap_b32 v228, v230
    v_permlane16_swap_b32 v229, v231
    s_nop 0
    v_mov_b32_dpp v196, v228 row_ror:8 row_mask:0xf bank_mask:0xc
    v_mov_b32_dpp v197, v229 row_ror:8 row_mask:0xf bank_mask:0xc
    v_mov_b32_dpp v198, v230 row_ror:8 row_mask:0xf bank_mask:0xc
    v_mov_b32_dpp v199, v231 row_ror:8 row_mask:0xf bank_mask:0xc
    buffer_store_dwordx4 v[196:199], v12, s[52:55], s86 offen sc1
    v_mov_b32_dpp v228, v212 row_ror:8 row_mask:0xf bank_mask:0x3
    v_mov_b32_dpp v229, v213 row_ror:8 row_mask:0xf bank_mask:0x3
    v_mov_b32_dpp v230, v214 row_ror:8 row_mask:0xf bank_mask:0x3
    v_mov_b32_dpp v231, v215 row_ror:8 row_mask:0xf bank_mask:0x3
    buffer_store_dwordx4 v[228:231], v12, s[52:55], s87 offen sc1
    s_endpgm
    .p2align 12
L_roleB:
    s_lshl3_add_u32 s76, s65, s72
    s_add_u32 s76, s76, 8
    s_lshl_b32 s76, s76, 7
    s_mov_b64 s[32:33], s[6:7]
    s_mov_b32 s34, 1572864
    s_mov_b32 s35, 0x20000
    v_mul_u32_u24 v28, 3072, v31
    v_lshl_add_u32 v44, v30, 4, v28
    v_xor_b32 v28, 64, v44
    v_add_u32 v45, 23552, v28
    v_add_u32 v46, 47104, v44
    v_add_u32 v47, 70656, v28
    s_add_u32 s93, s92, 1
    s_and_b32 s93, s93, 7
    s_add_u32 s94, s93, 1
    s_and_b32 s94, s94, 7
    s_add_u32 s95, s94, 1
    s_and_b32 s95, s95, 7
    s_add_u32 s96, s95, 1
    s_and_b32 s96, s96, 7
    s_add_u32 s97, s96, 1
    s_and_b32 s97, s97, 7
    s_add_u32 s98, s97, 1
    s_and_b32 s98, s98, 7
    s_add_u32 s99, s98, 1
    s_and_b32 s99, s99, 7
    s_mov_b64 s[48:49], s[24:25]
    s_mov_b32 s50, 11206656
    s_mov_b32 s51, 0x20000
    s_lshl1_add_u32 s79, s67, s65
    s_mul_i32 s85, s79, 294912
    s_lshl2_add_u32 s79, s79, s68
    s_lshl_b32 s88, s79, 7
    s_add_u32 s88, s88, 9830400
    s_lshl2_add_u32 s79, s79, s69
    s_lshl1_add_u32 s79, s79, s66
    s_lshl_b32 s3, s79, 1
    v_lshlrev_b32 v21, 4, v20
    v_lshrrev_b32 v28, 4, v20
    v_bfe_u32 v29, v20, 2, 2
    v_lshl_add_u32 v28, v28, 3, v29
    v_and_b32 v29, 3, v20
    v_lshlrev_b32 v29, 3, v29
    v_bfe_u32 v30, v20, 3, 2
    v_lshlrev_b32 v30, 5, v30
    v_lshl_add_u32 v31, v28, 7, v29
    v_or_b32 v31, v31, v30
    s_lshl_b32 s79, s66, 6
    v_xor_b32 v72, s79, v31
    v_xor_b32 v73, 32, v72
    v_add_u32 v74, 0x10000, v72
    v_add_u32 v75, 0x10000, v73
    v_add_u32 v80, s74, v31
    s_lshl_b32 s79, s65, 5
    v_xor_b32 v68, s79, v72
    v_xor_b32 v69, s79, v73
    v_xor_b32 v70, s79, v74
    v_xor_b32 v71, s79, v75
    v_lshl_add_u32 v31, v28, 6, v29
    v_bfe_u32 v30, v20, 4, 1
    v_lshl_or_b32 v76, v30, 5, v31
    v_and_b32 v28, 15, v20
    v_lshrrev_b32 v29, 4, v20
    v_bfe_u32 v30, v20, 1, 3
    v_xor_b32 v29, v29, v30
    v_lshlrev_b32 v29, 4, v29
    v_lshl_add_u32 v28, v28, 7, v29
    s_add_u32 s79, s74, 98304
    v_add_u32 v88, s79, v28
    v_xor_b32 v89, 64, v88
    v_xor_b32 v90, 0x1000, v88
    v_xor_b32 v91, 0x1000, v89
    s_mov_b64 exec, 0
    s_cmp_eq_u32 s64, 1
    s_cbranch_scc1 LB_pg2
    s_cmp_eq_u32 s64, 2
    s_cbranch_scc1 LB_pg3
    s_cmp_eq_u32 s64, 3
    s_cbranch_scc1 LB_pg4
    s_branch LB_pg1
LB_walked:
    s_mov_b64 exec, -1
    s_mov_b64 s[56:57], s[22:23]
    s_mov_b32 s58, 256
    s_mov_b32 s59, 0x20000
    s_mov_b64 s[60:61], s[18:19]
    s_mov_b32 s62, 1024
    s_mov_b32 s63, 0x20000
    s_mov_b64 s[40:41], s[16:17]
    s_mov_b32 s42, 1835008
    s_mov_b32 s43, 0x20000
    s_mov_b64 s[44:45], s[8:9]
    s_mov_b32 s46, 524288
    s_mov_b32 s47, 0x20000
    s_mov_b64 s[52:53], s[20:21]
    s_mov_b32 s54, 2097152
    s_mov_b32 s55, 0x20000
    v_mov_b32 v29, 0x40000000
    v_lshlrev_b32 v31, 7, v20
    s_and_b32 s1, s2, 255
    v_cmp_gt_u32 vcc, 14, v20
    s_lshl2_add_u32 s1, s1, s64
    s_mul_i32 s0, s1, 1792
    s_add_u32 m0, s74, 16384
    s_mul_i32 s78, s92, 196608
    s_add_u32 s78, s78, s76
    buffer_load_dwordx4 v44, s[32:35], s78 offen offset:0  lds
    v_cndmask_b32 v66, v29, v31, vcc
    v_cmp_gt_u32 vcc, 4, v20
    s_mul_i32 s1, s1, 512
    s_and_b32 s86, s69, 1
    v_cndmask_b32 v67, v29, v31, vcc
    s_lshl2_add_u32 s77, s68, 2
    s_cmp_eq_u32 s68, 3
    s_cselect_b32 s77, 22, s77
    s_lshl1_add_u32 s77, s77, s86
    s_lshl_b32 s77, s77, 6
    s_bfe_u32 s70, s2, 0x30003
    s_lshr_b32 s79, s2, 7
    s_xor_b32 s79, s79, s70
    s_and_b32 s79, s79, 1
    s_and_b32 s71, s69, 1
    s_xor_b32 s71, s71, 1
    s_lshl1_add_u32 s71, s71, s79
    s_and_b32 s79, s2, 1
    s_lshl2_add_u32 s71, s79, s71
    s_lshl3_add_u32 s70, s68, s70
    buffer_load_dwordx4 v45, s[32:35], s78 offen offset:1024  lds
    s_lshl1_add_u32 s90, s72, s66
    s_lshl1_add_u32 s90, s90, s65
    v_xor_b32 v81, 32, v80
    v_xor_b32 v82, 64, v80
    v_xor_b32 v83, 0x60, v80
    v_add_u32 v84, 0x10000, v80
    v_add_u32 v85, 0x10000, v81
    v_add_u32 v86, 0x10000, v82
    v_add_u32 v87, 0x10000, v83
    s_lshl4_add_u32 s22, s90, s67
    s_lshl_b32 s23, s22, 6
    s_lshl_b32 s22, s22, 9
    s_add_u32 s22, s22, 9437184
    s_lshl_b32 s90, s90, 7
    s_add_u32 s90, s90, 9850880
    s_add_u32 s23, s23, 9699328
    v_xor_b32 v77, 32, v76
    v_add_u32 v78, 0x10000, v76
    v_add_u32 v79, 0x10000, v77
    v_lshrrev_b32 v28, 2, v20
    v_mul_u32_u24 v28, 3584, v28
    buffer_load_dwordx4 v46, s[32:35], s78 offen offset:2048  lds
    v_lshrrev_b32 v29, 5, v20
    v_lshlrev_b32 v29, 1, v29
    v_and_b32 v30, 3, v20
    v_xor_b32 v29, v29, v30
    v_lshl_add_u32 v48, v29, 4, v28
    v_add_u32 v49, 56320, v48
    v_add_u32 v50, 112640, v48
    v_add_u32 v51, 168960, v48
    v_mov_b32 v92, 0x3f803f80
    v_mov_b32 v93, 0x3f803f80
    v_mov_b32 v94, 0x3f803f80
    v_mov_b32 v95, 0x3f803f80
    v_lshrrev_b32 v28, 5, v20
    v_bfe_u32 v29, v20, 3, 2
    v_lshl_add_u32 v28, v28, 4, v29
    v_lshlrev_b32 v28, 10, v28
    v_and_b32 v29, 2, v29
    v_and_b32 v30, 7, v20
    v_xor_b32 v29, v29, v30
    v_lshl_add_u32 v52, v29, 4, v28
    buffer_load_dwordx4 v47, s[32:35], s78 offen offset:3072  lds
    v_xor_b32 v28, 64, v52
    v_add_u32 v53, 3072, v28
    v_add_u32 v54, 6144, v52
    v_add_u32 v55, 9216, v28
    v_lshl_or_b32 v56, s64, 10, v21
    v_xor_b32 v57, 1024, v56
    v_xor_b32 v58, 2048, v56
    v_xor_b32 v59, 3072, v56
    v_and_b32 v28, 15, v20
    v_lshlrev_b32 v22, 2, v28
    v_mov_b32 v29, 0x40000000
    v_cmp_gt_u32 vcc, 1, v28
    v_and_b32 v30, 48, v20
    v_lshl_add_u32 v30, v28, 6, v30
    v_cndmask_b32 v23, v29, v30, vcc
    v_and_b32 v30, 16, v20
    v_cmp_eq_u32 vcc, 0, v30
    v_lshrrev_b32 v30, 1, v20
    v_and_b32 v30, 16, v30
    v_add_lshl_u32 v30, v30, v28, 4
    s_add_u32 m0, s74, 147456
    s_mul_i32 s78, s93, 128
    s_add_u32 s78, s78, s73
    buffer_load_dwordx4 v36, s[28:31], s78 offen offset:0  lds
    v_cndmask_b32 v64, v29, v30, vcc
    v_and_b32 v28, 31, v20
    v_cmp_eq_u32 vcc, 0, v28
    v_lshrrev_b32 v30, 3, v20
    s_mul_i32 s79, s70, 294912
    v_cndmask_b32 v24, v29, v30, vcc
    s_lshl2_add_u32 s81, s74, s79
    s_lshl1_add_u32 s82, s74, s79
    s_lshl_b32 s79, s71, 7
    s_lshl4_add_u32 s84, s74, s79
    s_lshl4_add_u32 s83, s74, s84
    s_xor_b32 s83, s83, 0x40000
    s_lshl2_add_u32 s84, s64, 2
    s_lshl3_add_u32 vcc_lo, s64, 4
    s_cmp_eq_u32 s64, 3
    s_cselect_b32 s84, 22, s84
    s_cmp_eq_u32 s64, 3
    s_cselect_b32 vcc_lo, 14, vcc_lo
    s_cmp_eq_u32 s64, 3
    s_cselect_b32 vcc_hi, 4, 1
    s_lshl_b32 s84, s84, 16
    buffer_load_dwordx4 v37, s[28:31], s78 offen offset:1024  lds
    s_add_u32 s84, s84, s79
    s_lshl_b32 vcc_lo, vcc_lo, 16
    s_add_u32 vcc_lo, vcc_lo, s79
    s_lshl_b32 vcc_hi, vcc_hi, 16
    s_lshl_b32 s10, s64, 19
    s_add_u32 s10, s10, s79
    s_mov_b32 s11, 0x10000
    s_lshl2_add_u32 s79, s70, s64
    s_lshl_b32 s89, s79, 7
    s_add_u32 s89, s89, 9830400
    s_cmp_eq_u32 s66, 0
    s_cselect_b32 s24, s92, s93
    s_cmp_eq_u32 s66, 0
    s_cselect_b32 s25, s94, s95
    s_cmp_eq_u32 s66, 0
    s_cselect_b32 s26, s96, s97
    s_cmp_eq_u32 s66, 0
    s_cselect_b32 s27, s98, s99
    s_bfe_u32 s87, s70, 0x10001
    s_lshl_b32 s79, s87, 13
    buffer_load_dwordx4 v38, s[28:31], s78 offen offset:2048  lds
    s_sub_u32 s18, s81, s79
    s_add_u32 s81, s81, s79
    s_lshl_b32 s79, s87, 12
    s_sub_u32 s19, s82, s79
    s_add_u32 s82, s82, s79
    s_lshl_b32 s79, s87, 16
    s_sub_u32 s20, s83, s79
    s_add_u32 s83, s83, s79
    s_lshl_b32 s79, s87, 15
    s_sub_u32 s21, s84, s79
    s_add_u32 s84, s84, s79
    s_mov_b64 s[12:13], s[10:11]
    s_cmp_eq_u32 s87, 0
    s_cselect_b64 s[10:11], s[12:13], vcc
    s_cmp_eq_u32 s87, 0
    s_cselect_b64 vcc, vcc, s[12:13]
    s_mov_b32 s12, 1
    s_mov_b32 s13, 1
    s_mov_b32 s14, 1
    s_mov_b32 s15, 1
    buffer_load_dwordx4 v39, s[28:31], s78 offen offset:3072  lds
    s_waitcnt vmcnt(8)
    s_barrier
    ds_read_b128 a[0:3], v88 offset:32768
    ds_read_b128 a[4:7], v88 offset:34816
    ds_read_b128 a[8:11], v90 offset:32768
    ds_read_b128 a[12:15], v90 offset:34816
    ds_read_b64_tr_b16 v[104:105], v72 offset:0
    ds_read_b64_tr_b16 v[106:107], v72 offset:512
    ds_read_b64_tr_b16 v[108:109], v72 offset:4096
    ds_read_b64_tr_b16 v[110:111], v72 offset:4608
    ds_read_b128 a[16:19], v89 offset:32768
    ds_read_b128 a[20:23], v89 offset:34816
    ds_read_b128 a[24:27], v91 offset:32768
    ds_read_b128 a[28:31], v91 offset:34816
    ds_read_b64_tr_b16 v[112:113], v73 offset:0
    ds_read_b64_tr_b16 v[114:115], v73 offset:512
    ds_read_b64_tr_b16 v[116:117], v73 offset:4096
    ds_read_b64_tr_b16 v[118:119], v73 offset:4608
    s_waitcnt lgkmcnt(4)
    v_mfma_f32_16x16x32_bf16 v[192:195], v[104:107], a[0:3], 0
    ds_read_b64_tr_b16 v[120:121], v72 offset:8192
    s_add_u32 m0, s74, 32768
    v_mfma_f32_16x16x32_bf16 v[192:195], v[108:111], a[16:19], v[192:195]
    s_mul_i32 s78, s93, 196608
    s_add_u32 s78, s78, s76
    buffer_load_dwordx4 v44, s[32:35], s78 offen offset:0  lds
    v_mfma_f32_16x16x32_bf16 v[196:199], v[104:107], a[4:7], 0
    ds_read_b64_tr_b16 v[122:123], v72 offset:8704
    v_mfma_f32_16x16x32_bf16 v[196:199], v[108:111], a[20:23], v[196:199]
    buffer_load_dwordx4 v45, s[32:35], s78 offen offset:1024  lds
    v_mfma_f32_16x16x32_bf16 v[200:203], v[104:107], a[8:11], 0
    ds_read_b64_tr_b16 v[124:125], v72 offset:12288
    v_mfma_f32_16x16x32_bf16 v[200:203], v[108:111], a[24:27], v[200:203]
    buffer_load_dwordx4 v46, s[32:35], s78 offen offset:2048  lds
    v_mfma_f32_16x16x32_bf16 v[204:207], v[104:107], a[12:15], 0
    ds_read_b64_tr_b16 v[126:127], v72 offset:12800
    v_mfma_f32_16x16x32_bf16 v[204:207], v[108:111], a[28:31], v[204:207]
    s_waitcnt lgkmcnt(4)
    buffer_load_dwordx4 v47, s[32:35], s78 offen offset:3072  lds
    v_mfma_f32_16x16x32_bf16 v[220:223], v[112:115], a[12:15], 0
    ds_read_b64_tr_b16 v[104:105], v73 offset:8192
    s_add_u32 m0, s74, 114688
    v_mfma_f32_16x16x32_bf16 v[220:223], v[116:119], a[28:31], v[220:223]
    s_mul_i32 s78, s94, 128
    s_add_u32 s78, s78, s73
    buffer_load_dwordx4 v36, s[28:31], s78 offen offset:0  lds
    v_mfma_f32_16x16x32_bf16 v[216:219], v[112:115], a[8:11], 0
    ds_read_b64_tr_b16 v[106:107], v73 offset:8704
    v_mfma_f32_16x16x32_bf16 v[216:219], v[116:119], a[24:27], v[216:219]
    v_mfma_f32_16x16x32_bf16 v[212:215], v[112:115], a[4:7], 0
    ds_read_b64_tr_b16 v[108:109], v73 offset:12288
    v_mfma_f32_16x16x32_bf16 v[212:215], v[116:119], a[20:23], v[212:215]
    buffer_load_dwordx4 v37, s[28:31], s78 offen offset:1024  lds
    v_mfma_f32_16x16x32_bf16 v[208:211], v[112:115], a[0:3], 0
    ds_read_b64_tr_b16 v[110:111], v73 offset:12800
    v_mfma_f32_16x16x32_bf16 v[208:211], v[116:119], a[16:19], v[208:211]
    s_waitcnt vmcnt(10) lgkmcnt(4)
    s_barrier
    v_mfma_f32_16x16x32_bf16 v[224:227], v[120:123], a[0:3], 0
    ds_read_b64_tr_b16 v[112:113], v68 offset:16384
    v_mfma_f32_16x16x32_bf16 v[224:227], v[124:127], a[16:19], v[224:227]
    buffer_load_dwordx4 v38, s[28:31], s78 offen offset:2048  lds
    v_mfma_f32_16x16x32_bf16 v[228:231], v[120:123], a[4:7], 0
    ds_read_b64_tr_b16 v[114:115], v68 offset:16896
    v_mfma_f32_16x16x32_bf16 v[228:231], v[124:127], a[20:23], v[228:231]
    v_mfma_f32_16x16x32_bf16 v[232:235], v[120:123], a[8:11], 0
    ds_read_b64_tr_b16 v[116:117], v68 offset:20480
    v_mfma_f32_16x16x32_bf16 v[232:235], v[124:127], a[24:27], v[232:235]
    buffer_load_dwordx4 v39, s[28:31], s78 offen offset:3072  lds
    v_mfma_f32_16x16x32_bf16 v[236:239], v[120:123], a[12:15], 0
    ds_read_b64_tr_b16 v[118:119], v68 offset:20992
    s_add_u32 m0, s74, 49152
    v_mfma_f32_16x16x32_bf16 v[236:239], v[124:127], a[28:31], v[236:239]
    s_waitcnt lgkmcnt(4)
    s_mul_i32 s78, s94, 196608
    s_add_u32 s78, s78, s76
    v_mfma_f32_16x16x32_bf16 v[252:255], v[104:107], a[12:15], 0
    ds_read_b64_tr_b16 v[120:121], v69 offset:16384
    v_mfma_f32_16x16x32_bf16 v[252:255], v[108:111], a[28:31], v[252:255]
    buffer_load_dwordx4 v44, s[32:35], s78 offen offset:0  lds
    v_mfma_f32_16x16x32_bf16 v[248:251], v[104:107], a[8:11], 0
    ds_read_b64_tr_b16 v[122:123], v69 offset:16896
    v_mfma_f32_16x16x32_bf16 v[248:251], v[108:111], a[24:27], v[248:251]
    buffer_load_dwordx4 v45, s[32:35], s78 offen offset:1024  lds
    v_mfma_f32_16x16x32_bf16 v[244:247], v[104:107], a[4:7], 0
    ds_read_b64_tr_b16 v[124:125], v69 offset:20480
    v_mfma_f32_16x16x32_bf16 v[244:247], v[108:111], a[20:23], v[244:247]
    buffer_load_dwordx4 v46, s[32:35], s78 offen offset:2048  lds
    v_mfma_f32_16x16x32_bf16 v[240:243], v[104:107], a[0:3], 0
    ds_read_b64_tr_b16 v[126:127], v69 offset:20992
    v_mfma_f32_16x16x32_bf16 v[240:243], v[108:111], a[16:19], v[240:243]
    s_waitcnt lgkmcnt(4)
    v_mfma_f32_16x16x32_bf16 v[128:131], a[0:3], v[112:115], 0
    ds_read_b64_tr_b16 v[104:105], v68 offset:24576
    v_mfma_f32_16x16x32_bf16 v[128:131], a[16:19], v[116:119], v[128:131]
    buffer_load_dwordx4 v47, s[32:35], s78 offen offset:3072  lds
    v_mfma_f32_16x16x32_bf16 v[132:135], a[4:7], v[112:115], 0
    ds_read_b64_tr_b16 v[106:107], v68 offset:25088
    s_add_u32 m0, s74, 131072
    v_mfma_f32_16x16x32_bf16 v[132:135], a[20:23], v[116:119], v[132:135]
    s_mul_i32 s78, s95, 128
    s_add_u32 s78, s78, s73
    v_mfma_f32_16x16x32_bf16 v[136:139], a[8:11], v[112:115], 0
    ds_read_b64_tr_b16 v[108:109], v68 offset:28672
    v_mfma_f32_16x16x32_bf16 v[136:139], a[24:27], v[116:119], v[136:139]
    buffer_load_dwordx4 v36, s[28:31], s78 offen offset:0  lds
    v_mfma_f32_16x16x32_bf16 v[140:143], a[12:15], v[112:115], 0
    ds_read_b64_tr_b16 v[110:111], v68 offset:29184
    v_mfma_f32_16x16x32_bf16 v[140:143], a[28:31], v[116:119], v[140:143]
    s_waitcnt lgkmcnt(4)
    v_mfma_f32_16x16x32_bf16 v[156:159], a[12:15], v[120:123], 0
    ds_read_b64_tr_b16 v[112:113], v69 offset:24576
    v_mfma_f32_16x16x32_bf16 v[156:159], a[28:31], v[124:127], v[156:159]
    buffer_load_dwordx4 v37, s[28:31], s78 offen offset:1024  lds
    v_mfma_f32_16x16x32_bf16 v[152:155], a[8:11], v[120:123], 0
    ds_read_b64_tr_b16 v[114:115], v69 offset:25088
    v_mfma_f32_16x16x32_bf16 v[152:155], a[24:27], v[124:127], v[152:155]
    buffer_load_dwordx4 v38, s[28:31], s78 offen offset:2048  lds
    v_mfma_f32_16x16x32_bf16 v[148:151], a[4:7], v[120:123], 0
    ds_read_b64_tr_b16 v[116:117], v69 offset:28672
    v_mfma_f32_16x16x32_bf16 v[148:151], a[20:23], v[124:127], v[148:151]
    buffer_load_dwordx4 v39, s[28:31], s78 offen offset:3072  lds
    v_mfma_f32_16x16x32_bf16 v[144:147], a[0:3], v[120:123], 0
    ds_read_b64_tr_b16 v[118:119], v69 offset:29184
    s_lshl_b32 s3, s3, 10
    v_mfma_f32_16x16x32_bf16 v[144:147], a[16:19], v[124:127], v[144:147]
    s_waitcnt vmcnt(12) lgkmcnt(4)
    s_barrier
    v_mfma_f32_16x16x32_bf16 v[160:163], a[0:3], v[104:107], 0
    ds_read_b128 a[32:35], v88 offset:49152
    v_mfma_f32_16x16x32_bf16 v[160:163], a[16:19], v[108:111], v[160:163]
    ds_read_b128 a[36:39], v88 offset:51200
    buffer_load_dwordx4 v[4:7], v21, s[28:31], s3 offen offset:0
    v_mfma_f32_16x16x32_bf16 v[164:167], a[4:7], v[104:107], 0
    ds_read_b128 a[40:43], v90 offset:49152
    v_mfma_f32_16x16x32_bf16 v[164:167], a[20:23], v[108:111], v[164:167]
    ds_read_b128 a[44:47], v90 offset:51200
    buffer_load_dwordx4 v[8:11], v21, s[28:31], s3 offen offset:1024
    v_mfma_f32_16x16x32_bf16 v[168:171], a[8:11], v[104:107], 0
    ds_read_b64_tr_b16 v[120:121], v68 offset:32768
    v_mfma_f32_16x16x32_bf16 v[168:171], a[24:27], v[108:111], v[168:171]
    ds_read_b64_tr_b16 v[122:123], v68 offset:33280
    buffer_load_dwordx4 v[12:15], v21, s[60:63], 0 offen
    v_mfma_f32_16x16x32_bf16 v[172:175], a[12:15], v[104:107], 0
    ds_read_b64_tr_b16 v[124:125], v68 offset:36864
    s_lshr_b32 s3, s3, 8
    v_mfma_f32_16x16x32_bf16 v[172:175], a[28:31], v[108:111], v[172:175]
    s_waitcnt lgkmcnt(7)
    ds_read_b64_tr_b16 v[126:127], v68 offset:37376
    v_mfma_f32_16x16x32_bf16 v[188:191], a[12:15], v[112:115], 0
    ds_read_b128 a[48:51], v89 offset:49152
    s_add_u32 s3, s3, 9764864
    v_mfma_f32_16x16x32_bf16 v[188:191], a[28:31], v[116:119], v[188:191]
    ds_read_b128 a[52:55], v89 offset:51200
    s_add_u32 m0, s74, 65536
    s_mul_i32 s78, s95, 196608
    s_add_u32 s78, s78, s76
    buffer_load_dwordx4 v44, s[32:35], s78 offen offset:0  lds
    v_mfma_f32_16x16x32_bf16 v[184:187], a[8:11], v[112:115], 0
    ds_read_b128 a[56:59], v91 offset:49152
    v_mfma_f32_16x16x32_bf16 v[184:187], a[24:27], v[116:119], v[184:187]
    ds_read_b128 a[60:63], v91 offset:51200
    buffer_load_dwordx4 v45, s[32:35], s78 offen offset:1024  lds
    v_mfma_f32_16x16x32_bf16 v[180:183], a[4:7], v[112:115], 0
    ds_read_b64_tr_b16 v[104:105], v69 offset:32768
    v_mfma_f32_16x16x32_bf16 v[180:183], a[20:23], v[116:119], v[180:183]
    ds_read_b64_tr_b16 v[106:107], v69 offset:33280
    buffer_load_dwordx4 v46, s[32:35], s78 offen offset:2048  lds
    v_mfma_f32_16x16x32_bf16 v[176:179], a[0:3], v[112:115], 0
    ds_read_b64_tr_b16 v[108:109], v69 offset:36864
    v_mfma_f32_16x16x32_bf16 v[176:179], a[16:19], v[116:119], v[176:179]
    s_waitcnt lgkmcnt(3)
    ds_read_b64_tr_b16 v[110:111], v69 offset:37376
    v_mfma_f32_16x16x32_bf16 v[128:131], a[32:35], v[120:123], v[128:131]
    ds_read_b64_tr_b16 v[112:113], v68 offset:40960
    v_mfma_f32_16x16x32_bf16 v[128:131], a[48:51], v[124:127], v[128:131]
    buffer_load_dwordx4 v47, s[32:35], s78 offen offset:3072  lds
    v_mfma_f32_16x16x32_bf16 v[132:135], a[36:39], v[120:123], v[132:135]
    ds_read_b64_tr_b16 v[114:115], v68 offset:41472
    s_add_u32 m0, s74, 81920
    v_mfma_f32_16x16x32_bf16 v[132:135], a[52:55], v[124:127], v[132:135]
    s_mul_i32 s78, s93, 229376
    s_add_u32 s78, s78, s75
    buffer_load_dwordx4 v40, s[36:39], s78 offen offset:0  lds
    v_mfma_f32_16x16x32_bf16 v[136:139], a[40:43], v[120:123], v[136:139]
    ds_read_b64_tr_b16 v[116:117], v68 offset:45056
    v_mfma_f32_16x16x32_bf16 v[136:139], a[56:59], v[124:127], v[136:139]
    buffer_load_dwordx4 v41, s[36:39], s78 offen offset:1024  lds
    v_mfma_f32_16x16x32_bf16 v[140:143], a[44:47], v[120:123], v[140:143]
    ds_read_b64_tr_b16 v[118:119], v68 offset:45568
    v_mfma_f32_16x16x32_bf16 v[140:143], a[60:63], v[124:127], v[140:143]
    s_waitcnt lgkmcnt(4)
    v_mfma_f32_16x16x32_bf16 v[156:159], a[44:47], v[104:107], v[156:159]
    ds_read_b64_tr_b16 v[120:121], v69 offset:40960
    v_mfma_f32_16x16x32_bf16 v[156:159], a[60:63], v[108:111], v[156:159]
    buffer_load_dwordx4 v42, s[36:39], s78 offen offset:2048  lds
    v_mfma_f32_16x16x32_bf16 v[152:155], a[40:43], v[104:107], v[152:155]
    ds_read_b64_tr_b16 v[122:123], v69 offset:41472
    v_mfma_f32_16x16x32_bf16 v[152:155], a[56:59], v[108:111], v[152:155]
    buffer_load_dwordx4 v43, s[36:39], s78 offen offset:3072  lds
    v_mfma_f32_16x16x32_bf16 v[148:151], a[36:39], v[104:107], v[148:151]
    ds_read_b64_tr_b16 v[124:125], v69 offset:45056
    s_add_u32 m0, s74, 147456
    v_mfma_f32_16x16x32_bf16 v[148:151], a[52:55], v[108:111], v[148:151]
    s_mul_i32 s78, s96, 128
    s_add_u32 s78, s78, s73
    v_mfma_f32_16x16x32_bf16 v[144:147], a[32:35], v[104:107], v[144:147]
    ds_read_b64_tr_b16 v[126:127], v69 offset:45568
    v_mfma_f32_16x16x32_bf16 v[144:147], a[48:51], v[108:111], v[144:147]
    s_waitcnt vmcnt(15) lgkmcnt(4)
    s_barrier
    v_mfma_f32_16x16x32_bf16 v[160:163], a[32:35], v[112:115], v[160:163]
    ds_read_b128 a[64:67], v88 offset:16384
    v_mfma_f32_16x16x32_bf16 v[160:163], a[48:51], v[116:119], v[160:163]
    ds_read_b128 a[68:71], v88 offset:18432
    buffer_load_dwordx4 v36, s[28:31], s78 offen offset:0  lds
    v_mfma_f32_16x16x32_bf16 v[164:167], a[36:39], v[112:115], v[164:167]
    ds_read_b128 a[72:75], v90 offset:16384
    v_mfma_f32_16x16x32_bf16 v[164:167], a[52:55], v[116:119], v[164:167]
    ds_read_b128 a[76:79], v90 offset:18432
    buffer_load_dwordx4 v37, s[28:31], s78 offen offset:1024  lds
    v_mfma_f32_16x16x32_bf16 v[168:171], a[40:43], v[112:115], v[168:171]
    ds_read_b64_tr_b16 v[104:105], v68 offset:49152
    v_mfma_f32_16x16x32_bf16 v[168:171], a[56:59], v[116:119], v[168:171]
    ds_read_b64_tr_b16 v[106:107], v68 offset:49664
    buffer_load_dwordx4 v38, s[28:31], s78 offen offset:2048  lds
    v_mfma_f32_16x16x32_bf16 v[172:175], a[44:47], v[112:115], v[172:175]
    ds_read_b64_tr_b16 v[108:109], v68 offset:53248
    v_mfma_f32_16x16x32_bf16 v[172:175], a[60:63], v[116:119], v[172:175]
    s_waitcnt lgkmcnt(7)
    ds_read_b64_tr_b16 v[110:111], v68 offset:53760
    v_mfma_f32_16x16x32_bf16 v[188:191], a[44:47], v[120:123], v[188:191]
    ds_read_b128 a[80:83], v89 offset:16384
    v_mfma_f32_16x16x32_bf16 v[188:191], a[60:63], v[124:127], v[188:191]
    ds_read_b128 a[84:87], v89 offset:18432
    buffer_load_dwordx4 v39, s[28:31], s78 offen offset:3072  lds
    v_mfma_f32_16x16x32_bf16 v[184:187], a[40:43], v[120:123], v[184:187]
    ds_read_b128 a[88:91], v91 offset:16384
    s_add_u32 m0, s74, 98304
    v_mfma_f32_16x16x32_bf16 v[184:187], a[56:59], v[124:127], v[184:187]
    ds_read_b128 a[92:95], v91 offset:18432
    s_mul_i32 s78, s96, 196608
    s_add_u32 s78, s78, s76
    buffer_load_dwordx4 v44, s[32:35], s78 offen offset:0  lds
    v_mfma_f32_16x16x32_bf16 v[180:183], a[36:39], v[120:123], v[180:183]
    ds_read_b64_tr_b16 v[112:113], v69 offset:49152
    v_mov_b32 v25, 0
    v_mfma_f32_16x16x32_bf16 v[180:183], a[52:55], v[124:127], v[180:183]
    ds_read_b64_tr_b16 v[114:115], v69 offset:49664
    buffer_load_dwordx4 v45, s[32:35], s78 offen offset:1024  lds
    v_mfma_f32_16x16x32_bf16 v[176:179], a[32:35], v[120:123], v[176:179]
    ds_read_b64_tr_b16 v[116:117], v69 offset:53248
    v_mov_b32 v16, 0
    v_mfma_f32_16x16x32_bf16 v[176:179], a[48:51], v[124:127], v[176:179]
    s_waitcnt lgkmcnt(3)
    ds_read_b64_tr_b16 v[118:119], v69 offset:53760
    v_mfma_f32_16x16x32_bf16 v[128:131], a[64:67], v[104:107], v[128:131]
    ds_read_b64_tr_b16 v[120:121], v68 offset:57344
    s_waitcnt vmcnt(14)
    v_lshlrev_b32 v29, 16, v12
    v_mfma_f32_16x16x32_bf16 v[128:131], a[80:83], v[108:111], v[128:131]
    buffer_load_dwordx4 v46, s[32:35], s78 offen offset:2048  lds
    v_mfma_f32_16x16x32_bf16 v[132:135], a[68:71], v[104:107], v[132:135]
    ds_read_b64_tr_b16 v[122:123], v68 offset:57856
    v_and_b32 v12, 0xffff0000, v12
    v_mfma_f32_16x16x32_bf16 v[132:135], a[84:87], v[108:111], v[132:135]
    buffer_load_dwordx4 v47, s[32:35], s78 offen offset:3072  lds
    v_mfma_f32_16x16x32_bf16 v[136:139], a[72:75], v[104:107], v[136:139]
    ds_read_b64_tr_b16 v[124:125], v68 offset:61440
    s_add_u32 m0, s74, 114688
    v_mfma_f32_16x16x32_bf16 v[136:139], a[88:91], v[108:111], v[136:139]
    s_mul_i32 s78, s97, 128
    s_add_u32 s78, s78, s73
    v_lshlrev_b32 v28, 16, v4
    v_mfma_f32_16x16x32_bf16 v[140:143], a[76:79], v[104:107], v[140:143]
    ds_read_b64_tr_b16 v[126:127], v68 offset:61952
    v_and_b32 v4, 0xffff0000, v4
    v_mfma_f32_16x16x32_bf16 v[140:143], a[92:95], v[108:111], v[140:143]
    s_waitcnt lgkmcnt(4)
    v_fmac_f32 v25, v28, v29
    v_fmac_f32 v25, v4, v12
    v_mfma_f32_16x16x32_bf16 v[156:159], a[76:79], v[112:115], v[156:159]
    ds_read_b64_tr_b16 v[104:105], v69 offset:57344
    v_lshlrev_b32 v28, 16, v8
    v_mfma_f32_16x16x32_bf16 v[156:159], a[92:95], v[116:119], v[156:159]
    v_and_b32 v8, 0xffff0000, v8
    v_fmac_f32 v16, v28, v29
    v_mfma_f32_16x16x32_bf16 v[152:155], a[72:75], v[112:115], v[152:155]
    ds_read_b64_tr_b16 v[106:107], v69 offset:57856
    v_fmac_f32 v16, v8, v12
    v_mfma_f32_16x16x32_bf16 v[152:155], a[88:91], v[116:119], v[152:155]
    v_lshlrev_b32 v29, 16, v13
    v_and_b32 v13, 0xffff0000, v13
    v_mfma_f32_16x16x32_bf16 v[148:151], a[68:71], v[112:115], v[148:151]
    ds_read_b64_tr_b16 v[108:109], v69 offset:61440
    v_lshlrev_b32 v28, 16, v5
    v_mfma_f32_16x16x32_bf16 v[148:151], a[84:87], v[116:119], v[148:151]
    v_and_b32 v5, 0xffff0000, v5
    v_fmac_f32 v25, v28, v29
    v_mfma_f32_16x16x32_bf16 v[144:147], a[64:67], v[112:115], v[144:147]
    ds_read_b64_tr_b16 v[110:111], v69 offset:61952
    v_fmac_f32 v25, v5, v13
    v_mfma_f32_16x16x32_bf16 v[144:147], a[80:83], v[116:119], v[144:147]
    s_waitcnt vmcnt(12) lgkmcnt(4)
    s_barrier
    v_lshlrev_b32 v28, 16, v9
    v_mfma_f32_16x16x32_bf16 v[160:163], a[64:67], v[120:123], v[160:163]
    ds_read_b128 a[96:99], v88 offset:32768
    v_and_b32 v9, 0xffff0000, v9
    v_mfma_f32_16x16x32_bf16 v[160:163], a[80:83], v[124:127], v[160:163]
    ds_read_b128 a[100:103], v88 offset:34816
    buffer_load_dwordx4 v36, s[28:31], s78 offen offset:0  lds
    v_mfma_f32_16x16x32_bf16 v[164:167], a[68:71], v[120:123], v[164:167]
    ds_read_b128 a[104:107], v90 offset:32768
    v_fmac_f32 v16, v28, v29
    v_mfma_f32_16x16x32_bf16 v[164:167], a[84:87], v[124:127], v[164:167]
    ds_read_b128 a[108:111], v90 offset:34816
    buffer_load_dwordx4 v37, s[28:31], s78 offen offset:1024  lds
    v_mfma_f32_16x16x32_bf16 v[168:171], a[72:75], v[120:123], v[168:171]
    ds_read_b64_tr_b16 v[112:113], v70 offset:0
    v_fmac_f32 v16, v9, v13
    v_mfma_f32_16x16x32_bf16 v[168:171], a[88:91], v[124:127], v[168:171]
    ds_read_b64_tr_b16 v[114:115], v70 offset:512
    buffer_load_dwordx4 v38, s[28:31], s78 offen offset:2048  lds
    v_mfma_f32_16x16x32_bf16 v[172:175], a[76:79], v[120:123], v[172:175]
    ds_read_b64_tr_b16 v[116:117], v70 offset:4096
    v_lshlrev_b32 v29, 16, v14
    v_mfma_f32_16x16x32_bf16 v[172:175], a[92:95], v[124:127], v[172:175]
    s_waitcnt lgkmcnt(7)
    ds_read_b64_tr_b16 v[118:119], v70 offset:4608
    v_mfma_f32_16x16x32_bf16 v[188:191], a[76:79], v[104:107], v[188:191]
    ds_read_b128 a[112:115], v89 offset:32768
    v_and_b32 v14, 0xffff0000, v14
    v_mfma_f32_16x16x32_bf16 v[188:191], a[92:95], v[108:111], v[188:191]
    ds_read_b128 a[116:119], v89 offset:34816
    buffer_load_dwordx4 v39, s[28:31], s78 offen offset:3072  lds
    v_mfma_f32_16x16x32_bf16 v[184:187], a[72:75], v[104:107], v[184:187]
    ds_read_b128 a[120:123], v91 offset:32768
    v_lshlrev_b32 v28, 16, v6
    v_mfma_f32_16x16x32_bf16 v[184:187], a[88:91], v[108:111], v[184:187]
    ds_read_b128 a[124:127], v91 offset:34816
    buffer_load_dword v62, v66, s[40:43], s0 offen
    buffer_load_dword v63, v67, s[44:47], s1 offen
    v_mfma_f32_16x16x32_bf16 v[180:183], a[68:71], v[104:107], v[180:183]
    ds_read_b64_tr_b16 v[120:121], v71 offset:0
    s_add_u32 m0, s74, 0
    v_mfma_f32_16x16x32_bf16 v[180:183], a[84:87], v[108:111], v[180:183]
    ds_read_b64_tr_b16 v[122:123], v71 offset:512
    s_mul_i32 s78, s97, 196608
    v_mfma_f32_16x16x32_bf16 v[176:179], a[64:67], v[104:107], v[176:179]
    ds_read_b64_tr_b16 v[124:125], v71 offset:4096
    s_add_u32 s78, s78, s76
    v_mfma_f32_16x16x32_bf16 v[176:179], a[80:83], v[108:111], v[176:179]
    s_waitcnt lgkmcnt(3)
    ds_read_b64_tr_b16 v[126:127], v71 offset:4608
    v_mfma_f32_16x16x32_bf16 v[128:131], a[96:99], v[112:115], v[128:131]
    ds_read_b64_tr_b16 v[104:105], v70 offset:8192
    v_and_b32 v6, 0xffff0000, v6
    v_mfma_f32_16x16x32_bf16 v[128:131], a[112:115], v[116:119], v[128:131]
    buffer_load_dwordx4 v44, s[32:35], s78 offen offset:0  lds
    v_mfma_f32_16x16x32_bf16 v[132:135], a[100:103], v[112:115], v[132:135]
    ds_read_b64_tr_b16 v[106:107], v70 offset:8704
    v_fmac_f32 v25, v28, v29
    v_mfma_f32_16x16x32_bf16 v[132:135], a[116:119], v[116:119], v[132:135]
    buffer_load_dwordx4 v45, s[32:35], s78 offen offset:1024  lds
    v_mfma_f32_16x16x32_bf16 v[136:139], a[104:107], v[112:115], v[136:139]
    ds_read_b64_tr_b16 v[108:109], v70 offset:12288
    v_fmac_f32 v25, v6, v14
LB_pg1:
    s_cbranch_execz LB_pg5
    v_mfma_f32_16x16x32_bf16 v[136:139], a[120:123], v[116:119], v[136:139]
    buffer_load_dwordx4 v46, s[32:35], s78 offen offset:2048  lds
    v_mfma_f32_16x16x32_bf16 v[140:143], a[108:111], v[112:115], v[140:143]
    ds_read_b64_tr_b16 v[110:111], v70 offset:12800
    v_lshlrev_b32 v28, 16, v10
    v_mfma_f32_16x16x32_bf16 v[140:143], a[124:127], v[116:119], v[140:143]
    s_waitcnt lgkmcnt(4)
    buffer_load_dwordx4 v47, s[32:35], s78 offen offset:3072  lds
    v_mfma_f32_16x16x32_bf16 v[156:159], a[108:111], v[120:123], v[156:159]
    ds_read_b64_tr_b16 v[112:113], v71 offset:8192
    s_add_u32 m0, s74, 131072
    v_mfma_f32_16x16x32_bf16 v[156:159], a[124:127], v[124:127], v[156:159]
    s_mul_i32 s78, s98, 128
    s_add_u32 s78, s78, s73
    v_and_b32 v10, 0xffff0000, v10
    v_mfma_f32_16x16x32_bf16 v[152:155], a[104:107], v[120:123], v[152:155]
    ds_read_b64_tr_b16 v[114:115], v71 offset:8704
    v_fmac_f32 v16, v28, v29
    v_mfma_f32_16x16x32_bf16 v[152:155], a[120:123], v[124:127], v[152:155]
    v_fmac_f32 v16, v10, v14
    v_lshlrev_b32 v29, 16, v15
    v_mfma_f32_16x16x32_bf16 v[148:151], a[100:103], v[120:123], v[148:151]
    ds_read_b64_tr_b16 v[116:117], v71 offset:12288
    v_and_b32 v15, 0xffff0000, v15
    v_mfma_f32_16x16x32_bf16 v[148:151], a[116:119], v[124:127], v[148:151]
    v_lshlrev_b32 v28, 16, v7
    v_and_b32 v7, 0xffff0000, v7
    v_mfma_f32_16x16x32_bf16 v[144:147], a[96:99], v[120:123], v[144:147]
    ds_read_b64_tr_b16 v[118:119], v71 offset:12800
    v_fmac_f32 v25, v28, v29
    v_mfma_f32_16x16x32_bf16 v[144:147], a[112:115], v[124:127], v[144:147]
    s_waitcnt vmcnt(18) lgkmcnt(4)
    s_barrier
    v_fmac_f32 v25, v7, v15
    v_mfma_f32_16x16x32_bf16 v[160:163], a[96:99], v[104:107], v[160:163]
    ds_read_b64_tr_b16 v[120:121], v74 offset:16384
    v_lshlrev_b32 v28, 16, v11
    v_mfma_f32_16x16x32_bf16 v[160:163], a[112:115], v[108:111], v[160:163]
    buffer_load_dwordx4 v36, s[28:31], s78 offen offset:0  lds
    v_mfma_f32_16x16x32_bf16 v[164:167], a[100:103], v[104:107], v[164:167]
    ds_read_b64_tr_b16 v[122:123], v74 offset:16896
    v_and_b32 v11, 0xffff0000, v11
    v_mfma_f32_16x16x32_bf16 v[164:167], a[116:119], v[108:111], v[164:167]
    buffer_load_dwordx4 v37, s[28:31], s78 offen offset:1024  lds
    v_mfma_f32_16x16x32_bf16 v[168:171], a[104:107], v[104:107], v[168:171]
    ds_read_b64_tr_b16 v[124:125], v74 offset:20480
    v_fmac_f32 v16, v28, v29
    v_mfma_f32_16x16x32_bf16 v[168:171], a[120:123], v[108:111], v[168:171]
    buffer_load_dwordx4 v38, s[28:31], s78 offen offset:2048  lds
    v_mfma_f32_16x16x32_bf16 v[172:175], a[108:111], v[104:107], v[172:175]
    ds_read_b64_tr_b16 v[126:127], v74 offset:20992
    v_fmac_f32 v16, v11, v15
    v_mfma_f32_16x16x32_bf16 v[172:175], a[124:127], v[108:111], v[172:175]
    s_waitcnt lgkmcnt(4)
    v_mfma_f32_16x16x32_bf16 v[188:191], a[108:111], v[112:115], v[188:191]
    ds_read_b64_tr_b16 v[104:105], v75 offset:16384
    v_mfma_f32_16x16x32_bf16 v[188:191], a[124:127], v[116:119], v[188:191]
    buffer_load_dwordx4 v39, s[28:31], s78 offen offset:3072  lds
    v_mfma_f32_16x16x32_bf16 v[184:187], a[104:107], v[112:115], v[184:187]
    ds_read_b64_tr_b16 v[106:107], v75 offset:16896
    s_add_u32 m0, s74, 16384
    v_mfma_f32_16x16x32_bf16 v[184:187], a[120:123], v[116:119], v[184:187]
    s_mul_i32 s78, s98, 196608
    s_add_u32 s78, s78, s76
    buffer_load_dwordx4 v44, s[32:35], s78 offen offset:0  lds
    v_mfma_f32_16x16x32_bf16 v[180:183], a[100:103], v[112:115], v[180:183]
    ds_read_b64_tr_b16 v[108:109], v75 offset:20480
    v_permlane32_swap_b32 v25, v16
    v_mfma_f32_16x16x32_bf16 v[180:183], a[116:119], v[116:119], v[180:183]
    buffer_load_dwordx4 v45, s[32:35], s78 offen offset:1024  lds
    v_mfma_f32_16x16x32_bf16 v[176:179], a[96:99], v[112:115], v[176:179]
    ds_read_b64_tr_b16 v[110:111], v75 offset:20992
    v_add_f32 v25, v25, v16
    v_mfma_f32_16x16x32_bf16 v[176:179], a[112:115], v[116:119], v[176:179]
    s_waitcnt lgkmcnt(4)
    v_mfma_f32_16x16x32_bf16 v[192:195], v[120:123], a[32:35], v[192:195]
    ds_read_b64_tr_b16 v[112:113], v74 offset:24576
    v_add_f32_dpp v25, v25, v25 row_ror:8 row_mask:0xf bank_mask:0xf
    v_mfma_f32_16x16x32_bf16 v[192:195], v[124:127], a[48:51], v[192:195]
    buffer_load_dwordx4 v46, s[32:35], s78 offen offset:2048  lds
    v_mfma_f32_16x16x32_bf16 v[196:199], v[120:123], a[36:39], v[196:199]
    ds_read_b64_tr_b16 v[114:115], v74 offset:25088
    v_add_f32_dpp v25, v25, v25 row_ror:4 row_mask:0xf bank_mask:0xf
    v_mfma_f32_16x16x32_bf16 v[196:199], v[124:127], a[52:55], v[196:199]
    buffer_load_dwordx4 v47, s[32:35], s78 offen offset:3072  lds
    v_mfma_f32_16x16x32_bf16 v[200:203], v[120:123], a[40:43], v[200:203]
    ds_read_b64_tr_b16 v[116:117], v74 offset:28672
    s_add_u32 m0, s74, 147456
    v_mfma_f32_16x16x32_bf16 v[200:203], v[124:127], a[56:59], v[200:203]
    s_mul_i32 s78, s99, 128
    s_add_u32 s78, s78, s73
    v_add_f32_dpp v25, v25, v25 row_ror:2 row_mask:0xf bank_mask:0xf
    v_mfma_f32_16x16x32_bf16 v[204:207], v[120:123], a[44:47], v[204:207]
    ds_read_b64_tr_b16 v[118:119], v74 offset:29184
    v_mfma_f32_16x16x32_bf16 v[204:207], v[124:127], a[60:63], v[204:207]
    s_waitcnt lgkmcnt(4)
    v_add_f32_dpp v25, v25, v25 row_ror:1 row_mask:0xf bank_mask:0xf
    v_mfma_f32_16x16x32_bf16 v[220:223], v[104:107], a[44:47], v[220:223]
    ds_read_b64_tr_b16 v[120:121], v75 offset:24576
    v_mfma_f32_16x16x32_bf16 v[220:223], v[108:111], a[60:63], v[220:223]
    v_mov_b32 v4, v25
    v_mfma_f32_16x16x32_bf16 v[216:219], v[104:107], a[40:43], v[216:219]
    ds_read_b64_tr_b16 v[122:123], v75 offset:25088
    v_mfma_f32_16x16x32_bf16 v[216:219], v[108:111], a[56:59], v[216:219]
    v_permlane16_swap_b32 v25, v4
    v_mfma_f32_16x16x32_bf16 v[212:215], v[104:107], a[36:39], v[212:215]
    ds_read_b64_tr_b16 v[124:125], v75 offset:28672
    v_mfma_f32_16x16x32_bf16 v[212:215], v[108:111], a[52:55], v[212:215]
    v_add_f32 v25, v25, v4
    v_mfma_f32_16x16x32_bf16 v[208:211], v[104:107], a[32:35], v[208:211]
    ds_read_b64_tr_b16 v[126:127], v75 offset:29184
    v_mfma_f32_16x16x32_bf16 v[208:211], v[108:111], a[48:51], v[208:211]
    s_waitcnt vmcnt(18) lgkmcnt(4)
    s_barrier
    v_mul_f32 v25, 0xbfb8aa3b, v25
    v_mfma_f32_16x16x32_bf16 v[224:227], v[112:115], a[32:35], v[224:227]
    ds_read_b128 a[128:131], v88 offset:49152
    v_mfma_f32_16x16x32_bf16 v[224:227], v[116:119], a[48:51], v[224:227]
    ds_read_b128 a[132:135], v88 offset:51200
    v_mfma_f32_16x16x32_bf16 v[228:231], v[112:115], a[36:39], v[228:231]
    ds_read_b128 a[136:139], v90 offset:49152
    v_mfma_f32_16x16x32_bf16 v[228:231], v[116:119], a[52:55], v[228:231]
    ds_read_b128 a[140:143], v90 offset:51200
    v_mfma_f32_16x16x32_bf16 v[232:235], v[112:115], a[40:43], v[232:235]
    ds_read_b64_tr_b16 v[104:105], v70 offset:32768
    v_mfma_f32_16x16x32_bf16 v[232:235], v[116:119], a[56:59], v[232:235]
    ds_read_b64_tr_b16 v[106:107], v70 offset:33280
    v_mfma_f32_16x16x32_bf16 v[236:239], v[112:115], a[44:47], v[236:239]
    ds_read_b64_tr_b16 v[108:109], v70 offset:36864
    v_mfma_f32_16x16x32_bf16 v[236:239], v[116:119], a[60:63], v[236:239]
    s_waitcnt lgkmcnt(7)
    ds_read_b64_tr_b16 v[110:111], v70 offset:37376
    v_mfma_f32_16x16x32_bf16 v[252:255], v[120:123], a[44:47], v[252:255]
    ds_read_b128 a[144:147], v89 offset:49152
    v_mfma_f32_16x16x32_bf16 v[252:255], v[124:127], a[60:63], v[252:255]
    ds_read_b128 a[148:151], v89 offset:51200
    v_mfma_f32_16x16x32_bf16 v[248:251], v[120:123], a[40:43], v[248:251]
    ds_read_b128 a[152:155], v91 offset:49152
    v_mfma_f32_16x16x32_bf16 v[248:251], v[124:127], a[56:59], v[248:251]
    ds_read_b128 a[156:159], v91 offset:51200
    v_mfma_f32_16x16x32_bf16 v[244:247], v[120:123], a[36:39], v[244:247]
    ds_read_b64_tr_b16 v[112:113], v71 offset:32768
    v_mfma_f32_16x16x32_bf16 v[244:247], v[124:127], a[52:55], v[244:247]
    ds_read_b64_tr_b16 v[114:115], v71 offset:33280
    v_mfma_f32_16x16x32_bf16 v[240:243], v[120:123], a[32:35], v[240:243]
    ds_read_b64_tr_b16 v[116:117], v71 offset:36864
    v_mfma_f32_16x16x32_bf16 v[240:243], v[124:127], a[48:51], v[240:243]
    s_waitcnt lgkmcnt(3)
    ds_read_b64_tr_b16 v[118:119], v71 offset:37376
    v_mfma_f32_16x16x32_bf16 v[128:131], a[128:131], v[104:107], v[128:131]
    ds_read_b64_tr_b16 v[120:121], v70 offset:40960
    v_mfma_f32_16x16x32_bf16 v[128:131], a[144:147], v[108:111], v[128:131]
    v_exp_f32 v25, v25
    v_mfma_f32_16x16x32_bf16 v[132:135], a[132:135], v[104:107], v[132:135]
    ds_read_b64_tr_b16 v[122:123], v70 offset:41472
    v_mfma_f32_16x16x32_bf16 v[132:135], a[148:151], v[108:111], v[132:135]
    s_mov_b32 s67, 0
    s_load_dword s67, s[56:57], 0
    v_add_f32 v25, 1.0, v25
    v_mfma_f32_16x16x32_bf16 v[136:139], a[136:139], v[104:107], v[136:139]
    ds_read_b64_tr_b16 v[124:125], v70 offset:45056
    v_mfma_f32_16x16x32_bf16 v[136:139], a[152:155], v[108:111], v[136:139]
    v_rcp_f32 v25, v25
    v_mfma_f32_16x16x32_bf16 v[140:143], a[140:143], v[104:107], v[140:143]
    ds_read_b64_tr_b16 v[126:127], v70 offset:45568
    v_mfma_f32_16x16x32_bf16 v[140:143], a[156:159], v[108:111], v[140:143]
    s_waitcnt lgkmcnt(4)
    v_mfma_f32_16x16x32_bf16 v[156:159], a[140:143], v[112:115], v[156:159]
    ds_read_b64_tr_b16 v[104:105], v71 offset:40960
    v_mfma_f32_16x16x32_bf16 v[156:159], a[156:159], v[116:119], v[156:159]
    v_mfma_f32_16x16x32_bf16 v[152:155], a[136:139], v[112:115], v[152:155]
    ds_read_b64_tr_b16 v[106:107], v71 offset:41472
    v_mfma_f32_16x16x32_bf16 v[152:155], a[152:155], v[116:119], v[152:155]
    v_mfma_f32_16x16x32_bf16 v[148:151], a[132:135], v[112:115], v[148:151]
    ds_read_b64_tr_b16 v[108:109], v71 offset:45056
    v_mfma_f32_16x16x32_bf16 v[148:151], a[148:151], v[116:119], v[148:151]
    v_mfma_f32_16x16x32_bf16 v[144:147], a[128:131], v[112:115], v[144:147]
    ds_read_b64_tr_b16 v[110:111], v71 offset:45568
    v_mfma_f32_16x16x32_bf16 v[144:147], a[144:147], v[116:119], v[144:147]
    s_waitcnt vmcnt(8) lgkmcnt(4)
    s_barrier
    v_mfma_f32_16x16x32_bf16 v[160:163], a[128:131], v[120:123], v[160:163]
    ds_read_b128 a[160:163], v88 offset:16384
    v_mfma_f32_16x16x32_bf16 v[160:163], a[144:147], v[124:127], v[160:163]
    ds_read_b128 a[164:167], v88 offset:18432
    buffer_load_dwordx4 v36, s[28:31], s78 offen offset:0  lds
    v_mfma_f32_16x16x32_bf16 v[164:167], a[132:135], v[120:123], v[164:167]
    ds_read_b128 a[168:171], v90 offset:16384
    v_mfma_f32_16x16x32_bf16 v[164:167], a[148:151], v[124:127], v[164:167]
    ds_read_b128 a[172:175], v90 offset:18432
    buffer_load_dwordx4 v37, s[28:31], s78 offen offset:1024  lds
    v_mfma_f32_16x16x32_bf16 v[168:171], a[136:139], v[120:123], v[168:171]
    ds_read_b64_tr_b16 v[112:113], v68 offset:0
    v_mfma_f32_16x16x32_bf16 v[168:171], a[152:155], v[124:127], v[168:171]
    ds_read_b64_tr_b16 v[114:115], v68 offset:512
    buffer_load_dwordx4 v38, s[28:31], s78 offen offset:2048  lds
    v_mfma_f32_16x16x32_bf16 v[172:175], a[140:143], v[120:123], v[172:175]
    ds_read_b64_tr_b16 v[116:117], v68 offset:4096
    v_mfma_f32_16x16x32_bf16 v[172:175], a[156:159], v[124:127], v[172:175]
    s_waitcnt lgkmcnt(7)
    ds_read_b64_tr_b16 v[118:119], v68 offset:4608
    buffer_load_dwordx4 v39, s[28:31], s78 offen offset:3072  lds
    v_mfma_f32_16x16x32_bf16 v[188:191], a[140:143], v[104:107], v[188:191]
    ds_read_b128 a[176:179], v89 offset:16384
    s_add_u32 m0, s74, 32768
    v_mfma_f32_16x16x32_bf16 v[188:191], a[156:159], v[108:111], v[188:191]
    ds_read_b128 a[180:183], v89 offset:18432
    s_mul_i32 s78, s99, 196608
    s_add_u32 s78, s78, s76
    buffer_load_dwordx4 v44, s[32:35], s78 offen offset:0  lds
    v_mfma_f32_16x16x32_bf16 v[184:187], a[136:139], v[104:107], v[184:187]
    ds_read_b128 a[184:187], v91 offset:16384
    v_mfma_f32_16x16x32_bf16 v[184:187], a[152:155], v[108:111], v[184:187]
    ds_read_b128 a[188:191], v91 offset:18432
    v_mfma_f32_16x16x32_bf16 v[180:183], a[132:135], v[104:107], v[180:183]
    ds_read_b64_tr_b16 v[120:121], v69 offset:0
    v_mfma_f32_16x16x32_bf16 v[180:183], a[148:151], v[108:111], v[180:183]
    ds_read_b64_tr_b16 v[122:123], v69 offset:512
    buffer_load_dwordx4 v45, s[32:35], s78 offen offset:1024  lds
    v_mfma_f32_16x16x32_bf16 v[176:179], a[128:131], v[104:107], v[176:179]
    ds_read_b64_tr_b16 v[124:125], v69 offset:4096
    v_mfma_f32_16x16x32_bf16 v[176:179], a[144:147], v[108:111], v[176:179]
    s_waitcnt lgkmcnt(3)
    ds_read_b64_tr_b16 v[126:127], v69 offset:4608
    v_mfma_f32_16x16x32_bf16 v[128:131], a[160:163], v[112:115], v[128:131]
    ds_read_b64_tr_b16 v[104:105], v68 offset:8192
    v_mfma_f32_16x16x32_bf16 v[128:131], a[176:179], v[116:119], v[128:131]
    buffer_load_dwordx4 v46, s[32:35], s78 offen offset:2048  lds
    v_mfma_f32_16x16x32_bf16 v[132:135], a[164:167], v[112:115], v[132:135]
    ds_read_b64_tr_b16 v[106:107], v68 offset:8704
    v_mfma_f32_16x16x32_bf16 v[132:135], a[180:183], v[116:119], v[132:135]
    v_mfma_f32_16x16x32_bf16 v[136:139], a[168:171], v[112:115], v[136:139]
    ds_read_b64_tr_b16 v[108:109], v68 offset:12288
    v_mfma_f32_16x16x32_bf16 v[136:139], a[184:187], v[116:119], v[136:139]
    buffer_load_dwordx4 v47, s[32:35], s78 offen offset:3072  lds
    v_mfma_f32_16x16x32_bf16 v[140:143], a[172:175], v[112:115], v[140:143]
    ds_read_b64_tr_b16 v[110:111], v68 offset:12800
    s_add_u32 m0, s74, 49152
    v_mfma_f32_16x16x32_bf16 v[140:143], a[188:191], v[116:119], v[140:143]
    s_waitcnt lgkmcnt(4)
    s_mul_i32 s78, s94, 229376
    s_add_u32 s78, s78, s75
    v_mfma_f32_16x16x32_bf16 v[156:159], a[172:175], v[120:123], v[156:159]
    ds_read_b64_tr_b16 v[112:113], v69 offset:8192
    v_mfma_f32_16x16x32_bf16 v[156:159], a[188:191], v[124:127], v[156:159]
    buffer_load_dwordx4 v40, s[36:39], s78 offen offset:0  lds
    v_mfma_f32_16x16x32_bf16 v[152:155], a[168:171], v[120:123], v[152:155]
    ds_read_b64_tr_b16 v[114:115], v69 offset:8704
    v_mfma_f32_16x16x32_bf16 v[152:155], a[184:187], v[124:127], v[152:155]
    v_mfma_f32_16x16x32_bf16 v[148:151], a[164:167], v[120:123], v[148:151]
    ds_read_b64_tr_b16 v[116:117], v69 offset:12288
    v_mfma_f32_16x16x32_bf16 v[148:151], a[180:183], v[124:127], v[148:151]
    buffer_load_dwordx4 v41, s[36:39], s78 offen offset:1024  lds
    v_mfma_f32_16x16x32_bf16 v[144:147], a[160:163], v[120:123], v[144:147]
    ds_read_b64_tr_b16 v[118:119], v69 offset:12800
    v_mfma_f32_16x16x32_bf16 v[144:147], a[176:179], v[124:127], v[144:147]
    s_waitcnt vmcnt(10) lgkmcnt(4)
    s_barrier
    v_mfma_f32_16x16x32_bf16 v[160:163], a[160:163], v[104:107], v[160:163]
    ds_read_b128 a[192:195], v88 offset:32768
    v_mfma_f32_16x16x32_bf16 v[160:163], a[176:179], v[108:111], v[160:163]
    ds_read_b128 a[196:199], v88 offset:34816
    buffer_load_dwordx4 v42, s[36:39], s78 offen offset:2048  lds
    v_mfma_f32_16x16x32_bf16 v[164:167], a[164:167], v[104:107], v[164:167]
    ds_read_b128 a[200:203], v90 offset:32768
    v_mfma_f32_16x16x32_bf16 v[164:167], a[180:183], v[108:111], v[164:167]
    ds_read_b128 a[204:207], v90 offset:34816
    v_mfma_f32_16x16x32_bf16 v[168:171], a[168:171], v[104:107], v[168:171]
    ds_read_b64_tr_b16 v[120:121], v68 offset:16384
    v_mfma_f32_16x16x32_bf16 v[168:171], a[184:187], v[108:111], v[168:171]
    ds_read_b64_tr_b16 v[122:123], v68 offset:16896
    buffer_load_dwordx4 v43, s[36:39], s78 offen offset:3072  lds
    v_mfma_f32_16x16x32_bf16 v[172:175], a[172:175], v[104:107], v[172:175]
    ds_read_b64_tr_b16 v[124:125], v68 offset:20480
    s_add_u32 m0, s74, 65536
    v_mfma_f32_16x16x32_bf16 v[172:175], a[188:191], v[108:111], v[172:175]
    s_waitcnt lgkmcnt(7)
    ds_read_b64_tr_b16 v[126:127], v68 offset:20992
    v_mfma_f32_16x16x32_bf16 v[188:191], a[172:175], v[112:115], v[188:191]
    ds_read_b128 a[208:211], v89 offset:32768
    s_mul_i32 s78, s95, 229376
    v_mfma_f32_16x16x32_bf16 v[188:191], a[188:191], v[116:119], v[188:191]
    ds_read_b128 a[212:215], v89 offset:34816
    s_add_u32 s78, s78, s75
    buffer_load_dwordx4 v40, s[36:39], s78 offen offset:0  lds
    v_mfma_f32_16x16x32_bf16 v[184:187], a[168:171], v[112:115], v[184:187]
    ds_read_b128 a[216:219], v91 offset:32768
    s_cmp_ge_u32 s67, 1
    s_cbranch_scc0 LB_slow0
LB_back0:
    v_mfma_f32_16x16x32_bf16 v[184:187], a[184:187], v[116:119], v[184:187]
    ds_read_b128 a[220:223], v91 offset:34816
    v_mfma_f32_16x16x32_bf16 v[180:183], a[164:167], v[112:115], v[180:183]
    ds_read_b64_tr_b16 v[104:105], v69 offset:16384
    v_mfma_f32_16x16x32_bf16 v[180:183], a[180:183], v[116:119], v[180:183]
    ds_read_b64_tr_b16 v[106:107], v69 offset:16896
    buffer_load_dwordx4 v41, s[36:39], s78 offen offset:1024  lds
    v_mfma_f32_16x16x32_bf16 v[176:179], a[160:163], v[112:115], v[176:179]
    ds_read_b64_tr_b16 v[108:109], v69 offset:20480
    v_mfma_f32_16x16x32_bf16 v[176:179], a[176:179], v[116:119], v[176:179]
    s_waitcnt lgkmcnt(3)
    ds_read_b64_tr_b16 v[110:111], v69 offset:20992
    v_mfma_f32_16x16x32_bf16 v[128:131], a[192:195], v[120:123], v[128:131]
    ds_read_b64_tr_b16 v[112:113], v68 offset:24576
    v_mfma_f32_16x16x32_bf16 v[128:131], a[208:211], v[124:127], v[128:131]
    buffer_load_dwordx4 v42, s[36:39], s78 offen offset:2048  lds
    v_mfma_f32_16x16x32_bf16 v[132:135], a[196:199], v[120:123], v[132:135]
    ds_read_b64_tr_b16 v[114:115], v68 offset:25088
    v_mfma_f32_16x16x32_bf16 v[132:135], a[212:215], v[124:127], v[132:135]
    buffer_load_dwordx4 v43, s[36:39], s78 offen offset:3072  lds
    v_mfma_f32_16x16x32_bf16 v[136:139], a[200:203], v[120:123], v[136:139]
    ds_read_b64_tr_b16 v[116:117], v68 offset:28672
    s_add_u32 m0, s74, 81920
    v_mfma_f32_16x16x32_bf16 v[136:139], a[216:219], v[124:127], v[136:139]
    s_mul_i32 s78, s96, 229376
    s_add_u32 s78, s78, s75
    buffer_load_dwordx4 v40, s[36:39], s78 offen offset:0  lds
    v_mfma_f32_16x16x32_bf16 v[140:143], a[204:207], v[120:123], v[140:143]
    ds_read_b64_tr_b16 v[118:119], v68 offset:29184
    v_mfma_f32_16x16x32_bf16 v[140:143], a[220:223], v[124:127], v[140:143]
    s_waitcnt lgkmcnt(4)
    v_mfma_f32_16x16x32_bf16 v[156:159], a[204:207], v[104:107], v[156:159]
    ds_read_b64_tr_b16 v[120:121], v69 offset:24576
    v_mfma_f32_16x16x32_bf16 v[156:159], a[220:223], v[108:111], v[156:159]
    buffer_load_dwordx4 v41, s[36:39], s78 offen offset:1024  lds
    v_mfma_f32_16x16x32_bf16 v[152:155], a[200:203], v[104:107], v[152:155]
    ds_read_b64_tr_b16 v[122:123], v69 offset:25088
    v_mfma_f32_16x16x32_bf16 v[152:155], a[216:219], v[108:111], v[152:155]
    v_mfma_f32_16x16x32_bf16 v[148:151], a[196:199], v[104:107], v[148:151]
    ds_read_b64_tr_b16 v[124:125], v69 offset:28672
    v_mfma_f32_16x16x32_bf16 v[148:151], a[212:215], v[108:111], v[148:151]
    buffer_load_dwordx4 v42, s[36:39], s78 offen offset:2048  lds
    v_mfma_f32_16x16x32_bf16 v[144:147], a[192:195], v[104:107], v[144:147]
    ds_read_b64_tr_b16 v[126:127], v69 offset:29184
    v_mfma_f32_16x16x32_bf16 v[144:147], a[208:211], v[108:111], v[144:147]
    s_waitcnt vmcnt(11) lgkmcnt(4)
    s_barrier
    v_mfma_f32_16x16x32_bf16 v[160:163], a[192:195], v[112:115], v[160:163]
    ds_read_b128 a[224:227], v88 offset:49152
    v_mfma_f32_16x16x32_bf16 v[160:163], a[208:211], v[116:119], v[160:163]
    ds_read_b128 a[228:231], v88 offset:51200
    buffer_load_dwordx4 v43, s[36:39], s78 offen offset:3072  lds
    v_mfma_f32_16x16x32_bf16 v[164:167], a[196:199], v[112:115], v[164:167]
    ds_read_b128 a[232:235], v90 offset:49152
    s_add_u32 m0, s74, 98304
    v_mfma_f32_16x16x32_bf16 v[164:167], a[212:215], v[116:119], v[164:167]
    ds_read_b128 a[236:239], v90 offset:51200
    s_mul_i32 s78, s97, 229376
    v_mfma_f32_16x16x32_bf16 v[168:171], a[200:203], v[112:115], v[168:171]
    ds_read_b64_tr_b16 v[104:105], v68 offset:32768
    s_add_u32 s78, s78, s75
    v_mfma_f32_16x16x32_bf16 v[168:171], a[216:219], v[116:119], v[168:171]
    ds_read_b64_tr_b16 v[106:107], v68 offset:33280
    buffer_load_dwordx4 v40, s[36:39], s78 offen offset:0  lds
    v_mfma_f32_16x16x32_bf16 v[172:175], a[204:207], v[112:115], v[172:175]
    ds_read_b64_tr_b16 v[108:109], v68 offset:36864
    v_mfma_f32_16x16x32_bf16 v[172:175], a[220:223], v[116:119], v[172:175]
    s_waitcnt lgkmcnt(7)
    ds_read_b64_tr_b16 v[110:111], v68 offset:37376
    v_mfma_f32_16x16x32_bf16 v[188:191], a[204:207], v[120:123], v[188:191]
    ds_read_b128 a[240:243], v89 offset:49152
    v_mfma_f32_16x16x32_bf16 v[188:191], a[220:223], v[124:127], v[188:191]
    ds_read_b128 a[244:247], v89 offset:51200
    buffer_load_dwordx4 v41, s[36:39], s78 offen offset:1024  lds
    v_mfma_f32_16x16x32_bf16 v[184:187], a[200:203], v[120:123], v[184:187]
    ds_read_b128 a[248:251], v91 offset:49152
    v_mfma_f32_16x16x32_bf16 v[184:187], a[216:219], v[124:127], v[184:187]
    ds_read_b128 a[252:255], v91 offset:51200
    buffer_load_dwordx4 v42, s[36:39], s78 offen offset:2048  lds
    v_mfma_f32_16x16x32_bf16 v[180:183], a[196:199], v[120:123], v[180:183]
    ds_read_b64_tr_b16 v[112:113], v69 offset:32768
    v_mfma_f32_16x16x32_bf16 v[180:183], a[212:215], v[124:127], v[180:183]
    ds_read_b64_tr_b16 v[114:115], v69 offset:33280
    buffer_load_dwordx4 v43, s[36:39], s78 offen offset:3072  lds
    v_mfma_f32_16x16x32_bf16 v[176:179], a[192:195], v[120:123], v[176:179]
    ds_read_b64_tr_b16 v[116:117], v69 offset:36864
    s_add_u32 m0, s74, 114688
    v_mfma_f32_16x16x32_bf16 v[176:179], a[208:211], v[124:127], v[176:179]
    s_waitcnt lgkmcnt(3)
    ds_read_b64_tr_b16 v[118:119], v69 offset:37376
    v_mfma_f32_16x16x32_bf16 v[128:131], a[224:227], v[104:107], v[128:131]
    ds_read_b64_tr_b16 v[120:121], v68 offset:40960
    s_mul_i32 s78, s98, 229376
    v_add_u32 v88, 0x20000, v80
    v_mfma_f32_16x16x32_bf16 v[128:131], a[240:243], v[108:111], v[128:131]
    s_add_u32 s78, s78, s75
    buffer_load_dwordx4 v40, s[36:39], s78 offen offset:0  lds
    v_mfma_f32_16x16x32_bf16 v[132:135], a[228:231], v[104:107], v[132:135]
    ds_read_b64_tr_b16 v[122:123], v68 offset:41472
    v_add_u32 v89, 0x20000, v81
    v_add_u32 v90, 0x20000, v82
    v_mfma_f32_16x16x32_bf16 v[132:135], a[244:247], v[108:111], v[132:135]
    v_add_u32 v91, 0x20000, v83
    v_mfma_f32_16x16x32_bf16 v[136:139], a[232:235], v[104:107], v[136:139]
    ds_read_b64_tr_b16 v[124:125], v68 offset:45056
    s_lshl_b32 s79, s64, 11
    s_add_u32 s79, s79, 147456
    v_mfma_f32_16x16x32_bf16 v[136:139], a[248:251], v[108:111], v[136:139]
    buffer_load_dwordx4 v41, s[36:39], s78 offen offset:1024  lds
    v_add_u32 v102, s79, v21
    v_mfma_f32_16x16x32_bf16 v[140:143], a[236:239], v[104:107], v[140:143]
    ds_read_b64_tr_b16 v[126:127], v68 offset:45568
    v_xor_b32 v103, 0x1000, v102
    v_mfma_f32_16x16x32_bf16 v[140:143], a[252:255], v[108:111], v[140:143]
    s_waitcnt lgkmcnt(4)
    v_mfma_f32_16x16x32_bf16 v[156:159], a[236:239], v[112:115], v[156:159]
    ds_read_b64_tr_b16 v[104:105], v69 offset:40960
    v_mfma_f32_16x16x32_bf16 v[156:159], a[252:255], v[116:119], v[156:159]
    buffer_load_dwordx4 v42, s[36:39], s78 offen offset:2048  lds
    v_mfma_f32_16x16x32_bf16 v[152:155], a[232:235], v[112:115], v[152:155]
    ds_read_b64_tr_b16 v[106:107], v69 offset:41472
    v_mfma_f32_16x16x32_bf16 v[152:155], a[248:251], v[116:119], v[152:155]
    v_mfma_f32_16x16x32_bf16 v[148:151], a[228:231], v[112:115], v[148:151]
    ds_read_b64_tr_b16 v[108:109], v69 offset:45056
    v_mfma_f32_16x16x32_bf16 v[148:151], a[244:247], v[116:119], v[148:151]
    buffer_load_dwordx4 v43, s[36:39], s78 offen offset:3072  lds
    v_mfma_f32_16x16x32_bf16 v[144:147], a[224:227], v[112:115], v[144:147]
    ds_read_b64_tr_b16 v[110:111], v69 offset:45568
    s_add_u32 m0, s74, 0
    v_mfma_f32_16x16x32_bf16 v[144:147], a[240:243], v[116:119], v[144:147]
    s_waitcnt vmcnt(16) lgkmcnt(4)
    s_barrier
    s_mul_i32 s78, s99, 229376
    v_mfma_f32_16x16x32_bf16 v[160:163], a[224:227], v[120:123], v[160:163]
    ds_read_b64_tr_b16 v[112:113], v72 offset:49152
    s_add_u32 s78, s78, s75
    v_mul_f32 v28, 0x3fb8aa3b, v156
    v_mfma_f32_16x16x32_bf16 v[160:163], a[240:243], v[124:127], v[160:163]
    buffer_load_dwordx4 v40, s[36:39], s78 offen offset:0  lds
    v_mul_f32 v29, 0x3fb8aa3b, v157
    v_mfma_f32_16x16x32_bf16 v[164:167], a[228:231], v[120:123], v[164:167]
    ds_read_b64_tr_b16 v[114:115], v72 offset:49664
    v_mul_f32 v30, 0x3fb8aa3b, v158
    v_mul_f32 v31, 0x3fb8aa3b, v159
    v_mfma_f32_16x16x32_bf16 v[164:167], a[244:247], v[124:127], v[164:167]
    buffer_load_dwordx4 v41, s[36:39], s78 offen offset:1024  lds
    v_mfma_f32_16x16x32_bf16 v[168:171], a[232:235], v[120:123], v[168:171]
    ds_read_b64_tr_b16 v[116:117], v72 offset:53248
    v_exp_f32 v28, v28 clamp
    v_mfma_f32_16x16x32_bf16 v[168:171], a[248:251], v[124:127], v[168:171]
    buffer_load_dwordx4 v42, s[36:39], s78 offen offset:2048  lds
    v_max_f32 v156, 0x358637bd, v156
    v_mfma_f32_16x16x32_bf16 v[172:175], a[236:239], v[120:123], v[172:175]
    ds_read_b64_tr_b16 v[118:119], v72 offset:53760
    v_exp_f32 v29, v29 clamp
    v_mfma_f32_16x16x32_bf16 v[172:175], a[252:255], v[124:127], v[172:175]
    s_waitcnt lgkmcnt(4)
    v_max_f32 v157, 0x358637bd, v157
    v_exp_f32 v30, v30 clamp
    v_mfma_f32_16x16x32_bf16 v[188:191], a[236:239], v[104:107], v[188:191]
    ds_read_b64_tr_b16 v[120:121], v73 offset:49152
    v_max_f32 v158, 0x358637bd, v158
    v_mfma_f32_16x16x32_bf16 v[188:191], a[252:255], v[108:111], v[188:191]
    buffer_load_dwordx4 v43, s[36:39], s78 offen offset:3072  lds
    v_mfma_f32_16x16x32_bf16 v[184:187], a[232:235], v[104:107], v[184:187]
    ds_read_b64_tr_b16 v[122:123], v73 offset:49664
    s_add_u32 m0, s74, 16384
    v_mfma_f32_16x16x32_bf16 v[184:187], a[248:251], v[108:111], v[184:187]
    s_mul_i32 s78, s24, 229376
    s_add_u32 s78, s78, s77
    v_exp_f32 v31, v31 clamp
    v_mfma_f32_16x16x32_bf16 v[180:183], a[228:231], v[104:107], v[180:183]
    ds_read_b64_tr_b16 v[124:125], v73 offset:53248
    v_max_f32 v159, 0x358637bd, v159
    v_add_f32 v156, v156, v28
    v_mfma_f32_16x16x32_bf16 v[180:183], a[244:247], v[108:111], v[180:183]
    buffer_load_dwordx4 v48, s[36:39], s78 offen offset:0  lds
    v_add_f32 v157, v157, v29
    v_mfma_f32_16x16x32_bf16 v[176:179], a[224:227], v[104:107], v[176:179]
    ds_read_b64_tr_b16 v[126:127], v73 offset:53760
    v_add_f32 v158, v158, v30
    v_add_f32 v159, v159, v31
    v_mfma_f32_16x16x32_bf16 v[176:179], a[240:243], v[108:111], v[176:179]
    s_waitcnt lgkmcnt(4)
    v_mul_f32 v28, 0x3fb8aa3b, v152
    v_mul_f32 v29, 0x3fb8aa3b, v153
    v_mul_f32 v30, 0x3fb8aa3b, v154
    v_mfma_f32_16x16x32_bf16 v[192:195], v[112:115], a[64:67], v[192:195]
    ds_read_b64_tr_b16 v[104:105], v72 offset:57344
    v_mul_f32 v31, 0x3fb8aa3b, v155
    v_mfma_f32_16x16x32_bf16 v[192:195], v[116:119], a[80:83], v[192:195]
    buffer_load_dwordx4 v49, s[36:39], s78 offen offset:1024  lds
    v_mfma_f32_16x16x32_bf16 v[196:199], v[112:115], a[68:71], v[196:199]
    ds_read_b64_tr_b16 v[106:107], v72 offset:57856
    v_exp_f32 v28, v28 clamp
    v_mfma_f32_16x16x32_bf16 v[196:199], v[116:119], a[84:87], v[196:199]
    v_max_f32 v152, 0x358637bd, v152
    v_exp_f32 v29, v29 clamp
    v_mfma_f32_16x16x32_bf16 v[200:203], v[112:115], a[72:75], v[200:203]
    ds_read_b64_tr_b16 v[108:109], v72 offset:61440
    v_max_f32 v153, 0x358637bd, v153
    v_mfma_f32_16x16x32_bf16 v[200:203], v[116:119], a[88:91], v[200:203]
    v_exp_f32 v30, v30 clamp
    v_max_f32 v154, 0x358637bd, v154
    v_mfma_f32_16x16x32_bf16 v[204:207], v[112:115], a[76:79], v[204:207]
    ds_read_b64_tr_b16 v[110:111], v72 offset:61952
    v_exp_f32 v31, v31 clamp
    v_mfma_f32_16x16x32_bf16 v[204:207], v[116:119], a[92:95], v[204:207]
    s_waitcnt lgkmcnt(4)
    v_max_f32 v155, 0x358637bd, v155
    v_add_f32 v152, v152, v28
    v_add_f32 v153, v153, v29
    v_mfma_f32_16x16x32_bf16 v[220:223], v[120:123], a[76:79], v[220:223]
    ds_read_b64_tr_b16 v[112:113], v73 offset:57344
    v_add_f32 v154, v154, v30
    v_add_f32 v155, v155, v31
    v_mfma_f32_16x16x32_bf16 v[220:223], v[124:127], a[92:95], v[220:223]
    buffer_load_dwordx4 v50, s[36:39], s78 offen offset:2048  lds
    v_cvt_pk_bf16_f32 v152, v152, v153
    v_mfma_f32_16x16x32_bf16 v[216:219], v[120:123], a[72:75], v[216:219]
    ds_read_b64_tr_b16 v[114:115], v73 offset:57856
    v_cvt_pk_bf16_f32 v153, v154, v155
    v_cvt_pk_bf16_f32 v154, v156, v157
    v_mfma_f32_16x16x32_bf16 v[216:219], v[124:127], a[88:91], v[216:219]
    v_cvt_pk_bf16_f32 v155, v158, v159
    v_mul_f32 v28, 0x3fb8aa3b, v148
    v_mul_f32 v29, 0x3fb8aa3b, v149
    v_mfma_f32_16x16x32_bf16 v[212:215], v[120:123], a[68:71], v[212:215]
    ds_read_b64_tr_b16 v[116:117], v73 offset:61440
    v_mul_f32 v30, 0x3fb8aa3b, v150
    v_mul_f32 v31, 0x3fb8aa3b, v151
    v_mfma_f32_16x16x32_bf16 v[212:215], v[124:127], a[84:87], v[212:215]
    v_exp_f32 v28, v28 clamp
    v_max_f32 v148, 0x358637bd, v148
    v_mfma_f32_16x16x32_bf16 v[208:211], v[120:123], a[64:67], v[208:211]
    ds_read_b64_tr_b16 v[118:119], v73 offset:61952
    v_exp_f32 v29, v29 clamp
    v_mfma_f32_16x16x32_bf16 v[208:211], v[124:127], a[80:83], v[208:211]
    s_waitcnt vmcnt(19) lgkmcnt(4)
    s_barrier
    v_max_f32 v149, 0x358637bd, v149
    v_mfma_f32_16x16x32_bf16 v[224:227], v[104:107], a[64:67], v[224:227]
    ds_read_b64_tr_b16 v[120:121], v74 offset:0
    v_exp_f32 v30, v30 clamp
    v_mfma_f32_16x16x32_bf16 v[224:227], v[108:111], a[80:83], v[224:227]
    buffer_load_dwordx4 v51, s[36:39], s78 offen offset:3072  lds
    v_max_f32 v150, 0x358637bd, v150
    v_mfma_f32_16x16x32_bf16 v[228:231], v[104:107], a[68:71], v[228:231]
    ds_read_b64_tr_b16 v[122:123], v74 offset:512
    s_add_u32 m0, s74, 32768
    v_mfma_f32_16x16x32_bf16 v[228:231], v[108:111], a[84:87], v[228:231]
    s_mul_i32 s78, s25, 229376
    s_add_u32 s78, s78, s77
    buffer_load_dwordx4 v48, s[36:39], s78 offen offset:0  lds
    v_mfma_f32_16x16x32_bf16 v[232:235], v[104:107], a[72:75], v[232:235]
    ds_read_b64_tr_b16 v[124:125], v74 offset:4096
    v_exp_f32 v31, v31 clamp
    v_mfma_f32_16x16x32_bf16 v[232:235], v[108:111], a[88:91], v[232:235]
    v_max_f32 v151, 0x358637bd, v151
    v_add_f32 v148, v148, v28
    v_add_f32 v149, v149, v29
    v_mfma_f32_16x16x32_bf16 v[236:239], v[104:107], a[76:79], v[236:239]
LB_pg2:
    s_cbranch_execz LB_walked
    ds_read_b64_tr_b16 v[126:127], v74 offset:4608
    v_add_f32 v150, v150, v30
    v_add_f32 v151, v151, v31
    v_mfma_f32_16x16x32_bf16 v[236:239], v[108:111], a[92:95], v[236:239]
    s_waitcnt lgkmcnt(4)
    v_mul_f32 v28, 0x3fb8aa3b, v144
    v_mul_f32 v29, 0x3fb8aa3b, v145
    v_mul_f32 v30, 0x3fb8aa3b, v146
    v_mfma_f32_16x16x32_bf16 v[252:255], v[112:115], a[76:79], v[252:255]
    ds_read_b64_tr_b16 v[104:105], v75 offset:0
    v_mul_f32 v31, 0x3fb8aa3b, v147
    v_mfma_f32_16x16x32_bf16 v[252:255], v[116:119], a[92:95], v[252:255]
    buffer_load_dwordx4 v49, s[36:39], s78 offen offset:1024  lds
    v_mfma_f32_16x16x32_bf16 v[248:251], v[112:115], a[72:75], v[248:251]
    ds_read_b64_tr_b16 v[106:107], v75 offset:512
    v_exp_f32 v28, v28 clamp
    v_mfma_f32_16x16x32_bf16 v[248:251], v[116:119], a[88:91], v[248:251]
    v_max_f32 v144, 0x358637bd, v144
    v_exp_f32 v29, v29 clamp
    v_mfma_f32_16x16x32_bf16 v[244:247], v[112:115], a[68:71], v[244:247]
    ds_read_b64_tr_b16 v[108:109], v75 offset:4096
    v_max_f32 v145, 0x358637bd, v145
    v_mfma_f32_16x16x32_bf16 v[244:247], v[116:119], a[84:87], v[244:247]
    v_exp_f32 v30, v30 clamp
    v_max_f32 v146, 0x358637bd, v146
    v_mfma_f32_16x16x32_bf16 v[240:243], v[112:115], a[64:67], v[240:243]
    ds_read_b64_tr_b16 v[110:111], v75 offset:4608
    v_exp_f32 v31, v31 clamp
    v_mfma_f32_16x16x32_bf16 v[240:243], v[116:119], a[80:83], v[240:243]
    s_waitcnt lgkmcnt(4)
    v_max_f32 v147, 0x358637bd, v147
    v_add_f32 v144, v144, v28
    v_add_f32 v145, v145, v29
    v_mfma_f32_16x16x32_bf16 v[192:195], v[120:123], a[96:99], v[192:195]
    ds_read_b64_tr_b16 v[112:113], v74 offset:8192
    v_add_f32 v146, v146, v30
    v_add_f32 v147, v147, v31
    v_mfma_f32_16x16x32_bf16 v[192:195], v[124:127], a[112:115], v[192:195]
    buffer_load_dwordx4 v50, s[36:39], s78 offen offset:2048  lds
    v_cvt_pk_bf16_f32 v144, v144, v145
    v_mfma_f32_16x16x32_bf16 v[196:199], v[120:123], a[100:103], v[196:199]
    ds_read_b64_tr_b16 v[114:115], v74 offset:8704
    v_cvt_pk_bf16_f32 v145, v146, v147
    v_cvt_pk_bf16_f32 v146, v148, v149
    v_mfma_f32_16x16x32_bf16 v[196:199], v[124:127], a[116:119], v[196:199]
    v_cvt_pk_bf16_f32 v147, v150, v151
    v_cvt_pk_bf16_f32 v176, v176, v177
    v_cvt_pk_bf16_f32 v177, v178, v179
    v_mfma_f32_16x16x32_bf16 v[200:203], v[120:123], a[104:107], v[200:203]
    ds_read_b64_tr_b16 v[116:117], v74 offset:12288
    v_cvt_pk_bf16_f32 v178, v180, v181
    v_cvt_pk_bf16_f32 v179, v182, v183
    v_mfma_f32_16x16x32_bf16 v[200:203], v[124:127], a[120:123], v[200:203]
    v_cvt_pk_bf16_f32 v184, v184, v185
    v_cvt_pk_bf16_f32 v185, v186, v187
    v_cvt_pk_bf16_f32 v186, v188, v189
    v_mfma_f32_16x16x32_bf16 v[204:207], v[120:123], a[108:111], v[204:207]
    ds_read_b64_tr_b16 v[118:119], v74 offset:12800
    v_cvt_pk_bf16_f32 v187, v190, v191
    v_mfma_f32_16x16x32_bf16 v[148:151], v[144:147], v[176:179], 0
    v_mfma_f32_16x16x32_bf16 v[204:207], v[124:127], a[124:127], v[204:207]
    s_waitcnt lgkmcnt(4)
    v_mfma_f32_16x16x32_bf16 v[148:151], v[152:155], v[184:187], v[148:151]
    v_mfma_f32_16x16x32_bf16 v[220:223], v[104:107], a[108:111], v[220:223]
    ds_read_b64_tr_b16 v[120:121], v75 offset:8192
    v_mfma_f32_16x16x32_bf16 v[180:183], v[144:147], v[92:95], 0
    v_mfma_f32_16x16x32_bf16 v[220:223], v[108:111], a[124:127], v[220:223]
    buffer_load_dwordx4 v51, s[36:39], s78 offen offset:3072  lds
    v_mfma_f32_16x16x32_bf16 v[180:183], v[152:155], v[92:95], v[180:183]
    v_mfma_f32_16x16x32_bf16 v[216:219], v[104:107], a[104:107], v[216:219]
    ds_read_b64_tr_b16 v[122:123], v75 offset:8704
    s_add_u32 m0, s74, 49152
    v_mul_f32 v28, 0x3fb8aa3b, v128
    v_mfma_f32_16x16x32_bf16 v[216:219], v[108:111], a[120:123], v[216:219]
    s_mul_i32 s78, s26, 229376
    s_add_u32 s78, s78, s77
    v_mul_f32 v29, 0x3fb8aa3b, v129
    v_mul_f32 v30, 0x3fb8aa3b, v130
    v_mfma_f32_16x16x32_bf16 v[212:215], v[104:107], a[100:103], v[212:215]
    ds_read_b64_tr_b16 v[124:125], v75 offset:12288
    v_mul_f32 v31, 0x3fb8aa3b, v131
    v_mfma_f32_16x16x32_bf16 v[212:215], v[108:111], a[116:119], v[212:215]
    v_exp_f32 v28, v28 clamp
    v_max_f32 v128, 0x358637bd, v128
    v_mfma_f32_16x16x32_bf16 v[208:211], v[104:107], a[96:99], v[208:211]
    ds_read_b64_tr_b16 v[126:127], v75 offset:12800
    v_exp_f32 v29, v29 clamp
    v_mfma_f32_16x16x32_bf16 v[208:211], v[108:111], a[112:115], v[208:211]
    s_waitcnt vmcnt(20) lgkmcnt(4)
    s_barrier
    v_max_f32 v129, 0x358637bd, v129
    v_mfma_f32_16x16x32_bf16 v[224:227], v[112:115], a[96:99], v[224:227]
    ds_read_b64_tr_b16 v[104:105], v74 offset:16384
    v_exp_f32 v30, v30 clamp
    v_mfma_f32_16x16x32_bf16 v[224:227], v[116:119], a[112:115], v[224:227]
    buffer_load_dwordx4 v48, s[36:39], s78 offen offset:0  lds
    v_max_f32 v130, 0x358637bd, v130
    v_mfma_f32_16x16x32_bf16 v[228:231], v[112:115], a[100:103], v[228:231]
    ds_read_b64_tr_b16 v[106:107], v74 offset:16896
    v_exp_f32 v31, v31 clamp
    v_mfma_f32_16x16x32_bf16 v[228:231], v[116:119], a[116:119], v[228:231]
    buffer_load_dwordx4 v49, s[36:39], s78 offen offset:1024  lds
    v_max_f32 v131, 0x358637bd, v131
    v_mfma_f32_16x16x32_bf16 v[232:235], v[112:115], a[104:107], v[232:235]
    ds_read_b64_tr_b16 v[108:109], v74 offset:20480
    v_add_f32 v128, v128, v28
    v_add_f32 v129, v129, v29
    v_mfma_f32_16x16x32_bf16 v[232:235], v[116:119], a[120:123], v[232:235]
    v_add_f32 v130, v130, v30
    v_add_f32 v131, v131, v31
    v_mfma_f32_16x16x32_bf16 v[236:239], v[112:115], a[108:111], v[236:239]
    ds_read_b64_tr_b16 v[110:111], v74 offset:20992
    ds_write_b128 v102, v[148:151]
    v_mfma_f32_16x16x32_bf16 v[236:239], v[116:119], a[124:127], v[236:239]
    s_waitcnt lgkmcnt(5)
    ds_write_b128 v102, v[180:183] offset:1024
    v_mfma_f32_16x16x32_bf16 v[252:255], v[120:123], a[108:111], v[252:255]
    ds_read_b64_tr_b16 v[112:113], v75 offset:16384
    v_mul_f32 v28, 0x3fb8aa3b, v132
    v_mul_f32 v29, 0x3fb8aa3b, v133
    v_mfma_f32_16x16x32_bf16 v[252:255], v[124:127], a[124:127], v[252:255]
    buffer_load_dwordx4 v50, s[36:39], s78 offen offset:2048  lds
    v_mul_f32 v30, 0x3fb8aa3b, v134
    v_mfma_f32_16x16x32_bf16 v[248:251], v[120:123], a[104:107], v[248:251]
    ds_read_b64_tr_b16 v[114:115], v75 offset:16896
    v_mul_f32 v31, 0x3fb8aa3b, v135
    v_mfma_f32_16x16x32_bf16 v[248:251], v[124:127], a[120:123], v[248:251]
    v_exp_f32 v28, v28 clamp
    v_max_f32 v132, 0x358637bd, v132
    v_mfma_f32_16x16x32_bf16 v[244:247], v[120:123], a[100:103], v[244:247]
    ds_read_b64_tr_b16 v[116:117], v75 offset:20480
    v_exp_f32 v29, v29 clamp
    v_mfma_f32_16x16x32_bf16 v[244:247], v[124:127], a[116:119], v[244:247]
    v_max_f32 v133, 0x358637bd, v133
    v_exp_f32 v30, v30 clamp
    v_mfma_f32_16x16x32_bf16 v[240:243], v[120:123], a[96:99], v[240:243]
    ds_read_b64_tr_b16 v[118:119], v75 offset:20992
    v_max_f32 v134, 0x358637bd, v134
    v_mfma_f32_16x16x32_bf16 v[240:243], v[124:127], a[112:115], v[240:243]
    s_waitcnt lgkmcnt(6)
    v_exp_f32 v31, v31 clamp
    v_max_f32 v135, 0x358637bd, v135
    v_mfma_f32_16x16x32_bf16 v[192:195], v[104:107], a[128:131], v[192:195]
    ds_read_b64_tr_b16 v[120:121], v74 offset:24576
    v_add_f32 v132, v132, v28
    v_add_f32 v133, v133, v29
    v_mfma_f32_16x16x32_bf16 v[192:195], v[108:111], a[144:147], v[192:195]
    buffer_load_dwordx4 v51, s[36:39], s78 offen offset:3072  lds
    v_add_f32 v134, v134, v30
    v_mfma_f32_16x16x32_bf16 v[196:199], v[104:107], a[132:135], v[196:199]
    ds_read_b64_tr_b16 v[122:123], v74 offset:25088
    s_add_u32 m0, s74, 65536
    v_add_f32 v135, v135, v31
    v_mfma_f32_16x16x32_bf16 v[196:199], v[108:111], a[148:151], v[196:199]
    s_mul_i32 s78, s27, 229376
    s_add_u32 s78, s78, s77
    v_cvt_pk_bf16_f32 v128, v128, v129
    v_cvt_pk_bf16_f32 v129, v130, v131
    v_mfma_f32_16x16x32_bf16 v[200:203], v[104:107], a[136:139], v[200:203]
    ds_read_b64_tr_b16 v[124:125], v74 offset:28672
    v_cvt_pk_bf16_f32 v130, v132, v133
    v_cvt_pk_bf16_f32 v131, v134, v135
    v_mfma_f32_16x16x32_bf16 v[200:203], v[108:111], a[152:155], v[200:203]
    s_waitcnt lgkmcnt(7)
    s_barrier
    ds_read_b128 v[156:159], v103
    v_mfma_f32_16x16x32_bf16 v[204:207], v[104:107], a[140:143], v[204:207]
    ds_read_b64_tr_b16 v[126:127], v74 offset:29184
    ds_read_b128 v[188:191], v103 offset:1024
    v_mfma_f32_16x16x32_bf16 v[204:207], v[108:111], a[156:159], v[204:207]
    s_waitcnt lgkmcnt(6)
    v_mul_f32 v28, 0x3fb8aa3b, v136
    v_mul_f32 v29, 0x3fb8aa3b, v137
    v_mul_f32 v30, 0x3fb8aa3b, v138
    v_mfma_f32_16x16x32_bf16 v[220:223], v[112:115], a[140:143], v[220:223]
    ds_read_b64_tr_b16 v[104:105], v75 offset:24576
    v_mul_f32 v31, 0x3fb8aa3b, v139
    v_mfma_f32_16x16x32_bf16 v[220:223], v[116:119], a[156:159], v[220:223]
    ds_read_b64_tr_b16 v[106:107], v75 offset:25088
    v_exp_f32 v28, v28 clamp
    v_mfma_f32_16x16x32_bf16 v[216:219], v[112:115], a[136:139], v[216:219]
    ds_read_b64_tr_b16 v[108:109], v75 offset:28672
    v_max_f32 v136, 0x358637bd, v136
    v_mfma_f32_16x16x32_bf16 v[216:219], v[116:119], a[152:155], v[216:219]
    ds_read_b64_tr_b16 v[110:111], v75 offset:29184
    v_exp_f32 v29, v29 clamp
    v_mfma_f32_16x16x32_bf16 v[212:215], v[112:115], a[132:135], v[212:215]
    v_max_f32 v137, 0x358637bd, v137
    v_exp_f32 v30, v30 clamp
    v_mfma_f32_16x16x32_bf16 v[212:215], v[116:119], a[148:151], v[212:215]
    v_max_f32 v138, 0x358637bd, v138
    v_exp_f32 v31, v31 clamp
    v_mfma_f32_16x16x32_bf16 v[208:211], v[112:115], a[128:131], v[208:211]
    v_max_f32 v139, 0x358637bd, v139
    v_add_f32 v136, v136, v28
    v_add_f32 v137, v137, v29
    v_mfma_f32_16x16x32_bf16 v[208:211], v[116:119], a[144:147], v[208:211]
    s_waitcnt vmcnt(20) lgkmcnt(0)
    s_barrier
    v_add_f32 v138, v138, v30
    v_add_f32 v139, v139, v31
    v_mfma_f32_16x16x32_bf16 v[224:227], v[120:123], a[128:131], v[224:227]
    ds_read_b64_tr_b16 v[112:113], v74 offset:32768
    v_mul_f32 v28, 0x3fb8aa3b, v140
    v_mul_f32 v29, 0x3fb8aa3b, v141
    v_mfma_f32_16x16x32_bf16 v[224:227], v[124:127], a[144:147], v[224:227]
    buffer_load_dwordx4 v48, s[36:39], s78 offen offset:0  lds
    v_mul_f32 v30, 0x3fb8aa3b, v142
    v_mfma_f32_16x16x32_bf16 v[228:231], v[120:123], a[132:135], v[228:231]
    ds_read_b64_tr_b16 v[114:115], v74 offset:33280
    v_mul_f32 v31, 0x3fb8aa3b, v143
    v_mfma_f32_16x16x32_bf16 v[228:231], v[124:127], a[148:151], v[228:231]
    buffer_load_dwordx4 v49, s[36:39], s78 offen offset:1024  lds
    v_mfma_f32_16x16x32_bf16 v[232:235], v[120:123], a[136:139], v[232:235]
    ds_read_b64_tr_b16 v[116:117], v74 offset:36864
    v_exp_f32 v28, v28 clamp
    v_mfma_f32_16x16x32_bf16 v[232:235], v[124:127], a[152:155], v[232:235]
    v_max_f32 v140, 0x358637bd, v140
    v_exp_f32 v29, v29 clamp
    v_mfma_f32_16x16x32_bf16 v[236:239], v[120:123], a[140:143], v[236:239]
    ds_read_b64_tr_b16 v[118:119], v74 offset:37376
    v_max_f32 v141, 0x358637bd, v141
    v_mfma_f32_16x16x32_bf16 v[236:239], v[124:127], a[156:159], v[236:239]
    v_exp_f32 v30, v30 clamp
    v_max_f32 v142, 0x358637bd, v142
    v_mfma_f32_16x16x32_bf16 v[252:255], v[104:107], a[140:143], v[252:255]
    ds_read_b64_tr_b16 v[120:121], v75 offset:32768
    v_exp_f32 v31, v31 clamp
    v_mfma_f32_16x16x32_bf16 v[252:255], v[108:111], a[156:159], v[252:255]
    buffer_load_dwordx4 v50, s[36:39], s78 offen offset:2048  lds
    v_max_f32 v143, 0x358637bd, v143
    v_mfma_f32_16x16x32_bf16 v[248:251], v[104:107], a[136:139], v[248:251]
    ds_read_b64_tr_b16 v[122:123], v75 offset:33280
    v_add_f32 v140, v140, v28
    v_add_f32 v141, v141, v29
    v_mfma_f32_16x16x32_bf16 v[248:251], v[108:111], a[152:155], v[248:251]
    v_add_f32 v142, v142, v30
    v_add_f32 v143, v143, v31
    v_cvt_pk_bf16_f32 v136, v136, v137
    v_mfma_f32_16x16x32_bf16 v[244:247], v[104:107], a[132:135], v[244:247]
    ds_read_b64_tr_b16 v[124:125], v75 offset:36864
    v_cvt_pk_bf16_f32 v137, v138, v139
    v_cvt_pk_bf16_f32 v138, v140, v141
    v_mfma_f32_16x16x32_bf16 v[244:247], v[108:111], a[148:151], v[244:247]
    v_cvt_pk_bf16_f32 v139, v142, v143
    v_cvt_pk_bf16_f32 v160, v160, v161
    v_cvt_pk_bf16_f32 v161, v162, v163
    v_mfma_f32_16x16x32_bf16 v[240:243], v[104:107], a[128:131], v[240:243]
    ds_read_b64_tr_b16 v[126:127], v75 offset:37376
    v_cvt_pk_bf16_f32 v162, v164, v165
    v_cvt_pk_bf16_f32 v163, v166, v167
    v_mfma_f32_16x16x32_bf16 v[240:243], v[108:111], a[144:147], v[240:243]
    s_waitcnt lgkmcnt(4)
    v_cvt_pk_bf16_f32 v168, v168, v169
    v_cvt_pk_bf16_f32 v169, v170, v171
    v_cvt_pk_bf16_f32 v170, v172, v173
    v_mfma_f32_16x16x32_bf16 v[192:195], v[112:115], a[160:163], v[192:195]
    ds_read_b64_tr_b16 v[104:105], v74 offset:40960
    v_cvt_pk_bf16_f32 v171, v174, v175
    v_mfma_f32_16x16x32_bf16 v[132:135], v[128:131], v[160:163], v[156:159]
    v_mfma_f32_16x16x32_bf16 v[192:195], v[116:119], a[176:179], v[192:195]
    buffer_load_dwordx4 v51, s[36:39], s78 offen offset:3072  lds
    v_mfma_f32_16x16x32_bf16 v[132:135], v[136:139], v[168:171], v[132:135]
    v_mfma_f32_16x16x32_bf16 v[196:199], v[112:115], a[164:167], v[196:199]
    ds_read_b64_tr_b16 v[106:107], v74 offset:41472
    s_add_u32 m0, s74, 131072
    v_mfma_f32_16x16x32_bf16 v[164:167], v[128:131], v[92:95], v[188:191]
    v_mfma_f32_16x16x32_bf16 v[196:199], v[116:119], a[180:183], v[196:199]
    s_add_u32 s78, s10, 0
    v_mfma_f32_16x16x32_bf16 v[164:167], v[136:139], v[92:95], v[164:167]
    v_mfma_f32_16x16x32_bf16 v[200:203], v[112:115], a[168:171], v[200:203]
    ds_read_b64_tr_b16 v[108:109], v74 offset:45056
    v_cvt_pk_bf16_f32 v140, v132, v133
    v_cvt_pk_bf16_f32 v141, v134, v135
    v_mfma_f32_16x16x32_bf16 v[200:203], v[116:119], a[184:187], v[200:203]
    v_cvt_pk_bf16_f32 v142, v132, v133
    v_cvt_pk_bf16_f32 v143, v134, v135
    v_mfma_f32_16x16x32_bf16 v[204:207], v[112:115], a[172:175], v[204:207]
    ds_read_b64_tr_b16 v[110:111], v74 offset:45568
    buffer_store_dwordx4 v[164:167], v23, s[48:51], s23 offen sc1
    v_mfma_f32_16x16x32_bf16 v[204:207], v[116:119], a[188:191], v[204:207]
    s_waitcnt lgkmcnt(4)
    v_permlane16_swap_b32 v140, v142
    v_permlane16_swap_b32 v141, v143
    v_mfma_f32_16x16x32_bf16 v[220:223], v[120:123], a[172:175], v[220:223]
    ds_read_b64_tr_b16 v[112:113], v75 offset:40960
    buffer_store_dwordx4 v[140:143], v64, s[48:51], s22 offen sc1
    v_mfma_f32_16x16x32_bf16 v[220:223], v[124:127], a[188:191], v[220:223]
    ds_read_b64_tr_b16 v[114:115], v75 offset:41472
    v_mfma_f32_16x16x32_bf16 v[216:219], v[120:123], a[168:171], v[216:219]
    ds_read_b64_tr_b16 v[116:117], v75 offset:45056
    v_mfma_f32_16x16x32_bf16 v[216:219], v[124:127], a[184:187], v[216:219]
    ds_read_b64_tr_b16 v[118:119], v75 offset:45568
    v_mfma_f32_16x16x32_bf16 v[212:215], v[120:123], a[164:167], v[212:215]
    v_mfma_f32_16x16x32_bf16 v[212:215], v[124:127], a[180:183], v[212:215]
    v_mfma_f32_16x16x32_bf16 v[208:211], v[120:123], a[160:163], v[208:211]
    v_mfma_f32_16x16x32_bf16 v[208:211], v[124:127], a[176:179], v[208:211]
    s_waitcnt vmcnt(22) lgkmcnt(0)
    s_barrier
    v_mfma_f32_16x16x32_bf16 v[224:227], v[104:107], a[160:163], v[224:227]
    ds_read_b64_tr_b16 v[120:121], v74 offset:49152
    v_mfma_f32_16x16x32_bf16 v[224:227], v[108:111], a[176:179], v[224:227]
    buffer_load_dwordx4 v52, s[40:43], s78 offen offset:0  lds
    v_mfma_f32_16x16x32_bf16 v[228:231], v[104:107], a[164:167], v[228:231]
    ds_read_b64_tr_b16 v[122:123], v74 offset:49664
    v_mfma_f32_16x16x32_bf16 v[228:231], v[108:111], a[180:183], v[228:231]
    buffer_load_dwordx4 v53, s[40:43], s78 offen offset:1024  lds
    v_mfma_f32_16x16x32_bf16 v[232:235], v[104:107], a[168:171], v[232:235]
    ds_read_b64_tr_b16 v[124:125], v74 offset:53248
    v_mfma_f32_16x16x32_bf16 v[232:235], v[108:111], a[184:187], v[232:235]
    buffer_load_dwordx4 v54, s[40:43], s78 offen offset:2048  lds
    v_mfma_f32_16x16x32_bf16 v[236:239], v[104:107], a[172:175], v[236:239]
    ds_read_b64_tr_b16 v[126:127], v74 offset:53760
    v_mfma_f32_16x16x32_bf16 v[236:239], v[108:111], a[188:191], v[236:239]
    v_mfma_f32_16x16x32_bf16 v[252:255], v[112:115], a[172:175], v[252:255]
    ds_read_b64_tr_b16 v[104:105], v75 offset:49152
    v_mfma_f32_16x16x32_bf16 v[252:255], v[116:119], a[188:191], v[252:255]
    buffer_load_dwordx4 v55, s[40:43], s78 offen offset:3072  lds
    v_mfma_f32_16x16x32_bf16 v[248:251], v[112:115], a[168:171], v[248:251]
    ds_read_b64_tr_b16 v[106:107], v75 offset:49664
    s_add_u32 m0, s74, 81920
    v_mfma_f32_16x16x32_bf16 v[248:251], v[116:119], a[184:187], v[248:251]
    s_add_u32 s78, s10, 32768
    v_mfma_f32_16x16x32_bf16 v[244:247], v[112:115], a[164:167], v[244:247]
    ds_read_b64_tr_b16 v[108:109], v75 offset:53248
    v_mfma_f32_16x16x32_bf16 v[244:247], v[116:119], a[180:183], v[244:247]
    buffer_load_dwordx4 v52, s[40:43], s78 offen offset:0  lds
    v_mfma_f32_16x16x32_bf16 v[240:243], v[112:115], a[160:163], v[240:243]
    ds_read_b64_tr_b16 v[110:111], v75 offset:53760
    v_mfma_f32_16x16x32_bf16 v[240:243], v[116:119], a[176:179], v[240:243]
    s_waitcnt lgkmcnt(4)
    v_mfma_f32_16x16x32_bf16 v[192:195], v[120:123], a[192:195], v[192:195]
    ds_read_b64_tr_b16 v[112:113], v74 offset:57344
    v_mfma_f32_16x16x32_bf16 v[192:195], v[124:127], a[208:211], v[192:195]
    buffer_load_dwordx4 v53, s[40:43], s78 offen offset:1024  lds
    v_mfma_f32_16x16x32_bf16 v[196:199], v[120:123], a[196:199], v[196:199]
    ds_read_b64_tr_b16 v[114:115], v74 offset:57856
    v_mfma_f32_16x16x32_bf16 v[196:199], v[124:127], a[212:215], v[196:199]
    v_mfma_f32_16x16x32_bf16 v[200:203], v[120:123], a[200:203], v[200:203]
    ds_read_b64_tr_b16 v[116:117], v74 offset:61440
    v_mfma_f32_16x16x32_bf16 v[200:203], v[124:127], a[216:219], v[200:203]
    buffer_load_dwordx4 v54, s[40:43], s78 offen offset:2048  lds
    v_mfma_f32_16x16x32_bf16 v[204:207], v[120:123], a[204:207], v[204:207]
    ds_read_b64_tr_b16 v[118:119], v74 offset:61952
    v_mfma_f32_16x16x32_bf16 v[204:207], v[124:127], a[220:223], v[204:207]
    s_waitcnt lgkmcnt(4)
    v_mfma_f32_16x16x32_bf16 v[220:223], v[104:107], a[204:207], v[220:223]
    ds_read_b64_tr_b16 v[120:121], v75 offset:57344
    v_mfma_f32_16x16x32_bf16 v[220:223], v[108:111], a[220:223], v[220:223]
    ds_read_b64_tr_b16 v[122:123], v75 offset:57856
    v_mfma_f32_16x16x32_bf16 v[216:219], v[104:107], a[200:203], v[216:219]
    ds_read_b64_tr_b16 v[124:125], v75 offset:61440
    v_mfma_f32_16x16x32_bf16 v[216:219], v[108:111], a[216:219], v[216:219]
    ds_read_b64_tr_b16 v[126:127], v75 offset:61952
    v_mfma_f32_16x16x32_bf16 v[212:215], v[104:107], a[196:199], v[212:215]
    buffer_load_dwordx4 v55, s[40:43], s78 offen offset:3072  lds
    v_mfma_f32_16x16x32_bf16 v[212:215], v[108:111], a[212:215], v[212:215]
    s_add_u32 m0, s74, 98304
    s_add_u32 s78, vcc_lo, 0
    v_mfma_f32_16x16x32_bf16 v[208:211], v[104:107], a[192:195], v[208:211]
    buffer_load_dwordx4 v52, s[40:43], s78 offen offset:0  lds
    v_mfma_f32_16x16x32_bf16 v[208:211], v[108:111], a[208:211], v[208:211]
    s_waitcnt vmcnt(27) lgkmcnt(0)
    s_barrier
    v_mfma_f32_16x16x32_bf16 v[224:227], v[112:115], a[192:195], v[224:227]
    ds_read_b64_tr_b16 v[128:129], v72 offset:0
    v_mfma_f32_16x16x32_bf16 v[224:227], v[116:119], a[208:211], v[224:227]
    ds_read_b64_tr_b16 v[130:131], v72 offset:512
    buffer_load_dwordx4 v53, s[40:43], s78 offen offset:1024  lds
    v_mfma_f32_16x16x32_bf16 v[228:231], v[112:115], a[196:199], v[228:231]
    ds_read_b64_tr_b16 v[132:133], v72 offset:4096
    v_mfma_f32_16x16x32_bf16 v[228:231], v[116:119], a[212:215], v[228:231]
    ds_read_b64_tr_b16 v[134:135], v72 offset:4608
    s_waitcnt vmcnt(10)
    s_atomic_add s12, s[48:49], s90 offset:0 glc
    v_mfma_f32_16x16x32_bf16 v[232:235], v[112:115], a[200:203], v[232:235]
    ds_read_b64_tr_b16 v[136:137], v73 offset:0
    v_mfma_f32_16x16x32_bf16 v[232:235], v[116:119], a[216:219], v[232:235]
    ds_read_b64_tr_b16 v[138:139], v73 offset:512
    buffer_load_dwordx4 v54, s[40:43], s78 offen offset:2048  lds
    v_mfma_f32_16x16x32_bf16 v[236:239], v[112:115], a[204:207], v[236:239]
    ds_read_b64_tr_b16 v[140:141], v73 offset:4096
    v_mfma_f32_16x16x32_bf16 v[236:239], v[116:119], a[220:223], v[236:239]
    ds_read_b64_tr_b16 v[142:143], v73 offset:4608
    v_mfma_f32_16x16x32_bf16 v[252:255], v[120:123], a[204:207], v[252:255]
    ds_read_b64_tr_b16 v[144:145], v72 offset:8192
    v_mfma_f32_16x16x32_bf16 v[252:255], v[124:127], a[220:223], v[252:255]
    ds_read_b64_tr_b16 v[146:147], v72 offset:8704
    buffer_load_dwordx4 v55, s[40:43], s78 offen offset:3072  lds
    v_mfma_f32_16x16x32_bf16 v[248:251], v[120:123], a[200:203], v[248:251]
    ds_read_b64_tr_b16 v[148:149], v72 offset:12288
    s_add_u32 m0, s74, 147456
    v_mfma_f32_16x16x32_bf16 v[248:251], v[124:127], a[216:219], v[248:251]
    ds_read_b64_tr_b16 v[150:151], v72 offset:12800
    s_add_u32 s78, vcc_lo, 32768
    buffer_load_dwordx4 v52, s[40:43], s78 offen offset:0  lds
    v_mfma_f32_16x16x32_bf16 v[244:247], v[120:123], a[196:199], v[244:247]
    ds_read_b64_tr_b16 v[152:153], v73 offset:8192
    v_mfma_f32_16x16x32_bf16 v[244:247], v[124:127], a[212:215], v[244:247]
    ds_read_b64_tr_b16 v[154:155], v73 offset:8704
    buffer_load_dwordx4 v53, s[40:43], s78 offen offset:1024  lds
    v_mfma_f32_16x16x32_bf16 v[240:243], v[120:123], a[192:195], v[240:243]
    ds_read_b64_tr_b16 v[156:157], v73 offset:12288
    v_mfma_f32_16x16x32_bf16 v[240:243], v[124:127], a[208:211], v[240:243]
    s_waitcnt lgkmcnt(11)
    ds_read_b64_tr_b16 v[158:159], v73 offset:12800
    v_mfma_f32_16x16x32_bf16 v[192:195], v[128:131], a[224:227], v[192:195]
    s_lshl_b32 s86, s72, 1
    s_add_u32 s86, s86, s66
    s_add_u32 s86, s86, 32
    s_lshl_b32 s86, s86, 12
    v_mfma_f32_16x16x32_bf16 v[192:195], v[132:135], a[240:243], v[192:195]
    buffer_load_dwordx4 v54, s[40:43], s78 offen offset:2048  lds
    s_add_u32 s86, s86, s85
    s_waitcnt lgkmcnt(6)
    v_mfma_f32_16x16x32_bf16 v[224:227], v[144:147], a[224:227], v[224:227]
    s_lshl_b32 s79, s66, 11
    s_sub_u32 s87, s86, s79
    s_add_u32 s86, s86, s79
    s_waitcnt lgkmcnt(4)
    v_mfma_f32_16x16x32_bf16 v[224:227], v[148:151], a[240:243], v[224:227]
    v_mfma_f32_16x16x32_bf16 v[208:211], v[136:139], a[224:227], v[208:211]
    v_mfma_f32_16x16x32_bf16 v[208:211], v[140:143], a[240:243], v[208:211]
    buffer_load_dwordx4 v55, s[40:43], s78 offen offset:3072  lds
    s_waitcnt lgkmcnt(2)
    v_mfma_f32_16x16x32_bf16 v[240:243], v[152:155], a[224:227], v[240:243]
    s_add_u32 m0, s74, 114688
    s_add_u32 s78, s10, s11
    ds_read_b32 v27, v22
    s_waitcnt lgkmcnt(1)
    v_mfma_f32_16x16x32_bf16 v[240:243], v[156:159], a[240:243], v[240:243]
    v_mfma_f32_16x16x32_bf16 v[196:199], v[128:131], a[228:231], v[196:199]
    v_max_f32 v192, 0, v192
    v_max_f32 v193, 0, v193
    v_max_f32 v194, 0, v194
    v_max_f32 v195, 0, v195
    v_mfma_f32_16x16x32_bf16 v[196:199], v[132:135], a[244:247], v[196:199]
    buffer_load_dwordx4 v52, s[40:43], s78 offen offset:0  lds
    v_mul_f32 v192, v192, v224
    v_mul_f32 v193, v193, v225
    v_mfma_f32_16x16x32_bf16 v[228:231], v[144:147], a[228:231], v[228:231]
    v_mul_f32 v194, v194, v226
    v_mul_f32 v195, v195, v227
    v_cvt_pk_bf16_f32 v224, v192, v193
    v_cvt_pk_bf16_f32 v225, v194, v195
    v_mfma_f32_16x16x32_bf16 v[228:231], v[148:151], a[244:247], v[228:231]
    buffer_load_dwordx4 v53, s[40:43], s78 offen offset:1024  lds
    v_max_f32 v208, 0, v208
    v_max_f32 v209, 0, v209
    v_mfma_f32_16x16x32_bf16 v[212:215], v[136:139], a[228:231], v[212:215]
    v_max_f32 v210, 0, v210
    v_max_f32 v211, 0, v211
    v_mul_f32 v208, v208, v240
    v_mul_f32 v209, v209, v241
    v_mfma_f32_16x16x32_bf16 v[212:215], v[140:143], a[244:247], v[212:215]
    buffer_load_dwordx4 v54, s[40:43], s78 offen offset:2048  lds
    v_mul_f32 v210, v210, v242
    v_mul_f32 v211, v211, v243
    v_mfma_f32_16x16x32_bf16 v[244:247], v[152:155], a[228:231], v[244:247]
    v_cvt_pk_bf16_f32 v226, v208, v209
    v_cvt_pk_bf16_f32 v227, v210, v211
    v_mfma_f32_16x16x32_bf16 v[244:247], v[156:159], a[244:247], v[244:247]
    s_barrier
    buffer_store_dword v25, v24, s[48:51], s3 offen sc1
    v_mfma_f32_16x16x32_bf16 v[200:203], v[128:131], a[232:235], v[200:203]
    ds_read_b64_tr_b16 v[104:105], v76 offset:16384
    buffer_store_dwordx4 v[224:227], v21, s[48:51], s86 offen offset:0 sc1
    v_mfma_f32_16x16x32_bf16 v[200:203], v[132:135], a[248:251], v[200:203]
    ds_read_b64_tr_b16 v[106:107], v76 offset:16640
    v_max_f32 v196, 0, v196
    v_max_f32 v197, 0, v197
    v_max_f32 v198, 0, v198
    v_mfma_f32_16x16x32_bf16 v[232:235], v[144:147], a[232:235], v[232:235]
    ds_read_b64_tr_b16 v[108:109], v76 offset:18432
    v_max_f32 v199, 0, v199
    v_mul_f32 v196, v196, v228
    v_mul_f32 v197, v197, v229
    v_mfma_f32_16x16x32_bf16 v[232:235], v[148:151], a[248:251], v[232:235]
    ds_read_b64_tr_b16 v[110:111], v76 offset:18688
    v_mul_f32 v198, v198, v230
    v_mul_f32 v199, v199, v231
    v_cvt_pk_bf16_f32 v228, v196, v197
    v_mfma_f32_16x16x32_bf16 v[216:219], v[136:139], a[232:235], v[216:219]
    ds_read_b64_tr_b16 v[112:113], v77 offset:16384
    v_cvt_pk_bf16_f32 v229, v198, v199
    v_max_f32 v212, 0, v212
    v_max_f32 v213, 0, v213
    v_mfma_f32_16x16x32_bf16 v[216:219], v[140:143], a[248:251], v[216:219]
    ds_read_b64_tr_b16 v[114:115], v77 offset:16640
    v_max_f32 v214, 0, v214
    v_max_f32 v215, 0, v215
    v_mul_f32 v212, v212, v244
    v_mfma_f32_16x16x32_bf16 v[248:251], v[152:155], a[232:235], v[248:251]
    ds_read_b64_tr_b16 v[116:117], v77 offset:18432
    v_mul_f32 v213, v213, v245
    v_mul_f32 v214, v214, v246
    v_mul_f32 v215, v215, v247
    v_mfma_f32_16x16x32_bf16 v[248:251], v[156:159], a[248:251], v[248:251]
    ds_read_b64_tr_b16 v[118:119], v77 offset:18688
    v_cvt_pk_bf16_f32 v230, v212, v213
    v_cvt_pk_bf16_f32 v231, v214, v215
    v_mfma_f32_16x16x32_bf16 v[204:207], v[128:131], a[236:239], v[204:207]
    ds_read_b64_tr_b16 v[120:121], v76 offset:24576
    buffer_store_dwordx4 v[228:231], v21, s[48:51], s86 offen offset:1024 sc1
    v_mfma_f32_16x16x32_bf16 v[204:207], v[132:135], a[252:255], v[204:207]
    ds_read_b64_tr_b16 v[122:123], v76 offset:24832
    v_max_f32 v200, 0, v200
    v_max_f32 v201, 0, v201
    v_max_f32 v202, 0, v202
    v_mfma_f32_16x16x32_bf16 v[236:239], v[144:147], a[236:239], v[236:239]
    ds_read_b64_tr_b16 v[124:125], v76 offset:26624
    v_max_f32 v203, 0, v203
    v_mul_f32 v200, v200, v232
    v_mul_f32 v201, v201, v233
    v_mfma_f32_16x16x32_bf16 v[236:239], v[148:151], a[252:255], v[236:239]
    ds_read_b64_tr_b16 v[126:127], v76 offset:26880
    v_mul_f32 v202, v202, v234
    v_mul_f32 v203, v203, v235
    v_cvt_pk_bf16_f32 v232, v200, v201
    v_mfma_f32_16x16x32_bf16 v[220:223], v[136:139], a[236:239], v[220:223]
    ds_read_b64_tr_b16 v[176:177], v77 offset:24576
    v_cvt_pk_bf16_f32 v233, v202, v203
    v_max_f32 v216, 0, v216
    v_max_f32 v217, 0, v217
    v_mfma_f32_16x16x32_bf16 v[220:223], v[140:143], a[252:255], v[220:223]
    ds_read_b64_tr_b16 v[178:179], v77 offset:24832
    v_max_f32 v218, 0, v218
    v_max_f32 v219, 0, v219
    v_mul_f32 v216, v216, v248
    v_mfma_f32_16x16x32_bf16 v[252:255], v[152:155], a[236:239], v[252:255]
    ds_read_b64_tr_b16 v[180:181], v77 offset:26624
    v_mul_f32 v217, v217, v249
    v_mul_f32 v218, v218, v250
    v_mul_f32 v219, v219, v251
    v_mfma_f32_16x16x32_bf16 v[252:255], v[156:159], a[252:255], v[252:255]
    s_waitcnt lgkmcnt(11)
    ds_read_b64_tr_b16 v[182:183], v77 offset:26880
    v_cvt_pk_bf16_f32 v234, v216, v217
    v_cvt_pk_bf16_f32 v235, v218, v219
    v_mfma_f32_16x16x32_bf16 v[128:131], v[104:107], a[0:3], 0
    ds_read_b64_tr_b16 v[184:185], v76 offset:20480
    buffer_store_dwordx4 v[232:235], v21, s[48:51], s87 offen offset:2048 sc1
    v_mfma_f32_16x16x32_bf16 v[128:131], v[108:111], a[16:19], v[128:131]
    ds_read_b64_tr_b16 v[186:187], v76 offset:20736
    v_max_f32 v204, 0, v204
    v_max_f32 v205, 0, v205
    v_max_f32 v206, 0, v206
    v_mfma_f32_16x16x32_bf16 v[132:135], v[104:107], a[4:7], 0
    ds_read_b64_tr_b16 v[188:189], v76 offset:22528
    v_max_f32 v207, 0, v207
    v_mul_f32 v204, v204, v236
    v_mul_f32 v205, v205, v237
    v_mfma_f32_16x16x32_bf16 v[132:135], v[108:111], a[20:23], v[132:135]
    s_waitcnt lgkmcnt(11)
    ds_read_b64_tr_b16 v[190:191], v76 offset:22784
    v_mul_f32 v206, v206, v238
    v_mul_f32 v207, v207, v239
    v_mfma_f32_16x16x32_bf16 v[140:143], v[112:115], a[4:7], 0
    ds_read_b64_tr_b16 v[104:105], v77 offset:20480
    v_cvt_pk_bf16_f32 v236, v204, v205
    v_cvt_pk_bf16_f32 v237, v206, v207
    v_max_f32 v220, 0, v220
    v_mfma_f32_16x16x32_bf16 v[140:143], v[116:119], a[20:23], v[140:143]
    ds_read_b64_tr_b16 v[106:107], v77 offset:20736
    v_max_f32 v221, 0, v221
    v_max_f32 v222, 0, v222
    v_max_f32 v223, 0, v223
    v_mfma_f32_16x16x32_bf16 v[136:139], v[112:115], a[0:3], 0
    ds_read_b64_tr_b16 v[108:109], v77 offset:22528
    v_mul_f32 v220, v220, v252
    v_mul_f32 v221, v221, v253
    v_mul_f32 v222, v222, v254
    v_mfma_f32_16x16x32_bf16 v[136:139], v[116:119], a[16:19], v[136:139]
    s_waitcnt lgkmcnt(11)
    ds_read_b64_tr_b16 v[110:111], v77 offset:22784
    v_mul_f32 v223, v223, v255
    v_cvt_pk_bf16_f32 v238, v220, v221
LB_pg3:
    s_cbranch_execz LB_walked
    v_mfma_f32_16x16x32_bf16 v[144:147], v[120:123], a[0:3], 0
    ds_read_b64_tr_b16 v[112:113], v76 offset:28672
    v_cvt_pk_bf16_f32 v239, v222, v223
    v_mfma_f32_16x16x32_bf16 v[144:147], v[124:127], a[16:19], v[144:147]
    ds_read_b64_tr_b16 v[114:115], v76 offset:28928
    buffer_load_dwordx4 v55, s[40:43], s78 offen offset:3072  lds
    v_mfma_f32_16x16x32_bf16 v[148:151], v[120:123], a[4:7], 0
    ds_read_b64_tr_b16 v[116:117], v76 offset:30720
    s_add_u32 m0, s74, 0
    buffer_store_dwordx4 v[236:239], v21, s[48:51], s87 offen offset:3072 sc1
    v_mfma_f32_16x16x32_bf16 v[148:151], v[124:127], a[20:23], v[148:151]
    s_waitcnt lgkmcnt(11)
    ds_read_b64_tr_b16 v[118:119], v76 offset:30976
    v_mfma_f32_16x16x32_bf16 v[156:159], v[176:179], a[4:7], 0
    ds_read_b64_tr_b16 v[120:121], v77 offset:28672
    s_add_u32 s78, s10, s11
    v_mfma_f32_16x16x32_bf16 v[156:159], v[180:183], a[20:23], v[156:159]
    ds_read_b64_tr_b16 v[122:123], v77 offset:28928
    s_add_u32 s78, s78, 32768
    v_mfma_f32_16x16x32_bf16 v[152:155], v[176:179], a[0:3], 0
    ds_read_b64_tr_b16 v[124:125], v77 offset:30720
    v_mfma_f32_16x16x32_bf16 v[152:155], v[180:183], a[16:19], v[152:155]
    s_waitcnt lgkmcnt(11)
    s_barrier
    ds_read_b64_tr_b16 v[126:127], v77 offset:30976
    v_mfma_f32_16x16x32_bf16 v[128:131], v[184:187], a[32:35], v[128:131]
    ds_read_b64_tr_b16 v[176:177], v76 offset:32768
    v_mfma_f32_16x16x32_bf16 v[128:131], v[188:191], a[48:51], v[128:131]
    ds_read_b64_tr_b16 v[178:179], v76 offset:33024
    v_mfma_f32_16x16x32_bf16 v[132:135], v[184:187], a[36:39], v[132:135]
    ds_read_b64_tr_b16 v[180:181], v76 offset:34816
    s_mov_b32 s69, 0
    s_atomic_add s69, s[48:49], s89 offset:0 glc
    v_mfma_f32_16x16x32_bf16 v[132:135], v[188:191], a[52:55], v[132:135]
    s_waitcnt lgkmcnt(11)
    ds_read_b64_tr_b16 v[182:183], v76 offset:35072
    v_mfma_f32_16x16x32_bf16 v[140:143], v[104:107], a[36:39], v[140:143]
    ds_read_b64_tr_b16 v[184:185], v77 offset:32768
    v_mfma_f32_16x16x32_bf16 v[140:143], v[108:111], a[52:55], v[140:143]
    ds_read_b64_tr_b16 v[186:187], v77 offset:33024
    buffer_load_dwordx4 v52, s[40:43], s78 offen offset:0  lds
    v_mfma_f32_16x16x32_bf16 v[136:139], v[104:107], a[32:35], v[136:139]
    ds_read_b64_tr_b16 v[188:189], v77 offset:34816
    v_mfma_f32_16x16x32_bf16 v[136:139], v[108:111], a[48:51], v[136:139]
    s_waitcnt lgkmcnt(11)
    ds_read_b64_tr_b16 v[190:191], v77 offset:35072
    buffer_load_dwordx4 v53, s[40:43], s78 offen offset:1024  lds
    v_mfma_f32_16x16x32_bf16 v[144:147], v[112:115], a[32:35], v[144:147]
    ds_read_b64_tr_b16 v[104:105], v76 offset:40960
    v_mfma_f32_16x16x32_bf16 v[144:147], v[116:119], a[48:51], v[144:147]
    ds_read_b64_tr_b16 v[106:107], v76 offset:41216
    buffer_load_dwordx4 v54, s[40:43], s78 offen offset:2048  lds
    v_mfma_f32_16x16x32_bf16 v[148:151], v[112:115], a[36:39], v[148:151]
    ds_read_b64_tr_b16 v[108:109], v76 offset:43008
    v_mfma_f32_16x16x32_bf16 v[148:151], v[116:119], a[52:55], v[148:151]
    s_waitcnt lgkmcnt(11)
    ds_read_b64_tr_b16 v[110:111], v76 offset:43264
    v_mfma_f32_16x16x32_bf16 v[156:159], v[120:123], a[36:39], v[156:159]
    ds_read_b64_tr_b16 v[112:113], v77 offset:40960
    v_mfma_f32_16x16x32_bf16 v[156:159], v[124:127], a[52:55], v[156:159]
    ds_read_b64_tr_b16 v[114:115], v77 offset:41216
    buffer_load_dwordx4 v55, s[40:43], s78 offen offset:3072  lds
    v_mfma_f32_16x16x32_bf16 v[152:155], v[120:123], a[32:35], v[152:155]
    ds_read_b64_tr_b16 v[116:117], v77 offset:43008
    s_add_u32 m0, s74, 16384
    v_mfma_f32_16x16x32_bf16 v[152:155], v[124:127], a[48:51], v[152:155]
    s_waitcnt lgkmcnt(11)
    ds_read_b64_tr_b16 v[118:119], v77 offset:43264
    v_mfma_f32_16x16x32_bf16 v[128:131], v[176:179], a[64:67], v[128:131]
    ds_read_b64_tr_b16 v[120:121], v76 offset:36864
    s_add_u32 s78, vcc_lo, vcc_hi
    v_mfma_f32_16x16x32_bf16 v[128:131], v[180:183], a[80:83], v[128:131]
    ds_read_b64_tr_b16 v[122:123], v76 offset:37120
    v_mfma_f32_16x16x32_bf16 v[132:135], v[176:179], a[68:71], v[132:135]
    ds_read_b64_tr_b16 v[124:125], v76 offset:38912
    v_mfma_f32_16x16x32_bf16 v[132:135], v[180:183], a[84:87], v[132:135]
    s_waitcnt lgkmcnt(11)
    ds_read_b64_tr_b16 v[126:127], v76 offset:39168
    v_mfma_f32_16x16x32_bf16 v[140:143], v[184:187], a[68:71], v[140:143]
    ds_read_b64_tr_b16 v[176:177], v77 offset:36864
    v_mfma_f32_16x16x32_bf16 v[140:143], v[188:191], a[84:87], v[140:143]
    ds_read_b64_tr_b16 v[178:179], v77 offset:37120
    v_mfma_f32_16x16x32_bf16 v[136:139], v[184:187], a[64:67], v[136:139]
    ds_read_b64_tr_b16 v[180:181], v77 offset:38912
    v_mfma_f32_16x16x32_bf16 v[136:139], v[188:191], a[80:83], v[136:139]
    s_waitcnt lgkmcnt(11)
    ds_read_b64_tr_b16 v[182:183], v77 offset:39168
    v_mfma_f32_16x16x32_bf16 v[144:147], v[104:107], a[64:67], v[144:147]
    ds_read_b64_tr_b16 v[184:185], v76 offset:45056
    v_mfma_f32_16x16x32_bf16 v[144:147], v[108:111], a[80:83], v[144:147]
    ds_read_b64_tr_b16 v[186:187], v76 offset:45312
    v_mfma_f32_16x16x32_bf16 v[148:151], v[104:107], a[68:71], v[148:151]
    ds_read_b64_tr_b16 v[188:189], v76 offset:47104
    v_mfma_f32_16x16x32_bf16 v[148:151], v[108:111], a[84:87], v[148:151]
    s_waitcnt lgkmcnt(11)
    ds_read_b64_tr_b16 v[190:191], v76 offset:47360
    v_mfma_f32_16x16x32_bf16 v[156:159], v[112:115], a[68:71], v[156:159]
    ds_read_b64_tr_b16 v[104:105], v77 offset:45056
    v_mfma_f32_16x16x32_bf16 v[156:159], v[116:119], a[84:87], v[156:159]
    ds_read_b64_tr_b16 v[106:107], v77 offset:45312
    v_mfma_f32_16x16x32_bf16 v[152:155], v[112:115], a[64:67], v[152:155]
    ds_read_b64_tr_b16 v[108:109], v77 offset:47104
    v_mfma_f32_16x16x32_bf16 v[152:155], v[116:119], a[80:83], v[152:155]
    s_waitcnt lgkmcnt(11)
    s_barrier
    ds_read_b64_tr_b16 v[110:111], v77 offset:47360
    v_mfma_f32_16x16x32_bf16 v[128:131], v[120:123], a[96:99], v[128:131]
    ds_read_b64_tr_b16 v[112:113], v76 offset:49152
    v_mfma_f32_16x16x32_bf16 v[128:131], v[124:127], a[112:115], v[128:131]
    ds_read_b64_tr_b16 v[114:115], v76 offset:49408
    buffer_load_dwordx4 v52, s[40:43], s78 offen offset:0  lds
    v_mfma_f32_16x16x32_bf16 v[132:135], v[120:123], a[100:103], v[132:135]
    ds_read_b64_tr_b16 v[116:117], v76 offset:51200
    v_mfma_f32_16x16x32_bf16 v[132:135], v[124:127], a[116:119], v[132:135]
    s_waitcnt lgkmcnt(11)
    ds_read_b64_tr_b16 v[118:119], v76 offset:51456
    buffer_load_dwordx4 v53, s[40:43], s78 offen offset:1024  lds
    v_mfma_f32_16x16x32_bf16 v[140:143], v[176:179], a[100:103], v[140:143]
    ds_read_b64_tr_b16 v[120:121], v77 offset:49152
    v_mfma_f32_16x16x32_bf16 v[140:143], v[180:183], a[116:119], v[140:143]
    ds_read_b64_tr_b16 v[122:123], v77 offset:49408
    buffer_load_dwordx4 v54, s[40:43], s78 offen offset:2048  lds
    v_mfma_f32_16x16x32_bf16 v[136:139], v[176:179], a[96:99], v[136:139]
    ds_read_b64_tr_b16 v[124:125], v77 offset:51200
    v_mfma_f32_16x16x32_bf16 v[136:139], v[180:183], a[112:115], v[136:139]
    s_waitcnt lgkmcnt(11)
    ds_read_b64_tr_b16 v[126:127], v77 offset:51456
    v_mfma_f32_16x16x32_bf16 v[144:147], v[184:187], a[96:99], v[144:147]
    ds_read_b64_tr_b16 v[176:177], v76 offset:57344
    v_mfma_f32_16x16x32_bf16 v[144:147], v[188:191], a[112:115], v[144:147]
    ds_read_b64_tr_b16 v[178:179], v76 offset:57600
    buffer_load_dwordx4 v55, s[40:43], s78 offen offset:3072  lds
    v_mfma_f32_16x16x32_bf16 v[148:151], v[184:187], a[100:103], v[148:151]
    ds_read_b64_tr_b16 v[180:181], v76 offset:59392
    s_waitcnt vmcnt(8)
    s_atomic_add s13, s[48:49], s88 offset:4 glc
    s_bfe_u32 s3, s3, 0x50008
    s_lshl_b32 s3, s3, 7
    s_add_u32 s3, s3, 9846784
    s_atomic_add s15, s[48:49], s3 glc
    v_mfma_f32_16x16x32_bf16 v[148:151], v[188:191], a[116:119], v[148:151]
    s_waitcnt lgkmcnt(11)
    ds_read_b64_tr_b16 v[182:183], v76 offset:59648
    v_mfma_f32_16x16x32_bf16 v[156:159], v[104:107], a[100:103], v[156:159]
    ds_read_b64_tr_b16 v[184:185], v77 offset:57344
    s_add_u32 m0, s74, 32768
    v_mfma_f32_16x16x32_bf16 v[156:159], v[108:111], a[116:119], v[156:159]
    ds_read_b64_tr_b16 v[186:187], v77 offset:57600
    s_add_u32 s78, vcc_lo, vcc_hi
    v_mfma_f32_16x16x32_bf16 v[152:155], v[104:107], a[96:99], v[152:155]
    ds_read_b64_tr_b16 v[188:189], v77 offset:59392
    s_add_u32 s78, s78, 32768
    v_mfma_f32_16x16x32_bf16 v[152:155], v[108:111], a[112:115], v[152:155]
    s_waitcnt lgkmcnt(11)
    ds_read_b64_tr_b16 v[190:191], v77 offset:59648
    v_mfma_f32_16x16x32_bf16 v[128:131], v[112:115], a[128:131], v[128:131]
    ds_read_b64_tr_b16 v[104:105], v76 offset:53248
    v_mfma_f32_16x16x32_bf16 v[128:131], v[116:119], a[144:147], v[128:131]
    ds_read_b64_tr_b16 v[106:107], v76 offset:53504
    v_mfma_f32_16x16x32_bf16 v[132:135], v[112:115], a[132:135], v[132:135]
    ds_read_b64_tr_b16 v[108:109], v76 offset:55296
    s_cmp_ge_u32 s69, 4
    s_cbranch_scc0 LB_slow1
LB_back1:
    v_mfma_f32_16x16x32_bf16 v[132:135], v[116:119], a[148:151], v[132:135]
    s_waitcnt lgkmcnt(11)
    ds_read_b64_tr_b16 v[110:111], v76 offset:55552
    s_add_u32 s80, s81, 0
    buffer_load_dwordx4 a[8:11], v56, s[48:51], s80 offen sc1
    v_mfma_f32_16x16x32_bf16 v[140:143], v[120:123], a[132:135], v[140:143]
    ds_read_b64_tr_b16 v[112:113], v77 offset:53248
    v_mfma_f32_16x16x32_bf16 v[140:143], v[124:127], a[148:151], v[140:143]
    ds_read_b64_tr_b16 v[114:115], v77 offset:53504
    buffer_load_dwordx4 a[12:15], v57, s[48:51], s80 offen sc1
    v_mfma_f32_16x16x32_bf16 v[136:139], v[120:123], a[128:131], v[136:139]
    ds_read_b64_tr_b16 v[116:117], v77 offset:55296
    v_mfma_f32_16x16x32_bf16 v[136:139], v[124:127], a[144:147], v[136:139]
    s_waitcnt lgkmcnt(11)
    ds_read_b64_tr_b16 v[118:119], v77 offset:55552
    buffer_load_dwordx4 a[24:27], v58, s[48:51], s80 offen sc1
    v_mfma_f32_16x16x32_bf16 v[144:147], v[176:179], a[128:131], v[144:147]
    ds_read_b64_tr_b16 v[120:121], v76 offset:61440
    v_mfma_f32_16x16x32_bf16 v[144:147], v[180:183], a[144:147], v[144:147]
    ds_read_b64_tr_b16 v[122:123], v76 offset:61696
    buffer_load_dwordx4 a[28:31], v59, s[48:51], s80 offen sc1
    v_mfma_f32_16x16x32_bf16 v[148:151], v[176:179], a[132:135], v[148:151]
    ds_read_b64_tr_b16 v[124:125], v76 offset:63488
    s_add_u32 s80, s81, 4096
    v_mfma_f32_16x16x32_bf16 v[148:151], v[180:183], a[148:151], v[148:151]
    s_waitcnt lgkmcnt(11)
    ds_read_b64_tr_b16 v[126:127], v76 offset:63744
    v_mfma_f32_16x16x32_bf16 v[156:159], v[184:187], a[132:135], v[156:159]
    ds_read_b64_tr_b16 v[176:177], v77 offset:61440
    v_mfma_f32_16x16x32_bf16 v[156:159], v[188:191], a[148:151], v[156:159]
    ds_read_b64_tr_b16 v[178:179], v77 offset:61696
    buffer_load_dwordx4 a[40:43], v56, s[48:51], s80 offen sc1
    v_mfma_f32_16x16x32_bf16 v[152:155], v[184:187], a[128:131], v[152:155]
    ds_read_b64_tr_b16 v[180:181], v77 offset:63488
    v_mfma_f32_16x16x32_bf16 v[152:155], v[188:191], a[144:147], v[152:155]
    s_waitcnt lgkmcnt(11)
    s_barrier
    ds_read_b64_tr_b16 v[182:183], v77 offset:63744
    v_mfma_f32_16x16x32_bf16 v[128:131], v[104:107], a[160:163], v[128:131]
    ds_read_b64_tr_b16 v[184:185], v78 offset:0
    v_mfma_f32_16x16x32_bf16 v[128:131], v[108:111], a[176:179], v[128:131]
    ds_read_b64_tr_b16 v[186:187], v78 offset:256
    buffer_load_dwordx4 a[44:47], v57, s[48:51], s80 offen sc1
    v_mfma_f32_16x16x32_bf16 v[132:135], v[104:107], a[164:167], v[132:135]
    ds_read_b64_tr_b16 v[188:189], v78 offset:2048
    v_mfma_f32_16x16x32_bf16 v[132:135], v[108:111], a[180:183], v[132:135]
    s_waitcnt lgkmcnt(11)
    ds_read_b64_tr_b16 v[190:191], v78 offset:2304
    buffer_load_dwordx4 a[56:59], v58, s[48:51], s80 offen sc1
    v_mfma_f32_16x16x32_bf16 v[140:143], v[112:115], a[164:167], v[140:143]
    ds_read_b64_tr_b16 v[104:105], v79 offset:0
    v_mfma_f32_16x16x32_bf16 v[140:143], v[116:119], a[180:183], v[140:143]
    ds_read_b64_tr_b16 v[106:107], v79 offset:256
    buffer_load_dwordx4 a[60:63], v59, s[48:51], s80 offen sc1
    v_mfma_f32_16x16x32_bf16 v[136:139], v[112:115], a[160:163], v[136:139]
    ds_read_b64_tr_b16 v[108:109], v79 offset:2048
    s_add_u32 s80, s18, 8192
    v_mfma_f32_16x16x32_bf16 v[136:139], v[116:119], a[176:179], v[136:139]
    s_waitcnt lgkmcnt(11)
    ds_read_b64_tr_b16 v[110:111], v79 offset:2304
    v_mfma_f32_16x16x32_bf16 v[144:147], v[120:123], a[160:163], v[144:147]
    ds_read_b64_tr_b16 v[112:113], v78 offset:8192
    v_mfma_f32_16x16x32_bf16 v[144:147], v[124:127], a[176:179], v[144:147]
    ds_read_b64_tr_b16 v[114:115], v78 offset:8448
    buffer_load_dwordx4 a[72:75], v56, s[48:51], s80 offen sc1
    v_mfma_f32_16x16x32_bf16 v[148:151], v[120:123], a[164:167], v[148:151]
    ds_read_b64_tr_b16 v[116:117], v78 offset:10240
    v_mfma_f32_16x16x32_bf16 v[148:151], v[124:127], a[180:183], v[148:151]
    s_waitcnt lgkmcnt(11)
    ds_read_b64_tr_b16 v[118:119], v78 offset:10496
    v_mfma_f32_16x16x32_bf16 v[156:159], v[176:179], a[164:167], v[156:159]
    ds_read_b64_tr_b16 v[120:121], v79 offset:8192
    v_mfma_f32_16x16x32_bf16 v[156:159], v[180:183], a[180:183], v[156:159]
    ds_read_b64_tr_b16 v[122:123], v79 offset:8448
    buffer_load_dwordx4 a[76:79], v57, s[48:51], s80 offen sc1
    v_mfma_f32_16x16x32_bf16 v[152:155], v[176:179], a[160:163], v[152:155]
    ds_read_b64_tr_b16 v[124:125], v79 offset:10240
    v_mfma_f32_16x16x32_bf16 v[152:155], v[180:183], a[176:179], v[152:155]
    s_waitcnt lgkmcnt(11)
    ds_read_b64_tr_b16 v[126:127], v79 offset:10496
    v_mfma_f32_16x16x32_bf16 v[128:131], v[184:187], a[192:195], v[128:131]
    ds_read_b64_tr_b16 v[176:177], v78 offset:4096
    v_mfma_f32_16x16x32_bf16 v[128:131], v[188:191], a[208:211], v[128:131]
    ds_read_b64_tr_b16 v[178:179], v78 offset:4352
    buffer_load_dwordx4 a[88:91], v58, s[48:51], s80 offen sc1
    v_mfma_f32_16x16x32_bf16 v[132:135], v[184:187], a[196:199], v[132:135]
    ds_read_b64_tr_b16 v[180:181], v78 offset:6144
    v_mfma_f32_16x16x32_bf16 v[132:135], v[188:191], a[212:215], v[132:135]
    s_waitcnt lgkmcnt(11)
    ds_read_b64_tr_b16 v[182:183], v78 offset:6400
    buffer_load_dwordx4 a[92:95], v59, s[48:51], s80 offen sc1
    v_mfma_f32_16x16x32_bf16 v[140:143], v[104:107], a[196:199], v[140:143]
    ds_read_b64_tr_b16 v[184:185], v79 offset:4096
    s_add_u32 s80, s18, 12288
    v_mfma_f32_16x16x32_bf16 v[140:143], v[108:111], a[212:215], v[140:143]
    ds_read_b64_tr_b16 v[186:187], v79 offset:4352
    buffer_load_dwordx4 a[104:107], v56, s[48:51], s80 offen sc1
    v_mfma_f32_16x16x32_bf16 v[136:139], v[104:107], a[192:195], v[136:139]
    ds_read_b64_tr_b16 v[188:189], v79 offset:6144
    v_mfma_f32_16x16x32_bf16 v[136:139], v[108:111], a[208:211], v[136:139]
    s_waitcnt lgkmcnt(11)
    ds_read_b64_tr_b16 v[190:191], v79 offset:6400
    v_mfma_f32_16x16x32_bf16 v[144:147], v[112:115], a[192:195], v[144:147]
    ds_read_b64_tr_b16 v[104:105], v78 offset:12288
    v_mfma_f32_16x16x32_bf16 v[144:147], v[116:119], a[208:211], v[144:147]
    ds_read_b64_tr_b16 v[106:107], v78 offset:12544
    buffer_load_dwordx4 a[108:111], v57, s[48:51], s80 offen sc1
    v_mfma_f32_16x16x32_bf16 v[148:151], v[112:115], a[196:199], v[148:151]
    ds_read_b64_tr_b16 v[108:109], v78 offset:14336
    v_mfma_f32_16x16x32_bf16 v[148:151], v[116:119], a[212:215], v[148:151]
    s_waitcnt lgkmcnt(11)
    ds_read_b64_tr_b16 v[110:111], v78 offset:14592
    v_mfma_f32_16x16x32_bf16 v[156:159], v[120:123], a[196:199], v[156:159]
    ds_read_b64_tr_b16 v[112:113], v79 offset:12288
    v_mfma_f32_16x16x32_bf16 v[156:159], v[124:127], a[212:215], v[156:159]
    ds_read_b64_tr_b16 v[114:115], v79 offset:12544
    buffer_load_dwordx4 a[120:123], v58, s[48:51], s80 offen sc1
    v_mfma_f32_16x16x32_bf16 v[152:155], v[120:123], a[192:195], v[152:155]
    ds_read_b64_tr_b16 v[116:117], v79 offset:14336
    v_mfma_f32_16x16x32_bf16 v[152:155], v[124:127], a[208:211], v[152:155]
    s_waitcnt lgkmcnt(11)
    s_barrier
    ds_read_b64_tr_b16 v[118:119], v79 offset:14592
    v_mfma_f32_16x16x32_bf16 v[128:131], v[176:179], a[224:227], v[128:131]
    ds_read_b64_tr_b16 v[120:121], v88 offset:0
    s_add_u32 s86, s72, 48
    s_lshl_b32 s86, s86, 12
    s_add_u32 s86, s86, s85
    v_mfma_f32_16x16x32_bf16 v[128:131], v[180:183], a[240:243], v[128:131]
    ds_read_b64_tr_b16 v[122:123], v88 offset:512
    buffer_load_dwordx4 a[124:127], v59, s[48:51], s80 offen sc1
    v_mfma_f32_16x16x32_bf16 v[132:135], v[176:179], a[228:231], v[132:135]
    ds_read_b64_tr_b16 v[124:125], v84 offset:16384
    s_mov_b32 s65, 0
    s_atomic_add s65, s[48:49], s89 offset:4 glc
    s_lshl_b32 s79, s66, 11
    v_mfma_f32_16x16x32_bf16 v[132:135], v[180:183], a[244:247], v[132:135]
    s_waitcnt lgkmcnt(11)
    ds_read_b64_tr_b16 v[126:127], v84 offset:16896
    buffer_load_dwordx4 v52, s[40:43], s78 offen offset:0  lds
    v_mfma_f32_16x16x32_bf16 v[140:143], v[184:187], a[228:231], v[140:143]
    s_sub_u32 s87, s86, s79
    s_add_u32 s86, s86, s79
    v_max_f32 v128, 0, v128
    v_max_f32 v129, 0, v129
    v_max_f32 v130, 0, v130
    v_mfma_f32_16x16x32_bf16 v[140:143], v[188:191], a[244:247], v[140:143]
    buffer_load_dwordx4 v53, s[40:43], s78 offen offset:1024  lds
    v_max_f32 v131, 0, v131
    v_max_f32 v132, 0, v132
    v_mfma_f32_16x16x32_bf16 v[136:139], v[184:187], a[224:227], v[136:139]
    v_max_f32 v133, 0, v133
    v_max_f32 v134, 0, v134
    v_max_f32 v135, 0, v135
    v_mfma_f32_16x16x32_bf16 v[136:139], v[188:191], a[240:243], v[136:139]
    s_waitcnt lgkmcnt(8)
    v_mfma_f32_16x16x32_bf16 v[144:147], v[104:107], a[224:227], v[144:147]
    ds_read_b64_tr_b16 v[176:177], v89 offset:0
    v_max_f32 v140, 0, v140
    v_max_f32 v141, 0, v141
    v_max_f32 v142, 0, v142
    v_mfma_f32_16x16x32_bf16 v[144:147], v[108:111], a[240:243], v[144:147]
    ds_read_b64_tr_b16 v[178:179], v89 offset:512
    buffer_load_dwordx4 v54, s[40:43], s78 offen offset:2048  lds
    v_mfma_f32_16x16x32_bf16 v[148:151], v[104:107], a[228:231], v[148:151]
    ds_read_b64_tr_b16 v[180:181], v85 offset:16384
    v_max_f32 v143, 0, v143
    v_max_f32 v136, 0, v136
    v_max_f32 v137, 0, v137
    v_mfma_f32_16x16x32_bf16 v[148:151], v[108:111], a[244:247], v[148:151]
    s_waitcnt lgkmcnt(7)
    ds_read_b64_tr_b16 v[182:183], v85 offset:16896
    buffer_load_dwordx4 v55, s[40:43], s78 offen offset:3072  lds
    v_mfma_f32_16x16x32_bf16 v[156:159], v[112:115], a[228:231], v[156:159]
    s_add_u32 m0, s74, 49152
    s_mul_i32 s78, s11, 3
    s_add_u32 s78, s78, s10
    v_max_f32 v138, 0, v138
    v_max_f32 v139, 0, v139
    v_mul_f32 v128, v128, v144
    v_mul_f32 v129, v129, v145
    v_mul_f32 v130, v130, v146
    v_mul_f32 v131, v131, v147
    v_mfma_f32_16x16x32_bf16 v[156:159], v[116:119], a[244:247], v[156:159]
    buffer_load_dwordx4 v52, s[40:43], s78 offen offset:0  lds
    v_cvt_pk_bf16_f32 v144, v128, v129
    v_cvt_pk_bf16_f32 v145, v130, v131
    v_mul_f32 v132, v132, v148
    v_mul_f32 v133, v133, v149
    v_mul_f32 v134, v134, v150
    v_mul_f32 v135, v135, v151
    v_mfma_f32_16x16x32_bf16 v[152:155], v[112:115], a[224:227], v[152:155]
    v_cvt_pk_bf16_f32 v148, v132, v133
    v_cvt_pk_bf16_f32 v149, v134, v135
    v_mfma_f32_16x16x32_bf16 v[152:155], v[116:119], a[240:243], v[152:155]
    s_waitcnt vmcnt(13) lgkmcnt(4)
    s_barrier
    v_mfma_f32_16x16x32_bf16 v[192:195], v[120:123], a[8:11], 0
    ds_read_b64_tr_b16 v[104:105], v90 offset:0
    v_mul_f32 v140, v140, v156
    v_mul_f32 v141, v141, v157
    v_mul_f32 v142, v142, v158
    v_mul_f32 v143, v143, v159
    v_cvt_pk_bf16_f32 v150, v140, v141
    v_cvt_pk_bf16_f32 v151, v142, v143
    v_mfma_f32_16x16x32_bf16 v[192:195], v[124:127], a[40:43], v[192:195]
    buffer_load_dwordx4 v53, s[40:43], s78 offen offset:1024  lds
    buffer_store_dwordx4 v[148:151], v21, s[48:51], s86 offen offset:1024 sc1
    v_mfma_f32_16x16x32_bf16 v[196:199], v[120:123], a[12:15], 0
    ds_read_b64_tr_b16 v[106:107], v90 offset:512
    v_mul_f32 v136, v136, v152
    v_mul_f32 v137, v137, v153
    v_mul_f32 v138, v138, v154
    v_mul_f32 v139, v139, v155
    v_cvt_pk_bf16_f32 v146, v136, v137
    v_cvt_pk_bf16_f32 v147, v138, v139
    v_mfma_f32_16x16x32_bf16 v[196:199], v[124:127], a[44:47], v[196:199]
    buffer_load_dwordx4 v54, s[40:43], s78 offen offset:2048  lds
    buffer_store_dwordx4 v[144:147], v21, s[48:51], s86 offen offset:0 sc1
    v_mfma_f32_16x16x32_bf16 v[200:203], v[120:123], a[24:27], 0
    ds_read_b64_tr_b16 v[108:109], v86 offset:16384
    v_mfma_f32_16x16x32_bf16 v[200:203], v[124:127], a[56:59], v[200:203]
    buffer_load_dwordx4 v55, s[40:43], s78 offen offset:3072  lds
    v_mfma_f32_16x16x32_bf16 v[204:207], v[120:123], a[28:31], 0
    ds_read_b64_tr_b16 v[110:111], v86 offset:16896
    s_add_u32 m0, s74, 65536
    v_mfma_f32_16x16x32_bf16 v[204:207], v[124:127], a[60:63], v[204:207]
    s_waitcnt lgkmcnt(4)
    s_mul_i32 s78, s11, 3
    s_add_u32 s78, s78, s10
    v_mfma_f32_16x16x32_bf16 v[220:223], v[176:179], a[28:31], 0
    ds_read_b64_tr_b16 v[112:113], v91 offset:0
    s_add_u32 s78, s78, 32768
    v_mfma_f32_16x16x32_bf16 v[220:223], v[180:183], a[60:63], v[220:223]
    buffer_load_dwordx4 v52, s[40:43], s78 offen offset:0  lds
    v_mfma_f32_16x16x32_bf16 v[216:219], v[176:179], a[24:27], 0
    ds_read_b64_tr_b16 v[114:115], v91 offset:512
    v_mfma_f32_16x16x32_bf16 v[216:219], v[180:183], a[56:59], v[216:219]
    buffer_load_dwordx4 v53, s[40:43], s78 offen offset:1024  lds
    v_mfma_f32_16x16x32_bf16 v[212:215], v[176:179], a[12:15], 0
    ds_read_b64_tr_b16 v[116:117], v87 offset:16384
    s_cmp_ge_u32 s65, 8
    s_cbranch_scc0 LB_slow2
LB_back2:
    v_mfma_f32_16x16x32_bf16 v[212:215], v[180:183], a[44:47], v[212:215]
    s_add_u32 s80, s81, 131072
    buffer_load_dwordx4 a[136:139], v56, s[48:51], s80 offen sc1
    v_mfma_f32_16x16x32_bf16 v[208:211], v[176:179], a[8:11], 0
    ds_read_b64_tr_b16 v[118:119], v87 offset:16896
    v_mfma_f32_16x16x32_bf16 v[208:211], v[180:183], a[40:43], v[208:211]
    s_waitcnt lgkmcnt(4)
    v_mfma_f32_16x16x32_bf16 v[224:227], v[104:107], a[8:11], 0
    ds_read_b64_tr_b16 v[120:121], v84 offset:32768
    v_mfma_f32_16x16x32_bf16 v[224:227], v[108:111], a[40:43], v[224:227]
    buffer_load_dwordx4 a[140:143], v57, s[48:51], s80 offen sc1
    v_mfma_f32_16x16x32_bf16 v[228:231], v[104:107], a[12:15], 0
    ds_read_b64_tr_b16 v[122:123], v84 offset:33280
    v_mfma_f32_16x16x32_bf16 v[228:231], v[108:111], a[44:47], v[228:231]
    buffer_load_dwordx4 a[152:155], v58, s[48:51], s80 offen sc1
    v_mfma_f32_16x16x32_bf16 v[232:235], v[104:107], a[24:27], 0
    ds_read_b64_tr_b16 v[124:125], v88 offset:16384
    v_mfma_f32_16x16x32_bf16 v[232:235], v[108:111], a[56:59], v[232:235]
    buffer_load_dwordx4 a[156:159], v59, s[48:51], s80 offen sc1
    v_mfma_f32_16x16x32_bf16 v[236:239], v[104:107], a[28:31], 0
    ds_read_b64_tr_b16 v[126:127], v88 offset:16896
    s_add_u32 s80, s81, 135168
    v_mfma_f32_16x16x32_bf16 v[236:239], v[108:111], a[60:63], v[236:239]
    s_waitcnt lgkmcnt(4)
    v_mfma_f32_16x16x32_bf16 v[252:255], v[112:115], a[28:31], 0
    ds_read_b64_tr_b16 v[104:105], v85 offset:32768
    v_mfma_f32_16x16x32_bf16 v[252:255], v[116:119], a[60:63], v[252:255]
    buffer_load_dwordx4 a[168:171], v56, s[48:51], s80 offen sc1
    v_mfma_f32_16x16x32_bf16 v[248:251], v[112:115], a[24:27], 0
    ds_read_b64_tr_b16 v[106:107], v85 offset:33280
    v_mfma_f32_16x16x32_bf16 v[248:251], v[116:119], a[56:59], v[248:251]
    buffer_load_dwordx4 a[172:175], v57, s[48:51], s80 offen sc1
    v_mfma_f32_16x16x32_bf16 v[244:247], v[112:115], a[12:15], 0
    ds_read_b64_tr_b16 v[108:109], v89 offset:16384
    v_mfma_f32_16x16x32_bf16 v[244:247], v[116:119], a[44:47], v[244:247]
    buffer_load_dwordx4 a[184:187], v58, s[48:51], s80 offen sc1
    s_waitcnt vmcnt(10)
    s_atomic_add s14, s[48:49], s88 offset:8 glc
    v_mfma_f32_16x16x32_bf16 v[240:243], v[112:115], a[8:11], 0
    ds_read_b64_tr_b16 v[110:111], v89 offset:16896
    v_mfma_f32_16x16x32_bf16 v[240:243], v[116:119], a[40:43], v[240:243]
    s_waitcnt lgkmcnt(4)
    buffer_load_dwordx4 a[188:191], v59, s[48:51], s80 offen sc1
    v_mfma_f32_16x16x32_bf16 v[192:195], v[120:123], a[72:75], v[192:195]
    ds_read_b64_tr_b16 v[112:113], v86 offset:32768
    s_add_u32 s80, s18, 139264
    v_mfma_f32_16x16x32_bf16 v[192:195], v[124:127], a[104:107], v[192:195]
    buffer_load_dwordx4 a[200:203], v56, s[48:51], s80 offen sc1
    v_mfma_f32_16x16x32_bf16 v[196:199], v[120:123], a[76:79], v[196:199]
    ds_read_b64_tr_b16 v[114:115], v86 offset:33280
    v_mfma_f32_16x16x32_bf16 v[196:199], v[124:127], a[108:111], v[196:199]
    buffer_load_dwordx4 a[204:207], v57, s[48:51], s80 offen sc1
    v_mfma_f32_16x16x32_bf16 v[200:203], v[120:123], a[88:91], v[200:203]
    ds_read_b64_tr_b16 v[116:117], v90 offset:16384
    v_mfma_f32_16x16x32_bf16 v[200:203], v[124:127], a[120:123], v[200:203]
    buffer_load_dwordx4 a[216:219], v58, s[48:51], s80 offen sc1
    v_mfma_f32_16x16x32_bf16 v[204:207], v[120:123], a[92:95], v[204:207]
    ds_read_b64_tr_b16 v[118:119], v90 offset:16896
    v_mfma_f32_16x16x32_bf16 v[204:207], v[124:127], a[124:127], v[204:207]
    s_waitcnt lgkmcnt(4)
    v_mfma_f32_16x16x32_bf16 v[220:223], v[104:107], a[92:95], v[220:223]
    ds_read_b64_tr_b16 v[120:121], v87 offset:32768
    v_mfma_f32_16x16x32_bf16 v[220:223], v[108:111], a[124:127], v[220:223]
    buffer_load_dwordx4 a[220:223], v59, s[48:51], s80 offen sc1
    v_mfma_f32_16x16x32_bf16 v[216:219], v[104:107], a[88:91], v[216:219]
    ds_read_b64_tr_b16 v[122:123], v87 offset:33280
    s_add_u32 s80, s18, 143360
    v_mfma_f32_16x16x32_bf16 v[216:219], v[108:111], a[120:123], v[216:219]
    buffer_load_dwordx4 a[232:235], v56, s[48:51], s80 offen sc1
    v_mfma_f32_16x16x32_bf16 v[212:215], v[104:107], a[76:79], v[212:215]
    ds_read_b64_tr_b16 v[124:125], v91 offset:16384
    v_mfma_f32_16x16x32_bf16 v[212:215], v[108:111], a[108:111], v[212:215]
    buffer_load_dwordx4 a[236:239], v57, s[48:51], s80 offen sc1
    v_mfma_f32_16x16x32_bf16 v[208:211], v[104:107], a[72:75], v[208:211]
    ds_read_b64_tr_b16 v[126:127], v91 offset:16896
    v_mfma_f32_16x16x32_bf16 v[208:211], v[108:111], a[104:107], v[208:211]
    s_waitcnt lgkmcnt(4)
    v_mfma_f32_16x16x32_bf16 v[224:227], v[112:115], a[72:75], v[224:227]
    ds_read_b64_tr_b16 v[104:105], v84 offset:49152
    v_mfma_f32_16x16x32_bf16 v[224:227], v[116:119], a[104:107], v[224:227]
    buffer_load_dwordx4 a[248:251], v58, s[48:51], s80 offen sc1
    v_mfma_f32_16x16x32_bf16 v[228:231], v[112:115], a[76:79], v[228:231]
    ds_read_b64_tr_b16 v[106:107], v84 offset:49664
    v_mfma_f32_16x16x32_bf16 v[228:231], v[116:119], a[108:111], v[228:231]
    buffer_load_dwordx4 a[252:255], v59, s[48:51], s80 offen sc1
    v_mfma_f32_16x16x32_bf16 v[232:235], v[112:115], a[88:91], v[232:235]
    ds_read_b64_tr_b16 v[108:109], v80 offset:0
    s_add_u32 s80, s81, 65536
    v_mfma_f32_16x16x32_bf16 v[232:235], v[116:119], a[120:123], v[232:235]
    buffer_load_dwordx4 v54, s[40:43], s78 offen offset:2048  lds
    v_mfma_f32_16x16x32_bf16 v[236:239], v[112:115], a[92:95], v[236:239]
    ds_read_b64_tr_b16 v[110:111], v80 offset:512
    v_mfma_f32_16x16x32_bf16 v[236:239], v[116:119], a[124:127], v[236:239]
    s_waitcnt lgkmcnt(4)
    buffer_load_dwordx4 v55, s[40:43], s78 offen offset:3072  lds
    v_mfma_f32_16x16x32_bf16 v[252:255], v[120:123], a[92:95], v[252:255]
    ds_read_b64_tr_b16 v[112:113], v85 offset:49152
    s_add_u32 m0, s74, 81920
    v_mfma_f32_16x16x32_bf16 v[252:255], v[124:127], a[124:127], v[252:255]
    buffer_load_dwordx4 a[0:3], v56, s[48:51], s80 offen sc1
    v_mfma_f32_16x16x32_bf16 v[248:251], v[120:123], a[88:91], v[248:251]
    ds_read_b64_tr_b16 v[114:115], v85 offset:49664
    s_mul_i32 s78, vcc_hi, 3
    v_mfma_f32_16x16x32_bf16 v[248:251], v[124:127], a[120:123], v[248:251]
    buffer_load_dwordx4 a[4:7], v57, s[48:51], s80 offen sc1
    s_lshl_b32 s76, s70, 7
    s_add_u32 s76, s76, 9846784
    s_mov_b32 s67, 0
    s_atomic_add s67, s[48:49], s76 offset:0 glc
    v_mfma_f32_16x16x32_bf16 v[244:247], v[120:123], a[76:79], v[244:247]
    ds_read_b64_tr_b16 v[116:117], v81 offset:0
    s_add_u32 s78, s78, vcc_lo
    v_mfma_f32_16x16x32_bf16 v[244:247], v[124:127], a[108:111], v[244:247]
    buffer_load_dwordx4 a[16:19], v58, s[48:51], s80 offen sc1
    v_mfma_f32_16x16x32_bf16 v[240:243], v[120:123], a[72:75], v[240:243]
    ds_read_b64_tr_b16 v[118:119], v81 offset:512
    v_mfma_f32_16x16x32_bf16 v[240:243], v[124:127], a[104:107], v[240:243]
    s_waitcnt vmcnt(13) lgkmcnt(4)
    v_mfma_f32_16x16x32_bf16 v[192:195], v[104:107], a[136:139], v[192:195]
    ds_read_b64_tr_b16 v[120:121], v86 offset:49152
    v_mfma_f32_16x16x32_bf16 v[192:195], v[108:111], a[168:171], v[192:195]
    buffer_load_dwordx4 a[20:23], v59, s[48:51], s80 offen sc1
    v_mfma_f32_16x16x32_bf16 v[196:199], v[104:107], a[140:143], v[196:199]
    ds_read_b64_tr_b16 v[122:123], v86 offset:49664
    s_add_u32 s80, s81, 69632
    v_mfma_f32_16x16x32_bf16 v[196:199], v[108:111], a[172:175], v[196:199]
    buffer_load_dwordx4 a[32:35], v56, s[48:51], s80 offen sc1
    v_mfma_f32_16x16x32_bf16 v[200:203], v[104:107], a[152:155], v[200:203]
    ds_read_b64_tr_b16 v[124:125], v82 offset:0
    v_mfma_f32_16x16x32_bf16 v[200:203], v[108:111], a[184:187], v[200:203]
    buffer_load_dwordx4 a[36:39], v57, s[48:51], s80 offen sc1
    v_mfma_f32_16x16x32_bf16 v[204:207], v[104:107], a[156:159], v[204:207]
    ds_read_b64_tr_b16 v[126:127], v82 offset:512
    v_mfma_f32_16x16x32_bf16 v[204:207], v[108:111], a[188:191], v[204:207]
    s_waitcnt lgkmcnt(4)
    v_mfma_f32_16x16x32_bf16 v[220:223], v[112:115], a[156:159], v[220:223]
    ds_read_b64_tr_b16 v[104:105], v87 offset:49152
    v_mfma_f32_16x16x32_bf16 v[220:223], v[116:119], a[188:191], v[220:223]
    buffer_load_dwordx4 a[48:51], v58, s[48:51], s80 offen sc1
    v_mfma_f32_16x16x32_bf16 v[216:219], v[112:115], a[152:155], v[216:219]
    ds_read_b64_tr_b16 v[106:107], v87 offset:49664
    v_mfma_f32_16x16x32_bf16 v[216:219], v[116:119], a[184:187], v[216:219]
    buffer_load_dwordx4 a[52:55], v59, s[48:51], s80 offen sc1
    v_mfma_f32_16x16x32_bf16 v[212:215], v[112:115], a[140:143], v[212:215]
    ds_read_b64_tr_b16 v[108:109], v83 offset:0
    s_add_u32 s80, s18, 73728
    v_mfma_f32_16x16x32_bf16 v[212:215], v[116:119], a[172:175], v[212:215]
    buffer_load_dwordx4 v52, s[40:43], s78 offen offset:0  lds
    v_mfma_f32_16x16x32_bf16 v[208:211], v[112:115], a[136:139], v[208:211]
    ds_read_b64_tr_b16 v[110:111], v83 offset:512
    v_mfma_f32_16x16x32_bf16 v[208:211], v[116:119], a[168:171], v[208:211]
    s_waitcnt lgkmcnt(4)
    v_mfma_f32_16x16x32_bf16 v[224:227], v[120:123], a[136:139], v[224:227]
    ds_read_b64_tr_b16 v[112:113], v80 offset:16384
    v_mfma_f32_16x16x32_bf16 v[224:227], v[124:127], a[168:171], v[224:227]
    buffer_load_dwordx4 v53, s[40:43], s78 offen offset:1024  lds
    v_mfma_f32_16x16x32_bf16 v[228:231], v[120:123], a[140:143], v[228:231]
    ds_read_b64_tr_b16 v[114:115], v80 offset:16896
LB_pg4:
    s_cbranch_execz LB_walked
    v_mfma_f32_16x16x32_bf16 v[228:231], v[124:127], a[172:175], v[228:231]
    buffer_load_dwordx4 v54, s[40:43], s78 offen offset:2048  lds
    v_mfma_f32_16x16x32_bf16 v[232:235], v[120:123], a[152:155], v[232:235]
    ds_read_b64_tr_b16 v[116:117], v80 offset:32768
    v_mfma_f32_16x16x32_bf16 v[232:235], v[124:127], a[184:187], v[232:235]
    buffer_load_dwordx4 v55, s[40:43], s78 offen offset:3072  lds
    v_mfma_f32_16x16x32_bf16 v[236:239], v[120:123], a[156:159], v[236:239]
    ds_read_b64_tr_b16 v[118:119], v80 offset:33280
    s_add_u32 m0, s74, 131072
    v_mfma_f32_16x16x32_bf16 v[236:239], v[124:127], a[188:191], v[236:239]
    s_waitcnt lgkmcnt(4)
    s_mul_i32 s78, vcc_hi, 3
    s_add_u32 s78, s78, vcc_lo
    s_add_u32 s78, s78, 32768
    buffer_load_dwordx4 v52, s[40:43], s78 offen offset:0  lds
    v_mfma_f32_16x16x32_bf16 v[252:255], v[104:107], a[156:159], v[252:255]
    ds_read_b64_tr_b16 v[120:121], v81 offset:16384
    v_mfma_f32_16x16x32_bf16 v[252:255], v[108:111], a[188:191], v[252:255]
    buffer_load_dwordx4 v53, s[40:43], s78 offen offset:1024  lds
    v_mfma_f32_16x16x32_bf16 v[248:251], v[104:107], a[152:155], v[248:251]
    ds_read_b64_tr_b16 v[122:123], v81 offset:16896
    v_mfma_f32_16x16x32_bf16 v[248:251], v[108:111], a[184:187], v[248:251]
    buffer_load_dwordx4 v54, s[40:43], s78 offen offset:2048  lds
    v_mfma_f32_16x16x32_bf16 v[244:247], v[104:107], a[140:143], v[244:247]
    ds_read_b64_tr_b16 v[124:125], v81 offset:32768
    v_mfma_f32_16x16x32_bf16 v[244:247], v[108:111], a[172:175], v[244:247]
    buffer_load_dwordx4 v55, s[40:43], s78 offen offset:3072  lds
    v_mfma_f32_16x16x32_bf16 v[240:243], v[104:107], a[136:139], v[240:243]
    ds_read_b64_tr_b16 v[126:127], v81 offset:33280
    s_add_u32 m0, s74, 98304
    v_mfma_f32_16x16x32_bf16 v[240:243], v[108:111], a[168:171], v[240:243]
    s_waitcnt vmcnt(18) lgkmcnt(4)
    s_add_u32 s78, s84, 0
    v_mfma_f32_16x16x32_bf16 v[192:195], v[112:115], a[200:203], v[192:195]
    ds_read_b64_tr_b16 v[104:105], v82 offset:16384
    v_add_u32 v4, s74, v21
    v_add_u32 v13, 49152, v4
    v_xor_b32 v5, 4096, v13
    v_add_u32 v14, 65536, v4
    v_xor_b32 v6, 8192, v14
    v_add_u32 v15, 81920, v4
    v_xor_b32 v7, 12288, v15
    v_mfma_f32_16x16x32_bf16 v[192:195], v[116:119], a[232:235], v[192:195]
    buffer_load_dwordx4 a[64:67], v56, s[48:51], s80 offen sc1
    v_and_b32 v28, 7, v20
    v_lshlrev_b32 v28, 10, v28
    v_bfe_u32 v29, v20, 3, 1
    v_lshl_add_u32 v28, v29, 6, v28
    v_bfe_u32 v29, v20, 4, 1
    v_lshl_add_u32 v28, v29, 5, v28
    v_mfma_f32_16x16x32_bf16 v[196:199], v[112:115], a[204:207], v[196:199]
    ds_read_b64_tr_b16 v[106:107], v82 offset:16896
    v_lshrrev_b32 v29, 5, v20
    v_lshl_add_u32 v12, v29, 4, v28
    v_mfma_f32_16x16x32_bf16 v[196:199], v[116:119], a[236:239], v[196:199]
    buffer_load_dwordx4 a[68:71], v57, s[48:51], s80 offen sc1
    s_mov_b32 s69, 0
    s_atomic_add s69, s[48:49], s89 offset:8 glc
    s_lshl_b32 s86, s70, 2
    s_add_u32 s86, s86, s64
    s_lshl_b32 s86, s86, 14
    s_lshl_b32 s79, s71, 7
    v_mfma_f32_16x16x32_bf16 v[200:203], v[112:115], a[216:219], v[200:203]
    ds_read_b64_tr_b16 v[108:109], v82 offset:32768
    s_add_u32 s86, s86, s79
    s_add_u32 s87, s86, 8192
    v_mfma_f32_16x16x32_bf16 v[200:203], v[116:119], a[248:251], v[200:203]
    buffer_load_dwordx4 a[80:83], v58, s[48:51], s80 offen sc1
    v_mfma_f32_16x16x32_bf16 v[204:207], v[112:115], a[220:223], v[204:207]
    ds_read_b64_tr_b16 v[110:111], v82 offset:33280
    v_mfma_f32_16x16x32_bf16 v[204:207], v[116:119], a[252:255], v[204:207]
    s_waitcnt lgkmcnt(4)
    v_mfma_f32_16x16x32_bf16 v[220:223], v[120:123], a[220:223], v[220:223]
    ds_read_b64_tr_b16 v[112:113], v83 offset:16384
    v_mfma_f32_16x16x32_bf16 v[220:223], v[124:127], a[252:255], v[220:223]
    buffer_load_dwordx4 a[84:87], v59, s[48:51], s80 offen sc1
    v_mfma_f32_16x16x32_bf16 v[216:219], v[120:123], a[216:219], v[216:219]
    ds_read_b64_tr_b16 v[114:115], v83 offset:16896
    s_add_u32 s80, s18, 77824
    v_mfma_f32_16x16x32_bf16 v[216:219], v[124:127], a[248:251], v[216:219]
    buffer_load_dwordx4 a[96:99], v56, s[48:51], s80 offen sc1
    v_mfma_f32_16x16x32_bf16 v[212:215], v[120:123], a[204:207], v[212:215]
    ds_read_b64_tr_b16 v[116:117], v83 offset:32768
    v_mfma_f32_16x16x32_bf16 v[212:215], v[124:127], a[236:239], v[212:215]
    buffer_load_dwordx4 a[100:103], v57, s[48:51], s80 offen sc1
    v_mfma_f32_16x16x32_bf16 v[208:211], v[120:123], a[200:203], v[208:211]
    ds_read_b64_tr_b16 v[118:119], v83 offset:33280
    v_mfma_f32_16x16x32_bf16 v[208:211], v[124:127], a[232:235], v[208:211]
    s_waitcnt lgkmcnt(4)
    buffer_load_dwordx4 a[112:115], v58, s[48:51], s80 offen sc1
    v_mfma_f32_16x16x32_bf16 v[224:227], v[104:107], a[200:203], v[224:227]
    ds_read_b64_tr_b16 v[120:121], v80 offset:49152
    v_mfma_f32_16x16x32_bf16 v[224:227], v[108:111], a[232:235], v[224:227]
    buffer_load_dwordx4 a[116:119], v59, s[48:51], s80 offen sc1
    v_mfma_f32_16x16x32_bf16 v[228:231], v[104:107], a[204:207], v[228:231]
    ds_read_b64_tr_b16 v[122:123], v80 offset:49664
    s_cmp_ge_u32 s67, 32
    s_cbranch_scc0 LB_slow5
LB_back5:
    v_mfma_f32_16x16x32_bf16 v[228:231], v[108:111], a[236:239], v[228:231]
    s_lshl_b32 s77, s64, 8
    v_xor_b32 v64, s77, v21
    v_lshrrev_b32 v64, 2, v64
    s_lshl_b32 s77, s70, 8
    s_add_u32 s77, s77, 9764864
    buffer_load_dword v60, v64, s[48:51], s77 offen sc1
    v_mfma_f32_16x16x32_bf16 v[232:235], v[104:107], a[216:219], v[232:235]
    s_waitcnt vmcnt(25)
    ds_read_b64_tr_b16 v[124:125], v84 offset:0
    v_mfma_f32_16x16x32_bf16 v[232:235], v[108:111], a[248:251], v[232:235]
    buffer_load_dwordx4 v52, s[40:43], s78 offen offset:0  lds
    v_mfma_f32_16x16x32_bf16 v[236:239], v[104:107], a[220:223], v[236:239]
    ds_read_b64_tr_b16 v[126:127], v84 offset:512
    v_mfma_f32_16x16x32_bf16 v[236:239], v[108:111], a[252:255], v[236:239]
    s_waitcnt lgkmcnt(4)
    v_mfma_f32_16x16x32_bf16 v[252:255], v[112:115], a[220:223], v[252:255]
    ds_read_b64_tr_b16 v[104:105], v81 offset:49152
    v_mfma_f32_16x16x32_bf16 v[252:255], v[116:119], a[252:255], v[252:255]
    buffer_load_dwordx4 v53, s[40:43], s78 offen offset:1024  lds
    v_mfma_f32_16x16x32_bf16 v[248:251], v[112:115], a[216:219], v[248:251]
    ds_read_b64_tr_b16 v[106:107], v81 offset:49664
    v_mfma_f32_16x16x32_bf16 v[248:251], v[116:119], a[248:251], v[248:251]
    buffer_load_dwordx4 v54, s[40:43], s78 offen offset:2048  lds
    v_mfma_f32_16x16x32_bf16 v[244:247], v[112:115], a[204:207], v[244:247]
    ds_read_b64_tr_b16 v[108:109], v85 offset:0
    v_mfma_f32_16x16x32_bf16 v[244:247], v[116:119], a[236:239], v[244:247]
    buffer_load_dwordx4 v55, s[40:43], s78 offen offset:3072  lds
    v_mfma_f32_16x16x32_bf16 v[240:243], v[112:115], a[200:203], v[240:243]
    ds_read_b64_tr_b16 v[110:111], v85 offset:512
    s_add_u32 m0, s74, 147456
    v_mfma_f32_16x16x32_bf16 v[240:243], v[116:119], a[232:235], v[240:243]
    s_waitcnt vmcnt(21) lgkmcnt(4)
    s_add_u32 s78, s21, 32768
    v_mfma_f32_16x16x32_bf16 v[192:195], v[120:123], a[0:3], v[192:195]
    ds_read_b64_tr_b16 v[112:113], v82 offset:49152
    v_mfma_f32_16x16x32_bf16 v[192:195], v[124:127], a[32:35], v[192:195]
    buffer_load_dwordx4 v52, s[40:43], s78 offen offset:0  lds
    v_mfma_f32_16x16x32_bf16 v[196:199], v[120:123], a[4:7], v[196:199]
    ds_read_b64_tr_b16 v[114:115], v82 offset:49664
    s_cmp_ge_u32 s69, 4
    s_cbranch_scc0 LB_slow3
LB_back3:
    v_mfma_f32_16x16x32_bf16 v[196:199], v[124:127], a[36:39], v[196:199]
    buffer_load_dwordx4 v53, s[40:43], s78 offen offset:1024  lds
    v_mfma_f32_16x16x32_bf16 v[200:203], v[120:123], a[16:19], v[200:203]
    ds_read_b64_tr_b16 v[116:117], v86 offset:0
    s_add_u32 s80, s82, 196608
    v_mfma_f32_16x16x32_bf16 v[200:203], v[124:127], a[48:51], v[200:203]
    buffer_load_dwordx4 v54, s[40:43], s78 offen offset:2048  lds
    v_mfma_f32_16x16x32_bf16 v[204:207], v[120:123], a[20:23], v[204:207]
    ds_read_b64_tr_b16 v[118:119], v86 offset:512
    v_mfma_f32_16x16x32_bf16 v[204:207], v[124:127], a[52:55], v[204:207]
    s_waitcnt lgkmcnt(4)
    buffer_load_dwordx4 v55, s[40:43], s78 offen offset:3072  lds
    v_mfma_f32_16x16x32_bf16 v[220:223], v[104:107], a[20:23], v[220:223]
    ds_read_b64_tr_b16 v[120:121], v83 offset:49152
    s_add_u32 m0, s74, 0
    v_mfma_f32_16x16x32_bf16 v[220:223], v[108:111], a[52:55], v[220:223]
    s_add_u32 s78, s83, 0
    buffer_load_dwordx4 v52, s[44:47], s78 offen offset:0  lds
    v_mfma_f32_16x16x32_bf16 v[216:219], v[104:107], a[16:19], v[216:219]
    ds_read_b64_tr_b16 v[122:123], v83 offset:49664
    v_mfma_f32_16x16x32_bf16 v[216:219], v[108:111], a[48:51], v[216:219]
    buffer_load_dwordx4 v53, s[44:47], s78 offen offset:1024  lds
    v_mfma_f32_16x16x32_bf16 v[212:215], v[104:107], a[4:7], v[212:215]
    ds_read_b64_tr_b16 v[124:125], v87 offset:0
    v_mfma_f32_16x16x32_bf16 v[212:215], v[108:111], a[36:39], v[212:215]
    buffer_load_dwordx4 v54, s[44:47], s78 offen offset:2048  lds
    v_mfma_f32_16x16x32_bf16 v[208:211], v[104:107], a[0:3], v[208:211]
    ds_read_b64_tr_b16 v[126:127], v87 offset:512
    v_mfma_f32_16x16x32_bf16 v[208:211], v[108:111], a[32:35], v[208:211]
    s_waitcnt lgkmcnt(4)
    v_mfma_f32_16x16x32_bf16 v[224:227], v[112:115], a[0:3], v[224:227]
    s_waitcnt vmcnt(24)
    ds_read_b64_tr_b16 v[104:105], v84 offset:16384
    v_mfma_f32_16x16x32_bf16 v[224:227], v[116:119], a[32:35], v[224:227]
    buffer_load_dwordx4 v55, s[44:47], s78 offen offset:3072  lds
    v_mfma_f32_16x16x32_bf16 v[228:231], v[112:115], a[4:7], v[228:231]
    ds_read_b64_tr_b16 v[106:107], v84 offset:16896
    s_add_u32 m0, s74, 114688
    v_mfma_f32_16x16x32_bf16 v[228:231], v[116:119], a[36:39], v[228:231]
    buffer_load_dwordx4 a[128:131], v56, s[48:51], s80 offen sc1
    s_mov_b32 s65, 0
    s_atomic_add s65, s[48:49], s89 offset:12 glc
    v_mfma_f32_16x16x32_bf16 v[232:235], v[112:115], a[16:19], v[232:235]
    s_waitcnt vmcnt(22)
    ds_read_b64_tr_b16 v[108:109], v88 offset:0
    s_add_u32 s78, s83, 32768
    v_mfma_f32_16x16x32_bf16 v[232:235], v[116:119], a[48:51], v[232:235]
    buffer_load_dwordx4 a[132:135], v57, s[48:51], s80 offen sc1
    v_mfma_f32_16x16x32_bf16 v[236:239], v[112:115], a[20:23], v[236:239]
    ds_read_b64_tr_b16 v[110:111], v88 offset:512
    v_mfma_f32_16x16x32_bf16 v[236:239], v[116:119], a[52:55], v[236:239]
    s_waitcnt lgkmcnt(4)
    v_mfma_f32_16x16x32_bf16 v[252:255], v[120:123], a[20:23], v[252:255]
    ds_read_b64_tr_b16 v[112:113], v85 offset:16384
    v_mfma_f32_16x16x32_bf16 v[252:255], v[124:127], a[52:55], v[252:255]
    buffer_load_dwordx4 a[144:147], v58, s[48:51], s80 offen sc1
    v_mfma_f32_16x16x32_bf16 v[248:251], v[120:123], a[16:19], v[248:251]
    ds_read_b64_tr_b16 v[114:115], v85 offset:16896
    v_mfma_f32_16x16x32_bf16 v[248:251], v[124:127], a[48:51], v[248:251]
    buffer_load_dwordx4 a[148:151], v59, s[48:51], s80 offen sc1
    v_mfma_f32_16x16x32_bf16 v[244:247], v[120:123], a[4:7], v[244:247]
    ds_read_b64_tr_b16 v[116:117], v89 offset:0
    s_add_u32 s80, s19, 200704
    v_mfma_f32_16x16x32_bf16 v[244:247], v[124:127], a[36:39], v[244:247]
    buffer_load_dwordx4 a[160:163], v56, s[48:51], s80 offen sc1
    v_mfma_f32_16x16x32_bf16 v[240:243], v[120:123], a[0:3], v[240:243]
    ds_read_b64_tr_b16 v[118:119], v89 offset:512
    v_mfma_f32_16x16x32_bf16 v[240:243], v[124:127], a[32:35], v[240:243]
    s_waitcnt vmcnt(18) lgkmcnt(4)
    v_mfma_f32_16x16x32_bf16 v[192:195], v[104:107], a[64:67], v[192:195]
    ds_read_b64_tr_b16 v[120:121], v86 offset:16384
    s_waitcnt vmcnt(17)
    v_mov_b32 v61, v60
    s_nop 1
    v_permlane16_swap_b32 v60, v61
    v_mov_b32 v62, v60
    v_mov_b32 v63, v61
    s_nop 0
    v_permlane32_swap_b32 v60, v62
    v_permlane32_swap_b32 v61, v63
    v_sub_f32 v64, 1.0, v60
    v_mfma_f32_16x16x32_bf16 v[192:195], v[108:111], a[96:99], v[192:195]
    buffer_load_dwordx4 a[164:167], v57, s[48:51], s80 offen sc1
    v_sub_f32 v65, 1.0, v61
    v_sub_f32 v66, 1.0, v62
    v_sub_f32 v67, 1.0, v63
    v_mfma_f32_16x16x32_bf16 v[196:199], v[104:107], a[68:71], v[196:199]
    ds_read_b64_tr_b16 v[122:123], v86 offset:16896
    v_mfma_f32_16x16x32_bf16 v[196:199], v[108:111], a[100:103], v[196:199]
    buffer_load_dwordx4 a[176:179], v58, s[48:51], s80 offen sc1
    v_mfma_f32_16x16x32_bf16 v[200:203], v[104:107], a[80:83], v[200:203]
    ds_read_b64_tr_b16 v[124:125], v90 offset:0
    v_mfma_f32_16x16x32_bf16 v[200:203], v[108:111], a[112:115], v[200:203]
    buffer_load_dwordx4 a[180:183], v59, s[48:51], s80 offen sc1
    v_mfma_f32_16x16x32_bf16 v[204:207], v[104:107], a[84:87], v[204:207]
    ds_read_b64_tr_b16 v[126:127], v90 offset:512
    v_mfma_f32_16x16x32_bf16 v[204:207], v[108:111], a[116:119], v[204:207]
    s_waitcnt lgkmcnt(4)
    buffer_load_dwordx4 v52, s[44:47], s78 offen offset:0  lds
    v_mfma_f32_16x16x32_bf16 v[220:223], v[112:115], a[84:87], v[220:223]
    ds_read_b64_tr_b16 v[104:105], v87 offset:16384
    v_mfma_f32_16x16x32_bf16 v[220:223], v[116:119], a[116:119], v[220:223]
    buffer_load_dwordx4 v53, s[44:47], s78 offen offset:1024  lds
    v_mfma_f32_16x16x32_bf16 v[216:219], v[112:115], a[80:83], v[216:219]
    ds_read_b64_tr_b16 v[106:107], v87 offset:16896
    v_mfma_f32_16x16x32_bf16 v[216:219], v[116:119], a[112:115], v[216:219]
    buffer_load_dwordx4 v54, s[44:47], s78 offen offset:2048  lds
    v_mfma_f32_16x16x32_bf16 v[212:215], v[112:115], a[68:71], v[212:215]
    ds_read_b64_tr_b16 v[108:109], v91 offset:0
    v_mfma_f32_16x16x32_bf16 v[212:215], v[116:119], a[100:103], v[212:215]
    buffer_load_dwordx4 v55, s[44:47], s78 offen offset:3072  lds
    v_mfma_f32_16x16x32_bf16 v[208:211], v[112:115], a[64:67], v[208:211]
    ds_read_b64_tr_b16 v[110:111], v91 offset:512
    s_add_u32 m0, s74, 16384
    v_mfma_f32_16x16x32_bf16 v[208:211], v[116:119], a[96:99], v[208:211]
    s_waitcnt lgkmcnt(4)
    s_add_u32 s78, s20, 65536
    v_mfma_f32_16x16x32_bf16 v[224:227], v[120:123], a[64:67], v[224:227]
    s_waitcnt vmcnt(20)
    ds_read_b64_tr_b16 v[112:113], v84 offset:32768
    v_mfma_f32_16x16x32_bf16 v[224:227], v[124:127], a[96:99], v[224:227]
    ds_read_b64_tr_b16 v[114:115], v84 offset:33280
    buffer_load_dwordx4 v52, s[44:47], s78 offen offset:0  lds
    v_mfma_f32_16x16x32_bf16 v[228:231], v[120:123], a[68:71], v[228:231]
    s_waitcnt vmcnt(17)
    ds_read_b64_tr_b16 v[116:117], v88 offset:16384
    s_cmp_ge_u32 s65, 4
    s_cbranch_scc0 LB_slow4
LB_back4:
    v_mfma_f32_16x16x32_bf16 v[228:231], v[124:127], a[100:103], v[228:231]
    ds_read_b64_tr_b16 v[118:119], v88 offset:16896
    buffer_load_dwordx4 v53, s[44:47], s78 offen offset:1024  lds
    v_mfma_f32_16x16x32_bf16 v[232:235], v[120:123], a[80:83], v[232:235]
    s_waitcnt vmcnt(14)
    ds_read_b64_tr_b16 a[72:73], v80 offset:0
    s_add_u32 s92, s81, 229376
    v_mfma_f32_16x16x32_bf16 v[232:235], v[124:127], a[112:115], v[232:235]
    ds_read_b64_tr_b16 a[74:75], v80 offset:512
    buffer_load_dwordx4 v54, s[44:47], s78 offen offset:2048  lds
    v_mfma_f32_16x16x32_bf16 v[236:239], v[120:123], a[84:87], v[236:239]
    ds_read_b64_tr_b16 a[76:77], v81 offset:0
    s_add_u32 s93, s81, 233472
    v_mfma_f32_16x16x32_bf16 v[236:239], v[124:127], a[116:119], v[236:239]
    s_waitcnt lgkmcnt(7)
    ds_read_b64_tr_b16 a[78:79], v81 offset:512
    v_mfma_f32_16x16x32_bf16 v[252:255], v[104:107], a[84:87], v[252:255]
    ds_read_b64_tr_b16 v[120:121], v85 offset:32768
    s_add_u32 s94, s18, 237568
    v_mfma_f32_16x16x32_bf16 v[252:255], v[108:111], a[116:119], v[252:255]
    ds_read_b64_tr_b16 v[122:123], v85 offset:33280
    buffer_load_dwordx4 v55, s[44:47], s78 offen offset:3072  lds
    v_mfma_f32_16x16x32_bf16 v[248:251], v[104:107], a[80:83], v[248:251]
    ds_read_b64_tr_b16 v[124:125], v89 offset:16384
    s_add_u32 m0, s74, 32768
    v_mfma_f32_16x16x32_bf16 v[248:251], v[108:111], a[112:115], v[248:251]
    ds_read_b64_tr_b16 v[126:127], v89 offset:16896
    s_add_u32 s78, s20, 98304
    buffer_load_dwordx4 v52, s[44:47], s78 offen offset:0  lds
    v_mfma_f32_16x16x32_bf16 v[244:247], v[104:107], a[68:71], v[244:247]
    ds_read_b64_tr_b16 a[88:89], v82 offset:0
    s_add_u32 s95, s18, 241664
    v_mfma_f32_16x16x32_bf16 v[244:247], v[108:111], a[100:103], v[244:247]
    ds_read_b64_tr_b16 a[90:91], v82 offset:512
    buffer_load_dwordx4 v53, s[44:47], s78 offen offset:1024  lds
    v_mfma_f32_16x16x32_bf16 v[240:243], v[104:107], a[64:67], v[240:243]
    ds_read_b64_tr_b16 a[92:93], v83 offset:0
    v_mfma_f32_16x16x32_bf16 v[240:243], v[108:111], a[96:99], v[240:243]
    s_waitcnt vmcnt(10) lgkmcnt(11)
    ds_read_b64_tr_b16 a[94:95], v83 offset:512
    v_mfma_f32_16x16x32_bf16 v[192:195], v[112:115], a[128:131], v[192:195]
    ds_read_b64_tr_b16 v[104:105], v86 offset:32768
    v_mfma_f32_16x16x32_bf16 v[192:195], v[116:119], a[160:163], v[192:195]
    ds_read_b64_tr_b16 v[106:107], v86 offset:33280
    buffer_load_dwordx4 v54, s[44:47], s78 offen offset:2048  lds
    v_mfma_f32_16x16x32_bf16 v[196:199], v[112:115], a[132:135], v[196:199]
    ds_read_b64_tr_b16 v[108:109], v90 offset:16384
    v_mfma_f32_16x16x32_bf16 v[196:199], v[116:119], a[164:167], v[196:199]
    ds_read_b64_tr_b16 v[110:111], v90 offset:16896
    buffer_load_dwordx4 v55, s[44:47], s78 offen offset:3072  lds
    v_mfma_f32_16x16x32_bf16 v[200:203], v[112:115], a[144:147], v[200:203]
    s_waitcnt vmcnt(8)
    ds_read_b64_tr_b16 a[104:105], v84 offset:49152
    v_mfma_f32_16x16x32_bf16 v[200:203], v[116:119], a[176:179], v[200:203]
    ds_read_b64_tr_b16 a[106:107], v84 offset:49664
    buffer_load_dwordx4 a[196:199], v57, s[48:51], s92 offen sc1
    v_mfma_f32_16x16x32_bf16 v[204:207], v[112:115], a[148:151], v[204:207]
    ds_read_b64_tr_b16 a[108:109], v85 offset:49152
    v_mfma_f32_16x16x32_bf16 v[204:207], v[116:119], a[180:183], v[204:207]
    s_waitcnt lgkmcnt(11)
    ds_read_b64_tr_b16 a[110:111], v85 offset:49664
    v_mfma_f32_16x16x32_bf16 v[220:223], v[120:123], a[148:151], v[220:223]
    ds_read_b64_tr_b16 v[112:113], v87 offset:32768
    v_mul_f32 v196, v196, v65
    v_mul_f32 v197, v197, v65
    v_mfma_f32_16x16x32_bf16 v[220:223], v[124:127], a[180:183], v[220:223]
    ds_read_b64_tr_b16 v[114:115], v87 offset:33280
    buffer_load_dwordx4 a[228:231], v57, s[48:51], s93 offen sc1
    v_mfma_f32_16x16x32_bf16 v[216:219], v[120:123], a[144:147], v[216:219]
    ds_read_b64_tr_b16 v[116:117], v91 offset:16384
    v_mul_f32 v198, v198, v65
    v_mul_f32 v199, v199, v65
    v_mfma_f32_16x16x32_bf16 v[216:219], v[124:127], a[176:179], v[216:219]
    ds_read_b64_tr_b16 v[118:119], v91 offset:16896
    buffer_load_dwordx4 a[12:15], v57, s[48:51], s94 offen sc1
    v_mfma_f32_16x16x32_bf16 v[212:215], v[120:123], a[132:135], v[212:215]
    ds_read_b64_tr_b16 a[120:121], v86 offset:49152
    v_mul_f32 v200, v200, v66
    v_mul_f32 v201, v201, v66
    v_mfma_f32_16x16x32_bf16 v[212:215], v[124:127], a[164:167], v[212:215]
    ds_read_b64_tr_b16 a[122:123], v86 offset:49664
    buffer_load_dwordx4 a[44:47], v57, s[48:51], s95 offen sc1
    v_mfma_f32_16x16x32_bf16 v[208:211], v[120:123], a[128:131], v[208:211]
    ds_read_b64_tr_b16 a[124:125], v87 offset:49152
    v_mul_f32 v202, v202, v66
    v_mul_f32 v203, v203, v66
    v_mfma_f32_16x16x32_bf16 v[208:211], v[124:127], a[160:163], v[208:211]
    s_waitcnt lgkmcnt(11)
    ds_read_b64_tr_b16 a[126:127], v87 offset:49664
    v_mfma_f32_16x16x32_bf16 v[224:227], v[104:107], a[128:131], v[224:227]
    s_waitcnt vmcnt(8)
    ds_read_b64_tr_b16 a[136:137], v80 offset:16384
    v_mul_f32 v216, v216, v66
    v_mul_f32 v217, v217, v66
    v_mfma_f32_16x16x32_bf16 v[224:227], v[108:111], a[160:163], v[224:227]
    ds_read_b64_tr_b16 a[138:139], v80 offset:16896
    buffer_load_dwordx4 a[208:211], v58, s[48:51], s92 offen sc1
    v_mfma_f32_16x16x32_bf16 v[228:231], v[104:107], a[132:135], v[228:231]
    ds_read_b64_tr_b16 a[140:141], v81 offset:16384
    v_mul_f32 v218, v218, v66
    v_mul_f32 v219, v219, v66
    v_mfma_f32_16x16x32_bf16 v[228:231], v[108:111], a[164:167], v[228:231]
    ds_read_b64_tr_b16 a[142:143], v81 offset:16896
    v_mul_f32 v212, v212, v65
    v_mul_f32 v213, v213, v65
    v_mfma_f32_16x16x32_bf16 v[232:235], v[104:107], a[144:147], v[232:235]
    ds_read_b64_tr_b16 a[152:153], v82 offset:16384
    v_mul_f32 v214, v214, v65
    v_mul_f32 v215, v215, v65
    v_mfma_f32_16x16x32_bf16 v[232:235], v[108:111], a[176:179], v[232:235]
    ds_read_b64_tr_b16 a[154:155], v82 offset:16896
    buffer_load_dwordx4 a[240:243], v58, s[48:51], s93 offen sc1
    v_mfma_f32_16x16x32_bf16 v[236:239], v[104:107], a[148:151], v[236:239]
    ds_read_b64_tr_b16 a[156:157], v83 offset:16384
    v_mfma_f32_16x16x32_bf16 v[236:239], v[108:111], a[180:183], v[236:239]
    s_waitcnt lgkmcnt(11)
    ds_read_b64_tr_b16 a[158:159], v83 offset:16896
    v_mfma_f32_16x16x32_bf16 v[252:255], v[112:115], a[148:151], v[252:255]
    s_waitcnt vmcnt(6)
    ds_read_b64_tr_b16 a[168:169], v80 offset:32768
    v_mul_f32 v228, v228, v65
    v_mul_f32 v229, v229, v65
    v_mfma_f32_16x16x32_bf16 v[252:255], v[116:119], a[180:183], v[252:255]
    ds_read_b64_tr_b16 a[170:171], v80 offset:33280
    buffer_load_dwordx4 a[24:27], v58, s[48:51], s94 offen sc1
    v_mfma_f32_16x16x32_bf16 v[248:251], v[112:115], a[144:147], v[248:251]
    ds_read_b64_tr_b16 a[172:173], v81 offset:32768
    v_mul_f32 v230, v230, v65
    v_mul_f32 v231, v231, v65
    v_mfma_f32_16x16x32_bf16 v[248:251], v[116:119], a[176:179], v[248:251]
    ds_read_b64_tr_b16 a[174:175], v81 offset:33280
    v_mul_f32 v232, v232, v66
    v_mul_f32 v233, v233, v66
    v_mfma_f32_16x16x32_bf16 v[244:247], v[112:115], a[132:135], v[244:247]
    ds_read_b64_tr_b16 a[184:185], v82 offset:32768
    v_mul_f32 v234, v234, v66
    v_mul_f32 v235, v235, v66
    v_mfma_f32_16x16x32_bf16 v[244:247], v[116:119], a[164:167], v[244:247]
    ds_read_b64_tr_b16 a[186:187], v82 offset:33280
    buffer_load_dwordx4 a[56:59], v58, s[48:51], s95 offen sc1
    v_mfma_f32_16x16x32_bf16 v[240:243], v[112:115], a[128:131], v[240:243]
    ds_read_b64_tr_b16 a[188:189], v83 offset:32768
    v_mfma_f32_16x16x32_bf16 v[240:243], v[116:119], a[160:163], v[240:243]
    s_waitcnt vmcnt(4) lgkmcnt(13)
    ds_read_b64_tr_b16 a[190:191], v83 offset:33280
    v_mfma_f32_16x16x32_bf16 v[132:135], a[72:75], a[196:199], 0
    v_mul_f32 v248, v248, v66
    v_mul_f32 v249, v249, v66
    v_mul_f32 v250, v250, v66
    v_mul_f32 v251, v251, v66
    v_mfma_f32_16x16x32_bf16 v[132:135], a[104:107], a[228:231], v[132:135]
    buffer_load_dwordx4 a[212:215], v59, s[48:51], s92 offen sc1
    v_mul_f32 v244, v244, v65
    v_mul_f32 v245, v245, v65
    v_mfma_f32_16x16x32_bf16 v[132:135], a[136:139], a[12:15], v[132:135]
    v_mul_f32 v246, v246, v65
    v_mul_f32 v247, v247, v65
    v_mul_f32 v204, v204, v67
    v_mul_f32 v205, v205, v67
    s_waitcnt lgkmcnt(6)
    v_mfma_f32_16x16x32_bf16 v[132:135], a[168:171], a[44:47], v[132:135]
    v_mul_f32 v206, v206, v67
    v_mul_f32 v207, v207, v67
    v_mul_f32 v220, v220, v67
    v_mul_f32 v221, v221, v67
    v_mfma_f32_16x16x32_bf16 v[148:151], a[76:79], a[196:199], 0
    v_mul_f32 v222, v222, v67
    v_mul_f32 v223, v223, v67
    v_mfma_f32_16x16x32_bf16 v[148:151], a[108:111], a[228:231], v[148:151]
    buffer_load_dwordx4 a[244:247], v59, s[48:51], s93 offen sc1
    v_mfma_f32_16x16x32_bf16 v[148:151], a[140:143], a[12:15], v[148:151]
    s_waitcnt lgkmcnt(4)
    v_mfma_f32_16x16x32_bf16 v[148:151], a[172:175], a[44:47], v[148:151]
    s_waitcnt lgkmcnt(0)
    v_mfma_f32_16x16x32_bf16 v[164:167], a[88:91], a[196:199], 0
    v_fmac_f32 v196, v132, v61
    v_fmac_f32 v197, v133, v61
    v_fmac_f32 v198, v134, v61
    v_fmac_f32 v199, v135, v61
    v_mfma_f32_16x16x32_bf16 v[164:167], a[120:123], a[228:231], v[164:167]
    buffer_load_dwordx4 a[28:31], v59, s[48:51], s94 offen sc1
    ds_write_b128 v13, v[196:199] offset:0
    v_mfma_f32_16x16x32_bf16 v[164:167], a[152:155], a[12:15], v[164:167]
    v_mfma_f32_16x16x32_bf16 v[164:167], a[184:187], a[44:47], v[164:167]
    v_fmac_f32 v212, v148, v61
    v_fmac_f32 v213, v149, v61
    v_fmac_f32 v214, v150, v61
    v_fmac_f32 v215, v151, v61
    v_mfma_f32_16x16x32_bf16 v[180:183], a[92:95], a[196:199], 0
    ds_write_b128 v13, v[212:215] offset:1024
    v_mfma_f32_16x16x32_bf16 v[180:183], a[124:127], a[228:231], v[180:183]
    buffer_load_dwordx4 a[60:63], v59, s[48:51], s95 offen sc1
    v_mul_f32 v236, v236, v67
    v_mul_f32 v237, v237, v67
    v_mfma_f32_16x16x32_bf16 v[180:183], a[156:159], a[12:15], v[180:183]
    v_mul_f32 v238, v238, v67
    v_mul_f32 v239, v239, v67
    v_mul_f32 v252, v252, v67
    v_mul_f32 v253, v253, v67
    v_mfma_f32_16x16x32_bf16 v[180:183], a[188:191], a[44:47], v[180:183]
    s_waitcnt vmcnt(4)
    v_mul_f32 v254, v254, v67
    v_mul_f32 v255, v255, v67
    v_mfma_f32_16x16x32_bf16 v[136:139], a[72:75], a[208:211], 0
    v_fmac_f32 v228, v164, v61
    v_fmac_f32 v229, v165, v61
    v_fmac_f32 v230, v166, v61
    v_fmac_f32 v231, v167, v61
    v_mfma_f32_16x16x32_bf16 v[136:139], a[104:107], a[240:243], v[136:139]
    buffer_load_dwordx4 a[192:195], v56, s[48:51], s92 offen sc1
    ds_write_b128 v13, v[228:231] offset:2048
    v_mfma_f32_16x16x32_bf16 v[136:139], a[136:139], a[24:27], v[136:139]
    v_mfma_f32_16x16x32_bf16 v[136:139], a[168:171], a[56:59], v[136:139]
    v_fmac_f32 v244, v180, v61
    v_fmac_f32 v245, v181, v61
    v_fmac_f32 v246, v182, v61
    v_fmac_f32 v247, v183, v61
    v_mfma_f32_16x16x32_bf16 v[152:155], a[76:79], a[208:211], 0
    ds_write_b128 v13, v[244:247] offset:3072
    v_mfma_f32_16x16x32_bf16 v[152:155], a[108:111], a[240:243], v[152:155]
    buffer_load_dwordx4 a[224:227], v56, s[48:51], s93 offen sc1
    v_mul_f32 v192, v192, v64
    v_mul_f32 v193, v193, v64
    v_mfma_f32_16x16x32_bf16 v[152:155], a[140:143], a[24:27], v[152:155]
    v_mul_f32 v194, v194, v64
    v_mul_f32 v195, v195, v64
    v_mul_f32 v208, v208, v64
    v_mul_f32 v209, v209, v64
    v_mfma_f32_16x16x32_bf16 v[152:155], a[172:175], a[56:59], v[152:155]
    v_mul_f32 v210, v210, v64
    v_mul_f32 v211, v211, v64
    v_mfma_f32_16x16x32_bf16 v[168:171], a[88:91], a[208:211], 0
    s_waitcnt lgkmcnt(0)
    s_barrier
    ds_read_b128 v[132:135], v5 offset:0
    ds_read_b128 v[148:151], v5 offset:1024
    v_mfma_f32_16x16x32_bf16 v[168:171], a[120:123], a[240:243], v[168:171]
    buffer_load_dwordx4 a[8:11], v56, s[48:51], s94 offen sc1
    ds_read_b128 v[164:167], v5 offset:2048
    v_mfma_f32_16x16x32_bf16 v[168:171], a[152:155], a[24:27], v[168:171]
    ds_read_b128 v[180:183], v5 offset:3072
    v_fmac_f32 v200, v136, v62
    v_fmac_f32 v201, v137, v62
    v_fmac_f32 v202, v138, v62
    v_mfma_f32_16x16x32_bf16 v[168:171], a[184:187], a[56:59], v[168:171]
    buffer_load_dwordx4 a[40:43], v56, s[48:51], s95 offen sc1
    v_fmac_f32 v203, v139, v62
    v_mfma_f32_16x16x32_bf16 v[184:187], a[92:95], a[208:211], 0
    ds_write_b128 v14, v[200:203] offset:0
    v_mfma_f32_16x16x32_bf16 v[184:187], a[124:127], a[240:243], v[184:187]
    v_fmac_f32 v216, v152, v62
    v_fmac_f32 v217, v153, v62
    v_fmac_f32 v218, v154, v62
    v_fmac_f32 v219, v155, v62
    v_mfma_f32_16x16x32_bf16 v[184:187], a[156:159], a[24:27], v[184:187]
    ds_write_b128 v14, v[216:219] offset:1024
    v_mfma_f32_16x16x32_bf16 v[184:187], a[188:191], a[56:59], v[184:187]
    s_waitcnt vmcnt(4)
    v_mul_f32 v224, v224, v64
    v_mul_f32 v225, v225, v64
    v_mul_f32 v226, v226, v64
    v_mul_f32 v227, v227, v64
    v_mfma_f32_16x16x32_bf16 v[140:143], a[72:75], a[212:215], 0
    v_mul_f32 v240, v240, v64
    v_mul_f32 v241, v241, v64
    v_mul_f32 v242, v242, v64
    v_mul_f32 v243, v243, v64
    v_mfma_f32_16x16x32_bf16 v[140:143], a[104:107], a[244:247], v[140:143]
    v_fmac_f32 v232, v168, v62
    v_fmac_f32 v233, v169, v62
    v_fmac_f32 v234, v170, v62
    v_fmac_f32 v235, v171, v62
    v_mfma_f32_16x16x32_bf16 v[140:143], a[136:139], a[28:31], v[140:143]
    ds_write_b128 v14, v[232:235] offset:2048
    v_mfma_f32_16x16x32_bf16 v[140:143], a[168:171], a[60:63], v[140:143]
    v_fmac_f32 v248, v184, v62
    v_fmac_f32 v249, v185, v62
    v_fmac_f32 v250, v186, v62
    v_fmac_f32 v251, v187, v62
    v_mfma_f32_16x16x32_bf16 v[156:159], a[76:79], a[212:215], 0
    ds_write_b128 v14, v[248:251] offset:3072
    v_mfma_f32_16x16x32_bf16 v[156:159], a[108:111], a[244:247], v[156:159]
    s_waitcnt lgkmcnt(7)
    v_add_f32 v192, v192, v132
    v_add_f32 v193, v193, v133
    v_add_f32 v194, v194, v134
    v_add_f32 v195, v195, v135
    v_mfma_f32_16x16x32_bf16 v[156:159], a[140:143], a[28:31], v[156:159]
    s_waitcnt lgkmcnt(6)
    v_add_f32 v208, v208, v148
    v_add_f32 v209, v209, v149
    v_add_f32 v210, v210, v150
    v_add_f32 v211, v211, v151
    v_mfma_f32_16x16x32_bf16 v[156:159], a[172:175], a[60:63], v[156:159]
    s_waitcnt lgkmcnt(0)
    s_barrier
    ds_read_b128 v[136:139], v6 offset:0
    v_mfma_f32_16x16x32_bf16 v[172:175], a[88:91], a[212:215], 0
    ds_read_b128 v[152:155], v6 offset:1024
    ds_read_b128 v[168:171], v6 offset:2048
    v_mfma_f32_16x16x32_bf16 v[172:175], a[120:123], a[244:247], v[172:175]
    ds_read_b128 v[184:187], v6 offset:3072
    v_fmac_f32 v204, v140, v63
    v_fmac_f32 v205, v141, v63
    v_fmac_f32 v206, v142, v63
    v_mfma_f32_16x16x32_bf16 v[172:175], a[152:155], a[28:31], v[172:175]
    v_fmac_f32 v207, v143, v63
    v_mfma_f32_16x16x32_bf16 v[172:175], a[184:187], a[60:63], v[172:175]
    ds_write_b128 v15, v[204:207] offset:0
    v_mfma_f32_16x16x32_bf16 v[188:191], a[92:95], a[212:215], 0
    v_fmac_f32 v220, v156, v63
    v_fmac_f32 v221, v157, v63
    v_fmac_f32 v222, v158, v63
    v_fmac_f32 v223, v159, v63
    v_mfma_f32_16x16x32_bf16 v[188:191], a[124:127], a[244:247], v[188:191]
    ds_write_b128 v15, v[220:223] offset:1024
    v_mfma_f32_16x16x32_bf16 v[188:191], a[156:159], a[28:31], v[188:191]
    v_add_f32 v224, v224, v164
    v_add_f32 v225, v225, v165
    v_add_f32 v226, v226, v166
    v_add_f32 v227, v227, v167
    v_mfma_f32_16x16x32_bf16 v[188:191], a[188:191], a[60:63], v[188:191]
    s_waitcnt vmcnt(0)
    v_add_f32 v240, v240, v180
    v_add_f32 v241, v241, v181
    v_add_f32 v242, v242, v182
    v_add_f32 v243, v243, v183
    v_mfma_f32_16x16x32_bf16 v[128:131], a[72:75], a[192:195], 0
    s_waitcnt lgkmcnt(5)
    v_add_f32 v192, v192, v136
    v_add_f32 v193, v193, v137
    v_add_f32 v194, v194, v138
    v_add_f32 v195, v195, v139
    v_mfma_f32_16x16x32_bf16 v[128:131], a[104:107], a[224:227], v[128:131]
    v_fmac_f32 v236, v172, v63
    v_fmac_f32 v237, v173, v63
    v_fmac_f32 v238, v174, v63
    v_fmac_f32 v239, v175, v63
    v_mfma_f32_16x16x32_bf16 v[128:131], a[136:139], a[8:11], v[128:131]
    ds_write_b128 v15, v[236:239] offset:2048
    v_mfma_f32_16x16x32_bf16 v[128:131], a[168:171], a[40:43], v[128:131]
    v_fmac_f32 v252, v188, v63
    v_fmac_f32 v253, v189, v63
    v_fmac_f32 v254, v190, v63
    v_fmac_f32 v255, v191, v63
    v_mfma_f32_16x16x32_bf16 v[144:147], a[76:79], a[192:195], 0
    ds_write_b128 v15, v[252:255] offset:3072
    v_mfma_f32_16x16x32_bf16 v[144:147], a[108:111], a[224:227], v[144:147]
    s_waitcnt lgkmcnt(6)
    v_add_f32 v208, v208, v152
LB_pg5:
    s_cbranch_execz LB_walked
    v_add_f32 v209, v209, v153
    v_add_f32 v210, v210, v154
    v_add_f32 v211, v211, v155
    v_mfma_f32_16x16x32_bf16 v[144:147], a[140:143], a[8:11], v[144:147]
    s_waitcnt lgkmcnt(5)
    v_add_f32 v224, v224, v168
    v_add_f32 v225, v225, v169
    v_add_f32 v226, v226, v170
    v_add_f32 v227, v227, v171
    v_mfma_f32_16x16x32_bf16 v[144:147], a[172:175], a[40:43], v[144:147]
    s_waitcnt lgkmcnt(0)
    s_barrier
    ds_read_b128 v[140:143], v7 offset:0
    v_mfma_f32_16x16x32_bf16 v[160:163], a[88:91], a[192:195], 0
    ds_read_b128 v[156:159], v7 offset:1024
    ds_read_b128 v[172:175], v7 offset:2048
    v_mfma_f32_16x16x32_bf16 v[160:163], a[120:123], a[224:227], v[160:163]
    ds_read_b128 v[188:191], v7 offset:3072
    v_add_f32 v240, v240, v184
    v_add_f32 v241, v241, v185
    v_add_f32 v242, v242, v186
    v_mfma_f32_16x16x32_bf16 v[160:163], a[152:155], a[8:11], v[160:163]
    v_add_f32 v243, v243, v187
    v_fmac_f32 v192, v128, v60
    v_fmac_f32 v193, v129, v60
    v_fmac_f32 v194, v130, v60
    v_mfma_f32_16x16x32_bf16 v[160:163], a[184:187], a[40:43], v[160:163]
    v_fmac_f32 v195, v131, v60
    v_fmac_f32 v208, v144, v60
    v_fmac_f32 v209, v145, v60
    v_fmac_f32 v210, v146, v60
    v_mfma_f32_16x16x32_bf16 v[176:179], a[92:95], a[192:195], 0
    v_fmac_f32 v211, v147, v60
    s_waitcnt lgkmcnt(3)
    v_add_f32 v192, v192, v140
    v_add_f32 v193, v193, v141
    v_add_f32 v194, v194, v142
    v_mfma_f32_16x16x32_bf16 v[176:179], a[124:127], a[224:227], v[176:179]
    v_add_f32 v195, v195, v143
    s_waitcnt lgkmcnt(2)
    v_add_f32 v208, v208, v156
    v_add_f32 v209, v209, v157
    v_add_f32 v210, v210, v158
    v_mfma_f32_16x16x32_bf16 v[176:179], a[156:159], a[8:11], v[176:179]
    v_add_f32 v211, v211, v159
    s_waitcnt lgkmcnt(1)
    v_add_f32 v224, v224, v172
    v_add_f32 v225, v225, v173
    v_add_f32 v226, v226, v174
    v_mfma_f32_16x16x32_bf16 v[176:179], a[188:191], a[40:43], v[176:179]
    v_add_f32 v227, v227, v175
    s_waitcnt lgkmcnt(0)
    v_add_f32 v240, v240, v188
    v_add_f32 v241, v241, v189
    v_add_f32 v242, v242, v190
    v_add_f32 v243, v243, v191
    v_cvt_pk_bf16_f32 v196, v192, v193
    v_cvt_pk_bf16_f32 v197, v194, v195
    v_cvt_pk_bf16_f32 v198, v208, v209
    v_cvt_pk_bf16_f32 v199, v210, v211
    s_nop 0
    v_permlane16_swap_b32 v196, v198
    v_permlane16_swap_b32 v197, v199
    v_mov_b32 v212, v196
    v_mov_b32 v213, v197
    v_mov_b32 v214, v198
    v_mov_b32 v215, v199
    v_fmac_f32 v224, v160, v60
    v_fmac_f32 v225, v161, v60
    v_fmac_f32 v226, v162, v60
    v_fmac_f32 v227, v163, v60
    v_fmac_f32 v240, v176, v60
    v_fmac_f32 v241, v177, v60
    v_fmac_f32 v242, v178, v60
    v_fmac_f32 v243, v179, v60
    v_cvt_pk_bf16_f32 v228, v224, v225
    v_cvt_pk_bf16_f32 v229, v226, v227
    v_cvt_pk_bf16_f32 v230, v240, v241
    v_cvt_pk_bf16_f32 v231, v242, v243
    s_nop 0
    v_permlane16_swap_b32 v228, v230
    v_permlane16_swap_b32 v229, v231
    s_nop 0
    v_mov_b32_dpp v196, v228 row_ror:8 row_mask:0xf bank_mask:0xc
    v_mov_b32_dpp v197, v229 row_ror:8 row_mask:0xf bank_mask:0xc
    v_mov_b32_dpp v198, v230 row_ror:8 row_mask:0xf bank_mask:0xc
    v_mov_b32_dpp v199, v231 row_ror:8 row_mask:0xf bank_mask:0xc
    buffer_store_dwordx4 v[196:199], v12, s[52:55], s86 offen sc1
    v_mov_b32_dpp v228, v212 row_ror:8 row_mask:0xf bank_mask:0x3
    v_mov_b32_dpp v229, v213 row_ror:8 row_mask:0xf bank_mask:0x3
    v_mov_b32_dpp v230, v214 row_ror:8 row_mask:0xf bank_mask:0x3
    v_mov_b32_dpp v231, v215 row_ror:8 row_mask:0xf bank_mask:0x3
    buffer_store_dwordx4 v[228:231], v12, s[52:55], s87 offen sc1
    s_endpgm
L_code_end:
.section .rodata,"a"
.p2align 6
.amdhsa_kernel gated_mix__linear_attn_block__glu_gated_reglu__prompt_kernel
  .amdhsa_next_free_vgpr 512
  .amdhsa_next_free_sgpr 102
  .amdhsa_accum_offset 256
  .amdhsa_group_segment_fixed_size 0
  .amdhsa_kernarg_size 88
  .amdhsa_user_sgpr_count 2
  .amdhsa_user_sgpr_kernarg_segment_ptr 1
  .amdhsa_system_sgpr_workgroup_id_x 1
.end_amdhsa_kernel
```
